```python
import torch

def _softmax(x, axis=-1):
    return torch.softmax(x, dim=axis)
def _gelu(x):
    return torch.nn.functional.gelu(x, approximate="tanh")
def _silu(x):
    return torch.nn.functional.silu(x)
def _sigmoid(x):
    return torch.sigmoid(x)
def _layernorm(x, axis=-1, eps=1e-5):
    m = x.mean(dim=axis, keepdim=True)
    v = x.var(dim=axis, keepdim=True, unbiased=False)
    return (x - m) / torch.sqrt(v + eps)
def _scatter_add(tgt, idx, src, axis=0):
    return tgt.clone().index_add_(axis, idx, src)
def _segment_sum(src, seg, n):
    out = torch.zeros((n,) + src.shape[1:], dtype=src.dtype)
    return out.index_add_(0, seg, src)
def _pad(x, pw):
    flat = tuple(v for pair in reversed(pw) for v in pair)
    return torch.nn.functional.pad(x, flat)

kernel_name = 'concat_heads__softmax_full_mha__ssm_conv_s5__prompt'

def setup_inputs():

    _w = (lambda a: (lambda t: t.to(torch.bfloat16) if t.is_floating_point() else t)(torch.as_tensor(a)))
    def _A_setup():
        B, S, D = 1, 2048, 640
        return {
            "x": _w((lambda *s: torch.randn(*s, dtype=torch.bfloat16) * 0.2)(B, S, D)),
            "wqkv": _w((lambda *s: torch.randn(*s, dtype=torch.bfloat16) * 0.2)(D, 3 * D)),
            "wo": _w((lambda *s: torch.randn(*s, dtype=torch.bfloat16) * 0.05)(D, D)),
        }
    _A_in = _A_setup()

    def _B_setup():
        B, S, D = 1, 2048, 640
        P = D
        Lambda_re = -0.5 * (lambda _x: torch.exp(torch.as_tensor(_x)))((lambda *s: torch.randn(*s, dtype=torch.bfloat16) * 0.8)(P))
        Lambda_im = (lambda *s: torch.randn(*s, dtype=torch.bfloat16) * 0.8)(P) * 1.0
        B_re = (lambda *s: torch.randn(*s, dtype=torch.bfloat16) * 0.8)(P, D) * (D ** -0.5)
        B_im = (lambda *s: torch.randn(*s, dtype=torch.bfloat16) * 0.8)(P, D) * (D ** -0.5)
        C_re = (lambda *s: torch.randn(*s, dtype=torch.bfloat16) * 0.8)(D, P) * (P ** -0.5)
        C_im = (lambda *s: torch.randn(*s, dtype=torch.bfloat16) * 0.8)(D, P) * (P ** -0.5)
        log_dt = (lambda *s: torch.randn(*s, dtype=torch.bfloat16) * 0.8)(P) * 0.3 - 2.0
        Dskip = (lambda *s: torch.randn(*s, dtype=torch.bfloat16) * 0.8)(D)
        return {
            "x": _w((lambda *s: torch.randn(*s, dtype=torch.bfloat16) * 0.05)(B, S, D)),
            "Lambda_re": _w(Lambda_re),
            "Lambda_im": _w(Lambda_im),
            "B_re": _w(B_re),
            "B_im": _w(B_im),
            "C_re": _w(C_re),
            "C_im": _w(C_im),
            "log_dt": _w(log_dt),
            "Dskip": _w(Dskip),
        }
    _B_in = _B_setup()

    return {
        "A_x": _A_in["x"],
        "A_wqkv": _A_in["wqkv"],
        "A_wo": _A_in["wo"],
        "B_x": _B_in["x"],
        "B_Lambda_re": _B_in["Lambda_re"],
        "B_Lambda_im": _B_in["Lambda_im"],
        "B_B_re": _B_in["B_re"],
        "B_B_im": _B_in["B_im"],
        "B_C_re": _B_in["C_re"],
        "B_C_im": _B_in["C_im"],
        "B_log_dt": _B_in["log_dt"],
        "B_Dskip": _B_in["Dskip"],
    }

def reference(A_x, A_wqkv, A_wo, B_x, B_Lambda_re, B_Lambda_im, B_B_re, B_B_im, B_C_re, B_C_im, B_log_dt, B_Dskip):
    def _A_ref(x, wqkv, wo):
        B, S, D = x.shape
        H = 32; Dh = D // H
        qkv = (lambda x, *d: x.permute(*d))((x @ wqkv).reshape(B, S, 3, H, Dh), 2, 0, 3, 1, 4)
        q, k, v = qkv[0], qkv[1], qkv[2]
        scale = Dh ** -0.5
        scores = torch.einsum("bhqd,bhkd->bhqk", q, k) * scale
        p = _softmax(scores, axis=-1)
        o = torch.einsum("bhqk,bhkd->bhqd", p, v)
        return (lambda x, *d: x.permute(*d))(o, 0, 2, 1, 3).reshape(B, S, D) @ wo

    def _B_ref(x, Lambda_re, Lambda_im, B_re, B_im, C_re, C_im, log_dt, Dskip):
        Bsz, L, H = x.shape
        Lam = Lambda_re + 1j * Lambda_im
        Bmat = B_re + 1j * B_im
        Cmat = C_re + 1j * C_im
        dt = torch.exp(log_dt)
        Lam_bar = torch.exp(dt * Lam)
        B_bar = ((Lam_bar - 1.0) / Lam)[:, None] * Bmat
        Bu = torch.einsum("bld,pd->blp", x + 0j, B_bar)
        h = torch.zeros_like(Bu[:, 0, :])
        hs = []
        for t in range(L):
            h = Lam_bar[None, :] * h + Bu[:, t, :]
            hs.append(h)
        hseq = torch.stack(hs, 1)
        y = 2.0 * torch.einsum("blp,dp->bld", hseq, Cmat).real + x * Dskip[None, None, :]
        return y

    a = _A_ref(A_x, A_wqkv, A_wo)
    b = _B_ref(B_x, B_Lambda_re, B_Lambda_im, B_B_re, B_B_im, B_C_re, B_C_im, B_log_dt, B_Dskip)
    return torch.concatenate([a, b], axis=-1)
```

```asm
; @launch grid=(512,1,1) block=(512,1,1) lds=81920
.amdgcn_target "amdgcn-amd-amdhsa--gfx950"

.text
.globl concat_heads__softmax_full_mha__ssm_conv_s5__prompt_kernel
.p2align 8
.type concat_heads__softmax_full_mha__ssm_conv_s5__prompt_kernel,@function
concat_heads__softmax_full_mha__ssm_conv_s5__prompt_kernel:
    s_cmp_ge_u32 s2, 256
    s_cbranch_scc1 L_ROLE_B
    s_load_dwordx2 s[44:45], s[0:1], 0
    s_load_dwordx2 s[48:49], s[0:1], 8
    s_load_dwordx2 s[56:57], s[0:1], 112
    v_lshrrev_b32 v2, 6, v0
    v_and_b32 v1, 63, v0
    v_readfirstlane_b32 s40, v2
    s_lshr_b32 s42, s2, 4
    s_and_b32 s42, s42, 14
    s_bfe_u32 s67, s2, 0x10002
    s_or_b32 s42, s42, s67
    s_lshr_b32 s41, s2, 1
    s_and_b32 s41, s41, 12
    s_and_b32 s67, s2, 3
    s_or_b32 s41, s41, s67
    s_cmp_eq_u32 s42, 15
    s_cselect_b32 s67, 8, 0
    s_add_u32 s41, s41, s67
    s_min_u32 s42, s42, 14
    s_mul_i32 s43, s41, 3
    s_add_u32 s43, s43, s42
    s_mul_i32 s67, s43, 205
    s_lshr_b32 s67, s67, 11
    s_mul_i32 s67, s67, 10
    s_sub_u32 s43, s43, s67
    s_mul_i32 s64, s43, 245760
    s_lshl_b32 s43, s43, 7
    s_lshl_b32 s67, s41, 7
    s_lshr_b32 s68, s40, 1
    s_lshl_b32 s68, s68, 5
    s_add_u32 s67, s67, s68
    s_and_b32 s68, s40, 1
    s_add_u32 s67, s67, s68
    v_lshrrev_b32 v10, 3, v1
    v_lshl_add_u32 v10, v10, 1, s67
    v_mul_u32_u24 v10, 1280, v10
    v_lshrrev_b32 v11, 4, v1
    v_and_b32 v12, 7, v1
    v_xor_b32 v12, v12, v11
    v_lshl_add_u32 v2, v12, 4, v10
    s_lshl_b32 s65, s40, 11
    s_mov_b32 s46, 2621440
    s_mov_b32 s47, 0x20000
    s_mov_b32 m0, s65
    s_cmp_ge_u32 s2, 240
    s_cbranch_scc1 L_QKV_IDLE
    s_waitcnt lgkmcnt(0)
    buffer_load_dwordx4 v2, s[44:47], s43 offen lds
    v_xor_b32 v3, 64, v2
    v_add_u32 v3, 20480, v3
    s_add_u32 m0, s65, 1024
    s_nop 0
    buffer_load_dwordx4 v3, s[44:47], s43 offen lds
    s_add_u32 s43, s43, 128
    s_cmp_eq_u32 s43, 1280
    s_cselect_b32 s43, 0, s43
    s_lshl_b32 s68, s40, 2
    v_add_u32 v10, s68, v11
    v_mul_u32_u24 v10, 3840, v10
    s_and_b32 s68, s40, 2
    s_lshl_b32 s68, s68, 2
    v_and_b32 v12, 15, v1
    v_lshl_add_u32 v13, v11, 1, s68
    v_xor_b32 v12, v12, v13
    v_lshl_add_u32 v10, v12, 4, v10
    s_lshl_b32 s68, s42, 8
    v_add_u32 v4, s68, v10
    s_lshl_b32 s66, s40, 10
    s_add_u32 s66, s66, 49152
    s_mov_b32 s50, 2457600
    s_mov_b32 s51, 0x20000
    s_add_u32 m0, s66, 0
    s_nop 0
    buffer_load_dwordx4 v4, s[48:51], s64 offen lds
    s_add_u32 s64, s64, 122880
    s_cmp_eq_u32 s64, 2457600
    s_cselect_b32 s64, 0, s64
    s_load_dword s6, s[56:57], 0
    s_mov_b32 s58, 19922944
    s_mov_b32 s59, 0x20000
    s_barrier
    s_add_u32 m0, s66, 8192
    s_nop 0
    buffer_load_dwordx4 v4, s[48:51], s64 offen lds
    s_add_u32 s64, s64, 122880
    s_cmp_eq_u32 s64, 2457600
    s_cselect_b32 s64, 0, s64
    s_add_u32 m0, s65, 16384
    s_nop 0
    buffer_load_dwordx4 v2, s[44:47], s43 offen lds
    s_add_u32 m0, s65, 17408
    s_nop 0
    buffer_load_dwordx4 v3, s[44:47], s43 offen lds
    s_add_u32 s43, s43, 128
    s_cmp_eq_u32 s43, 1280
    s_cselect_b32 s43, 0, s43
    s_add_u32 m0, s66, 16384
    s_nop 0
    buffer_load_dwordx4 v4, s[48:51], s64 offen lds
    s_add_u32 s64, s64, 122880
    s_cmp_eq_u32 s64, 2457600
    s_cselect_b32 s64, 0, s64
    v_lshrrev_b32 v10, 4, v1
    v_bfe_u32 v11, v1, 2, 2
    v_lshl_add_u32 v12, v10, 3, v11
    v_lshlrev_b32 v12, 8, v12
    s_and_b32 s68, s40, 3
    s_lshl_b32 s68, s68, 2
    v_bfe_u32 v13, v1, 1, 1
    v_add_u32 v13, s68, v13
    v_and_b32 v14, 1, v10
    v_lshl_add_u32 v11, v14, 2, v11
    v_lshlrev_b32 v11, 1, v11
    v_xor_b32 v13, v13, v11
    v_lshl_add_u32 v12, v13, 4, v12
    v_and_b32 v14, 1, v1
    v_lshl_add_u32 v12, v14, 3, v12
    v_add_u32 v5, 49152, v12
    v_xor_b32 v6, 32, v5
    s_lshr_b32 s68, s40, 2
    s_lshl_b32 s68, s68, 6
    v_and_b32 v11, 15, v1
    v_add_u32 v12, s68, v11
    v_lshlrev_b32 v12, 7, v12
    v_lshrrev_b32 v13, 1, v11
    v_xor_b32 v13, v13, v10
    v_lshl_add_u32 v7, v13, 4, v12
    v_xor_b32 v8, 64, v7
    s_waitcnt vmcnt(4)
    s_barrier
    ds_read_b64_tr_b16 v[64:65], v5 offset:0
    ds_read_b64_tr_b16 v[66:67], v5 offset:1024
    ds_read_b128 v[72:75], v7 offset:0
    ds_read_b128 v[76:79], v7 offset:2048
    ds_read_b64_tr_b16 v[68:69], v6 offset:0
    ds_read_b64_tr_b16 v[70:71], v6 offset:1024
    ds_read_b128 v[80:83], v7 offset:4096
    ds_read_b128 v[84:87], v7 offset:6144
    s_add_u32 m0, s66, 24576
    s_nop 0
    buffer_load_dwordx4 v4, s[48:51], s64 offen lds
    s_add_u32 s64, s64, 122880
    s_cmp_eq_u32 s64, 2457600
    s_cselect_b32 s64, 0, s64
    s_add_u32 m0, s65, 32768
    s_nop 0
    buffer_load_dwordx4 v2, s[44:47], s43 offen lds
    s_add_u32 m0, s65, 33792
    s_nop 0
    buffer_load_dwordx4 v3, s[44:47], s43 offen lds
    s_add_u32 s43, s43, 128
    s_cmp_eq_u32 s43, 1280
    s_cselect_b32 s43, 0, s43
    s_waitcnt lgkmcnt(0)
    s_waitcnt vmcnt(6)
    s_barrier
    v_mfma_f32_16x16x32_bf16 v[32:35], v[64:67], v[72:75], 0
    v_mfma_f32_16x16x32_bf16 v[48:51], v[68:71], v[72:75], 0
    ds_read_b64_tr_b16 v[88:89], v5 offset:8192
    ds_read_b64_tr_b16 v[90:91], v5 offset:9216
    ds_read_b128 v[96:99], v8 offset:0
    v_mfma_f32_16x16x32_bf16 v[36:39], v[64:67], v[76:79], 0
    v_mfma_f32_16x16x32_bf16 v[52:55], v[68:71], v[76:79], 0
    ds_read_b128 v[100:103], v8 offset:2048
    ds_read_b64_tr_b16 v[92:93], v6 offset:8192
    ds_read_b64_tr_b16 v[94:95], v6 offset:9216
    v_mfma_f32_16x16x32_bf16 v[40:43], v[64:67], v[80:83], 0
    v_mfma_f32_16x16x32_bf16 v[56:59], v[68:71], v[80:83], 0
    ds_read_b128 v[104:107], v8 offset:4096
    ds_read_b128 v[108:111], v8 offset:6144
    s_add_u32 m0, s66, 0
    s_nop 0
    buffer_load_dwordx4 v4, s[48:51], s64 offen lds
    s_add_u32 s64, s64, 122880
    s_cmp_eq_u32 s64, 2457600
    s_cselect_b32 s64, 0, s64
    s_mul_i32 s6, s6, 0x9E3779B1
    s_add_u32 s6, s6, 0x7F4A7C15
    s_xor_b32 s7, s6, 0x5bd1e995
    v_mfma_f32_16x16x32_bf16 v[44:47], v[64:67], v[84:87], 0
    v_mfma_f32_16x16x32_bf16 v[60:63], v[68:71], v[84:87], 0
    s_waitcnt lgkmcnt(0)
    s_waitcnt vmcnt(4)
    s_barrier
    v_mfma_f32_16x16x32_bf16 v[32:35], v[88:91], v[96:99], v[32:35]
    v_mfma_f32_16x16x32_bf16 v[48:51], v[92:95], v[96:99], v[48:51]
    ds_read_b64_tr_b16 v[64:65], v5 offset:16384
    ds_read_b64_tr_b16 v[66:67], v5 offset:17408
    ds_read_b128 v[72:75], v7 offset:16384
    v_mfma_f32_16x16x32_bf16 v[36:39], v[88:91], v[100:103], v[36:39]
    v_mfma_f32_16x16x32_bf16 v[52:55], v[92:95], v[100:103], v[52:55]
    ds_read_b128 v[76:79], v7 offset:18432
    ds_read_b64_tr_b16 v[68:69], v6 offset:16384
    ds_read_b64_tr_b16 v[70:71], v6 offset:17408
    v_mfma_f32_16x16x32_bf16 v[40:43], v[88:91], v[104:107], v[40:43]
    v_mfma_f32_16x16x32_bf16 v[56:59], v[92:95], v[104:107], v[56:59]
    ds_read_b128 v[80:83], v7 offset:20480
    ds_read_b128 v[84:87], v7 offset:22528
    s_add_u32 m0, s66, 8192
    s_nop 0
    buffer_load_dwordx4 v4, s[48:51], s64 offen lds
    s_add_u32 s64, s64, 122880
    s_cmp_eq_u32 s64, 2457600
    s_cselect_b32 s64, 0, s64
    s_add_u32 m0, s65, 0
    s_nop 0
    buffer_load_dwordx4 v2, s[44:47], s43 offen lds
    s_add_u32 m0, s65, 1024
    s_nop 0
    buffer_load_dwordx4 v3, s[44:47], s43 offen lds
    s_add_u32 s43, s43, 128
    s_cmp_eq_u32 s43, 1280
    s_cselect_b32 s43, 0, s43
    v_mfma_f32_16x16x32_bf16 v[44:47], v[88:91], v[108:111], v[44:47]
    v_mfma_f32_16x16x32_bf16 v[60:63], v[92:95], v[108:111], v[60:63]
    s_waitcnt lgkmcnt(0)
    s_waitcnt vmcnt(6)
    s_barrier
    v_mfma_f32_16x16x32_bf16 v[32:35], v[64:67], v[72:75], v[32:35]
    v_mfma_f32_16x16x32_bf16 v[48:51], v[68:71], v[72:75], v[48:51]
    ds_read_b64_tr_b16 v[88:89], v5 offset:24576
    ds_read_b64_tr_b16 v[90:91], v5 offset:25600
    ds_read_b128 v[96:99], v8 offset:16384
    v_mfma_f32_16x16x32_bf16 v[36:39], v[64:67], v[76:79], v[36:39]
    v_mfma_f32_16x16x32_bf16 v[52:55], v[68:71], v[76:79], v[52:55]
    ds_read_b128 v[100:103], v8 offset:18432
    ds_read_b64_tr_b16 v[92:93], v6 offset:24576
    ds_read_b64_tr_b16 v[94:95], v6 offset:25600
    v_mfma_f32_16x16x32_bf16 v[40:43], v[64:67], v[80:83], v[40:43]
    v_mfma_f32_16x16x32_bf16 v[56:59], v[68:71], v[80:83], v[56:59]
    ds_read_b128 v[104:107], v8 offset:20480
    ds_read_b128 v[108:111], v8 offset:22528
    s_add_u32 m0, s66, 16384
    s_nop 0
    buffer_load_dwordx4 v4, s[48:51], s64 offen lds
    s_add_u32 s64, s64, 122880
    s_cmp_eq_u32 s64, 2457600
    s_cselect_b32 s64, 0, s64
    v_mfma_f32_16x16x32_bf16 v[44:47], v[64:67], v[84:87], v[44:47]
    v_mfma_f32_16x16x32_bf16 v[60:63], v[68:71], v[84:87], v[60:63]
    s_waitcnt lgkmcnt(0)
    s_waitcnt vmcnt(4)
    s_barrier
    v_mfma_f32_16x16x32_bf16 v[32:35], v[88:91], v[96:99], v[32:35]
    v_mfma_f32_16x16x32_bf16 v[48:51], v[92:95], v[96:99], v[48:51]
    ds_read_b64_tr_b16 v[64:65], v5 offset:0
    ds_read_b64_tr_b16 v[66:67], v5 offset:1024
    ds_read_b128 v[72:75], v7 offset:32768
    v_mfma_f32_16x16x32_bf16 v[36:39], v[88:91], v[100:103], v[36:39]
    v_mfma_f32_16x16x32_bf16 v[52:55], v[92:95], v[100:103], v[52:55]
    ds_read_b128 v[76:79], v7 offset:34816
    ds_read_b64_tr_b16 v[68:69], v6 offset:0
    ds_read_b64_tr_b16 v[70:71], v6 offset:1024
    v_mfma_f32_16x16x32_bf16 v[40:43], v[88:91], v[104:107], v[40:43]
    v_mfma_f32_16x16x32_bf16 v[56:59], v[92:95], v[104:107], v[56:59]
    ds_read_b128 v[80:83], v7 offset:36864
    ds_read_b128 v[84:87], v7 offset:38912
    s_add_u32 m0, s66, 24576
    s_nop 0
    buffer_load_dwordx4 v4, s[48:51], s64 offen lds
    s_add_u32 s64, s64, 122880
    s_cmp_eq_u32 s64, 2457600
    s_cselect_b32 s64, 0, s64
    s_add_u32 m0, s65, 16384
    s_nop 0
    buffer_load_dwordx4 v2, s[44:47], s43 offen lds
    s_add_u32 m0, s65, 17408
    s_nop 0
    buffer_load_dwordx4 v3, s[44:47], s43 offen lds
    s_add_u32 s43, s43, 128
    s_cmp_eq_u32 s43, 1280
    s_cselect_b32 s43, 0, s43
    v_mfma_f32_16x16x32_bf16 v[44:47], v[88:91], v[108:111], v[44:47]
    v_mfma_f32_16x16x32_bf16 v[60:63], v[92:95], v[108:111], v[60:63]
    s_waitcnt lgkmcnt(0)
    s_waitcnt vmcnt(6)
    s_barrier
    v_mfma_f32_16x16x32_bf16 v[32:35], v[64:67], v[72:75], v[32:35]
    v_mfma_f32_16x16x32_bf16 v[48:51], v[68:71], v[72:75], v[48:51]
    ds_read_b64_tr_b16 v[88:89], v5 offset:8192
    ds_read_b64_tr_b16 v[90:91], v5 offset:9216
    ds_read_b128 v[96:99], v8 offset:32768
    v_mfma_f32_16x16x32_bf16 v[36:39], v[64:67], v[76:79], v[36:39]
    v_mfma_f32_16x16x32_bf16 v[52:55], v[68:71], v[76:79], v[52:55]
    ds_read_b128 v[100:103], v8 offset:34816
    ds_read_b64_tr_b16 v[92:93], v6 offset:8192
    ds_read_b64_tr_b16 v[94:95], v6 offset:9216
    v_mfma_f32_16x16x32_bf16 v[40:43], v[64:67], v[80:83], v[40:43]
    v_mfma_f32_16x16x32_bf16 v[56:59], v[68:71], v[80:83], v[56:59]
    ds_read_b128 v[104:107], v8 offset:36864
    ds_read_b128 v[108:111], v8 offset:38912
    s_add_u32 m0, s66, 0
    s_nop 0
    buffer_load_dwordx4 v4, s[48:51], s64 offen lds
    s_add_u32 s64, s64, 122880
    s_cmp_eq_u32 s64, 2457600
    s_cselect_b32 s64, 0, s64
    v_mfma_f32_16x16x32_bf16 v[44:47], v[64:67], v[84:87], v[44:47]
    v_mfma_f32_16x16x32_bf16 v[60:63], v[68:71], v[84:87], v[60:63]
    s_waitcnt lgkmcnt(0)
    s_waitcnt vmcnt(4)
    s_barrier
    v_mfma_f32_16x16x32_bf16 v[32:35], v[88:91], v[96:99], v[32:35]
    v_mfma_f32_16x16x32_bf16 v[48:51], v[92:95], v[96:99], v[48:51]
    ds_read_b64_tr_b16 v[64:65], v5 offset:16384
    ds_read_b64_tr_b16 v[66:67], v5 offset:17408
    ds_read_b128 v[72:75], v7 offset:0
    v_mfma_f32_16x16x32_bf16 v[36:39], v[88:91], v[100:103], v[36:39]
    v_mfma_f32_16x16x32_bf16 v[52:55], v[92:95], v[100:103], v[52:55]
    ds_read_b128 v[76:79], v7 offset:2048
    ds_read_b64_tr_b16 v[68:69], v6 offset:16384
    ds_read_b64_tr_b16 v[70:71], v6 offset:17408
    v_mfma_f32_16x16x32_bf16 v[40:43], v[88:91], v[104:107], v[40:43]
    v_mfma_f32_16x16x32_bf16 v[56:59], v[92:95], v[104:107], v[56:59]
    ds_read_b128 v[80:83], v7 offset:4096
    ds_read_b128 v[84:87], v7 offset:6144
    s_add_u32 m0, s66, 8192
    s_nop 0
    buffer_load_dwordx4 v4, s[48:51], s64 offen lds
    s_add_u32 s64, s64, 122880
    s_cmp_eq_u32 s64, 2457600
    s_cselect_b32 s64, 0, s64
    s_add_u32 m0, s65, 32768
    s_nop 0
    buffer_load_dwordx4 v2, s[44:47], s43 offen lds
    s_add_u32 m0, s65, 33792
    s_nop 0
    buffer_load_dwordx4 v3, s[44:47], s43 offen lds
    s_add_u32 s43, s43, 128
    s_cmp_eq_u32 s43, 1280
    s_cselect_b32 s43, 0, s43
    v_mfma_f32_16x16x32_bf16 v[44:47], v[88:91], v[108:111], v[44:47]
    v_mfma_f32_16x16x32_bf16 v[60:63], v[92:95], v[108:111], v[60:63]
    s_waitcnt lgkmcnt(0)
    s_waitcnt vmcnt(6)
    s_barrier
    v_mfma_f32_16x16x32_bf16 v[32:35], v[64:67], v[72:75], v[32:35]
    v_mfma_f32_16x16x32_bf16 v[48:51], v[68:71], v[72:75], v[48:51]
    ds_read_b64_tr_b16 v[88:89], v5 offset:24576
    ds_read_b64_tr_b16 v[90:91], v5 offset:25600
    ds_read_b128 v[96:99], v8 offset:0
    v_mfma_f32_16x16x32_bf16 v[36:39], v[64:67], v[76:79], v[36:39]
    v_mfma_f32_16x16x32_bf16 v[52:55], v[68:71], v[76:79], v[52:55]
    ds_read_b128 v[100:103], v8 offset:2048
    ds_read_b64_tr_b16 v[92:93], v6 offset:24576
    ds_read_b64_tr_b16 v[94:95], v6 offset:25600
    v_mfma_f32_16x16x32_bf16 v[40:43], v[64:67], v[80:83], v[40:43]
    v_mfma_f32_16x16x32_bf16 v[56:59], v[68:71], v[80:83], v[56:59]
    ds_read_b128 v[104:107], v8 offset:4096
    ds_read_b128 v[108:111], v8 offset:6144
    s_add_u32 m0, s66, 16384
    s_nop 0
    buffer_load_dwordx4 v4, s[48:51], s64 offen lds
    s_add_u32 s64, s64, 122880
    s_cmp_eq_u32 s64, 2457600
    s_cselect_b32 s64, 0, s64
    v_mfma_f32_16x16x32_bf16 v[44:47], v[64:67], v[84:87], v[44:47]
    v_mfma_f32_16x16x32_bf16 v[60:63], v[68:71], v[84:87], v[60:63]
    s_waitcnt lgkmcnt(0)
    s_waitcnt vmcnt(4)
    s_barrier
    v_mfma_f32_16x16x32_bf16 v[32:35], v[88:91], v[96:99], v[32:35]
    v_mfma_f32_16x16x32_bf16 v[48:51], v[92:95], v[96:99], v[48:51]
    ds_read_b64_tr_b16 v[64:65], v5 offset:0
    ds_read_b64_tr_b16 v[66:67], v5 offset:1024
    ds_read_b128 v[72:75], v7 offset:16384
    v_mfma_f32_16x16x32_bf16 v[36:39], v[88:91], v[100:103], v[36:39]
    v_mfma_f32_16x16x32_bf16 v[52:55], v[92:95], v[100:103], v[52:55]
    ds_read_b128 v[76:79], v7 offset:18432
    ds_read_b64_tr_b16 v[68:69], v6 offset:0
    ds_read_b64_tr_b16 v[70:71], v6 offset:1024
    v_mfma_f32_16x16x32_bf16 v[40:43], v[88:91], v[104:107], v[40:43]
    v_mfma_f32_16x16x32_bf16 v[56:59], v[92:95], v[104:107], v[56:59]
    ds_read_b128 v[80:83], v7 offset:20480
    ds_read_b128 v[84:87], v7 offset:22528
    s_add_u32 m0, s66, 24576
    s_nop 0
    buffer_load_dwordx4 v4, s[48:51], s64 offen lds
    s_add_u32 s64, s64, 122880
    s_cmp_eq_u32 s64, 2457600
    s_cselect_b32 s64, 0, s64
    s_add_u32 m0, s65, 0
    s_nop 0
    buffer_load_dwordx4 v2, s[44:47], s43 offen lds
    s_add_u32 m0, s65, 1024
    s_nop 0
    buffer_load_dwordx4 v3, s[44:47], s43 offen lds
    s_add_u32 s43, s43, 128
    s_cmp_eq_u32 s43, 1280
    s_cselect_b32 s43, 0, s43
    v_mfma_f32_16x16x32_bf16 v[44:47], v[88:91], v[108:111], v[44:47]
    v_mfma_f32_16x16x32_bf16 v[60:63], v[92:95], v[108:111], v[60:63]
    s_waitcnt lgkmcnt(0)
    s_waitcnt vmcnt(6)
    s_barrier
    v_mfma_f32_16x16x32_bf16 v[32:35], v[64:67], v[72:75], v[32:35]
    v_mfma_f32_16x16x32_bf16 v[48:51], v[68:71], v[72:75], v[48:51]
    ds_read_b64_tr_b16 v[88:89], v5 offset:8192
    ds_read_b64_tr_b16 v[90:91], v5 offset:9216
    ds_read_b128 v[96:99], v8 offset:16384
    v_mfma_f32_16x16x32_bf16 v[36:39], v[64:67], v[76:79], v[36:39]
    v_mfma_f32_16x16x32_bf16 v[52:55], v[68:71], v[76:79], v[52:55]
    ds_read_b128 v[100:103], v8 offset:18432
    ds_read_b64_tr_b16 v[92:93], v6 offset:8192
    ds_read_b64_tr_b16 v[94:95], v6 offset:9216
    v_mfma_f32_16x16x32_bf16 v[40:43], v[64:67], v[80:83], v[40:43]
    v_mfma_f32_16x16x32_bf16 v[56:59], v[68:71], v[80:83], v[56:59]
    ds_read_b128 v[104:107], v8 offset:20480
    ds_read_b128 v[108:111], v8 offset:22528
    s_add_u32 m0, s66, 0
    s_nop 0
    buffer_load_dwordx4 v4, s[48:51], s64 offen lds
    s_add_u32 s64, s64, 122880
    s_cmp_eq_u32 s64, 2457600
    s_cselect_b32 s64, 0, s64
    v_mfma_f32_16x16x32_bf16 v[44:47], v[64:67], v[84:87], v[44:47]
    v_mfma_f32_16x16x32_bf16 v[60:63], v[68:71], v[84:87], v[60:63]
    s_waitcnt lgkmcnt(0)
    s_waitcnt vmcnt(4)
    s_barrier
    v_mfma_f32_16x16x32_bf16 v[32:35], v[88:91], v[96:99], v[32:35]
    v_mfma_f32_16x16x32_bf16 v[48:51], v[92:95], v[96:99], v[48:51]
    ds_read_b64_tr_b16 v[64:65], v5 offset:16384
    ds_read_b64_tr_b16 v[66:67], v5 offset:17408
    ds_read_b128 v[72:75], v7 offset:32768
    v_mfma_f32_16x16x32_bf16 v[36:39], v[88:91], v[100:103], v[36:39]
    v_mfma_f32_16x16x32_bf16 v[52:55], v[92:95], v[100:103], v[52:55]
    ds_read_b128 v[76:79], v7 offset:34816
    ds_read_b64_tr_b16 v[68:69], v6 offset:16384
    ds_read_b64_tr_b16 v[70:71], v6 offset:17408
    v_mfma_f32_16x16x32_bf16 v[40:43], v[88:91], v[104:107], v[40:43]
    v_mfma_f32_16x16x32_bf16 v[56:59], v[92:95], v[104:107], v[56:59]
    ds_read_b128 v[80:83], v7 offset:36864
    ds_read_b128 v[84:87], v7 offset:38912
    s_add_u32 m0, s66, 8192
    s_nop 0
    buffer_load_dwordx4 v4, s[48:51], s64 offen lds
    s_add_u32 s64, s64, 122880
    s_cmp_eq_u32 s64, 2457600
    s_cselect_b32 s64, 0, s64
    s_add_u32 m0, s65, 16384
    s_nop 0
    buffer_load_dwordx4 v2, s[44:47], s43 offen lds
    s_add_u32 m0, s65, 17408
    s_nop 0
    buffer_load_dwordx4 v3, s[44:47], s43 offen lds
    s_add_u32 s43, s43, 128
    s_cmp_eq_u32 s43, 1280
    s_cselect_b32 s43, 0, s43
    v_mfma_f32_16x16x32_bf16 v[44:47], v[88:91], v[108:111], v[44:47]
    v_mfma_f32_16x16x32_bf16 v[60:63], v[92:95], v[108:111], v[60:63]
    s_waitcnt lgkmcnt(0)
    s_waitcnt vmcnt(6)
    s_barrier
    v_mfma_f32_16x16x32_bf16 v[32:35], v[64:67], v[72:75], v[32:35]
    v_mfma_f32_16x16x32_bf16 v[48:51], v[68:71], v[72:75], v[48:51]
    ds_read_b64_tr_b16 v[88:89], v5 offset:24576
    ds_read_b64_tr_b16 v[90:91], v5 offset:25600
    ds_read_b128 v[96:99], v8 offset:32768
    v_mfma_f32_16x16x32_bf16 v[36:39], v[64:67], v[76:79], v[36:39]
    v_mfma_f32_16x16x32_bf16 v[52:55], v[68:71], v[76:79], v[52:55]
    ds_read_b128 v[100:103], v8 offset:34816
    ds_read_b64_tr_b16 v[92:93], v6 offset:24576
    ds_read_b64_tr_b16 v[94:95], v6 offset:25600
    v_mfma_f32_16x16x32_bf16 v[40:43], v[64:67], v[80:83], v[40:43]
    v_mfma_f32_16x16x32_bf16 v[56:59], v[68:71], v[80:83], v[56:59]
    ds_read_b128 v[104:107], v8 offset:36864
    ds_read_b128 v[108:111], v8 offset:38912
    s_add_u32 m0, s66, 16384
    s_nop 0
    buffer_load_dwordx4 v4, s[48:51], s64 offen lds
    s_add_u32 s64, s64, 122880
    s_cmp_eq_u32 s64, 2457600
    s_cselect_b32 s64, 0, s64
    v_mfma_f32_16x16x32_bf16 v[44:47], v[64:67], v[84:87], v[44:47]
    v_mfma_f32_16x16x32_bf16 v[60:63], v[68:71], v[84:87], v[60:63]
    s_waitcnt lgkmcnt(0)
    s_waitcnt vmcnt(4)
    s_barrier
    v_mfma_f32_16x16x32_bf16 v[32:35], v[88:91], v[96:99], v[32:35]
    v_mfma_f32_16x16x32_bf16 v[48:51], v[92:95], v[96:99], v[48:51]
    ds_read_b64_tr_b16 v[64:65], v5 offset:0
    ds_read_b64_tr_b16 v[66:67], v5 offset:1024
    ds_read_b128 v[72:75], v7 offset:0
    v_mfma_f32_16x16x32_bf16 v[36:39], v[88:91], v[100:103], v[36:39]
    v_mfma_f32_16x16x32_bf16 v[52:55], v[92:95], v[100:103], v[52:55]
    ds_read_b128 v[76:79], v7 offset:2048
    ds_read_b64_tr_b16 v[68:69], v6 offset:0
    ds_read_b64_tr_b16 v[70:71], v6 offset:1024
    v_mfma_f32_16x16x32_bf16 v[40:43], v[88:91], v[104:107], v[40:43]
    v_mfma_f32_16x16x32_bf16 v[56:59], v[92:95], v[104:107], v[56:59]
    ds_read_b128 v[80:83], v7 offset:4096
    ds_read_b128 v[84:87], v7 offset:6144
    s_add_u32 m0, s66, 24576
    s_nop 0
    buffer_load_dwordx4 v4, s[48:51], s64 offen lds
    s_add_u32 s64, s64, 122880
    s_cmp_eq_u32 s64, 2457600
    s_cselect_b32 s64, 0, s64
    s_add_u32 m0, s65, 32768
    s_nop 0
    buffer_load_dwordx4 v2, s[44:47], s43 offen lds
    s_add_u32 m0, s65, 33792
    s_nop 0
    buffer_load_dwordx4 v3, s[44:47], s43 offen lds
    s_add_u32 s43, s43, 128
    s_cmp_eq_u32 s43, 1280
    s_cselect_b32 s43, 0, s43
    v_mfma_f32_16x16x32_bf16 v[44:47], v[88:91], v[108:111], v[44:47]
    v_mfma_f32_16x16x32_bf16 v[60:63], v[92:95], v[108:111], v[60:63]
    s_waitcnt lgkmcnt(0)
    s_waitcnt vmcnt(6)
    s_barrier
    v_mfma_f32_16x16x32_bf16 v[32:35], v[64:67], v[72:75], v[32:35]
    v_mfma_f32_16x16x32_bf16 v[48:51], v[68:71], v[72:75], v[48:51]
    ds_read_b64_tr_b16 v[88:89], v5 offset:8192
    ds_read_b64_tr_b16 v[90:91], v5 offset:9216
    ds_read_b128 v[96:99], v8 offset:0
    v_mfma_f32_16x16x32_bf16 v[36:39], v[64:67], v[76:79], v[36:39]
    v_mfma_f32_16x16x32_bf16 v[52:55], v[68:71], v[76:79], v[52:55]
    ds_read_b128 v[100:103], v8 offset:2048
    ds_read_b64_tr_b16 v[92:93], v6 offset:8192
    ds_read_b64_tr_b16 v[94:95], v6 offset:9216
    v_mfma_f32_16x16x32_bf16 v[40:43], v[64:67], v[80:83], v[40:43]
    v_mfma_f32_16x16x32_bf16 v[56:59], v[68:71], v[80:83], v[56:59]
    ds_read_b128 v[104:107], v8 offset:4096
    ds_read_b128 v[108:111], v8 offset:6144
    s_add_u32 m0, s66, 0
    s_nop 0
    buffer_load_dwordx4 v4, s[48:51], s64 offen lds
    s_add_u32 s64, s64, 122880
    s_cmp_eq_u32 s64, 2457600
    s_cselect_b32 s64, 0, s64
    v_mfma_f32_16x16x32_bf16 v[44:47], v[64:67], v[84:87], v[44:47]
    v_mfma_f32_16x16x32_bf16 v[60:63], v[68:71], v[84:87], v[60:63]
    s_waitcnt lgkmcnt(0)
    s_waitcnt vmcnt(4)
    s_barrier
    v_mfma_f32_16x16x32_bf16 v[32:35], v[88:91], v[96:99], v[32:35]
    v_mfma_f32_16x16x32_bf16 v[48:51], v[92:95], v[96:99], v[48:51]
    ds_read_b64_tr_b16 v[64:65], v5 offset:16384
    ds_read_b64_tr_b16 v[66:67], v5 offset:17408
    ds_read_b128 v[72:75], v7 offset:16384
    v_mfma_f32_16x16x32_bf16 v[36:39], v[88:91], v[100:103], v[36:39]
    v_mfma_f32_16x16x32_bf16 v[52:55], v[92:95], v[100:103], v[52:55]
    ds_read_b128 v[76:79], v7 offset:18432
    ds_read_b64_tr_b16 v[68:69], v6 offset:16384
    ds_read_b64_tr_b16 v[70:71], v6 offset:17408
    v_mfma_f32_16x16x32_bf16 v[40:43], v[88:91], v[104:107], v[40:43]
    v_mfma_f32_16x16x32_bf16 v[56:59], v[92:95], v[104:107], v[56:59]
    ds_read_b128 v[80:83], v7 offset:20480
    ds_read_b128 v[84:87], v7 offset:22528
    s_add_u32 m0, s66, 8192
    s_nop 0
    buffer_load_dwordx4 v4, s[48:51], s64 offen lds
    s_add_u32 s64, s64, 122880
    s_cmp_eq_u32 s64, 2457600
    s_cselect_b32 s64, 0, s64
    s_add_u32 m0, s65, 0
    s_nop 0
    buffer_load_dwordx4 v2, s[44:47], s43 offen lds
    s_add_u32 m0, s65, 1024
    s_nop 0
    buffer_load_dwordx4 v3, s[44:47], s43 offen lds
    s_add_u32 s43, s43, 128
    s_cmp_eq_u32 s43, 1280
    s_cselect_b32 s43, 0, s43
    v_mfma_f32_16x16x32_bf16 v[44:47], v[88:91], v[108:111], v[44:47]
    v_mfma_f32_16x16x32_bf16 v[60:63], v[92:95], v[108:111], v[60:63]
    s_waitcnt lgkmcnt(0)
    s_waitcnt vmcnt(6)
    s_barrier
    v_mfma_f32_16x16x32_bf16 v[32:35], v[64:67], v[72:75], v[32:35]
    v_mfma_f32_16x16x32_bf16 v[48:51], v[68:71], v[72:75], v[48:51]
    ds_read_b64_tr_b16 v[88:89], v5 offset:24576
    ds_read_b64_tr_b16 v[90:91], v5 offset:25600
    ds_read_b128 v[96:99], v8 offset:16384
    v_mfma_f32_16x16x32_bf16 v[36:39], v[64:67], v[76:79], v[36:39]
    v_mfma_f32_16x16x32_bf16 v[52:55], v[68:71], v[76:79], v[52:55]
    ds_read_b128 v[100:103], v8 offset:18432
    ds_read_b64_tr_b16 v[92:93], v6 offset:24576
    ds_read_b64_tr_b16 v[94:95], v6 offset:25600
    v_mfma_f32_16x16x32_bf16 v[40:43], v[64:67], v[80:83], v[40:43]
    v_mfma_f32_16x16x32_bf16 v[56:59], v[68:71], v[80:83], v[56:59]
    ds_read_b128 v[104:107], v8 offset:20480
    ds_read_b128 v[108:111], v8 offset:22528
    s_add_u32 m0, s66, 16384
    s_nop 0
    buffer_load_dwordx4 v4, s[48:51], s64 offen lds
    s_add_u32 s64, s64, 122880
    s_cmp_eq_u32 s64, 2457600
    s_cselect_b32 s64, 0, s64
    v_mfma_f32_16x16x32_bf16 v[44:47], v[64:67], v[84:87], v[44:47]
    v_mfma_f32_16x16x32_bf16 v[60:63], v[68:71], v[84:87], v[60:63]
    s_waitcnt lgkmcnt(0)
    s_waitcnt vmcnt(4)
    s_barrier
    v_mfma_f32_16x16x32_bf16 v[32:35], v[88:91], v[96:99], v[32:35]
    v_mfma_f32_16x16x32_bf16 v[48:51], v[92:95], v[96:99], v[48:51]
    ds_read_b64_tr_b16 v[64:65], v5 offset:0
    ds_read_b64_tr_b16 v[66:67], v5 offset:1024
    ds_read_b128 v[72:75], v7 offset:32768
    v_mfma_f32_16x16x32_bf16 v[36:39], v[88:91], v[100:103], v[36:39]
    v_mfma_f32_16x16x32_bf16 v[52:55], v[92:95], v[100:103], v[52:55]
    ds_read_b128 v[76:79], v7 offset:34816
    ds_read_b64_tr_b16 v[68:69], v6 offset:0
    ds_read_b64_tr_b16 v[70:71], v6 offset:1024
    v_mfma_f32_16x16x32_bf16 v[40:43], v[88:91], v[104:107], v[40:43]
    v_mfma_f32_16x16x32_bf16 v[56:59], v[92:95], v[104:107], v[56:59]
    ds_read_b128 v[80:83], v7 offset:36864
    ds_read_b128 v[84:87], v7 offset:38912
    s_add_u32 m0, s66, 24576
    s_nop 0
    buffer_load_dwordx4 v4, s[48:51], s64 offen lds
    s_add_u32 s64, s64, 122880
    s_cmp_eq_u32 s64, 2457600
    s_cselect_b32 s64, 0, s64
    s_and_b32 s34, s40, 3
    s_lshl_b32 s34, s34, 3
    v_add_u32 v10, s34, v10
    v_mul_u32_u24 v10, 16384, v10
    v_and_b32 v11, 15, v1
    v_lshl_add_u32 v10, v11, 4, v10
    s_lshr_b32 s34, s40, 2
    s_lshl_b32 s34, s34, 9
    v_add_u32 v10, s34, v10
    v_mfma_f32_16x16x32_bf16 v[44:47], v[88:91], v[108:111], v[44:47]
    v_mfma_f32_16x16x32_bf16 v[60:63], v[92:95], v[108:111], v[60:63]
    s_waitcnt lgkmcnt(0)
    s_waitcnt vmcnt(4)
    s_barrier
    v_mfma_f32_16x16x32_bf16 v[32:35], v[64:67], v[72:75], v[32:35]
    v_mfma_f32_16x16x32_bf16 v[48:51], v[68:71], v[72:75], v[48:51]
    ds_read_b64_tr_b16 v[88:89], v5 offset:8192
    ds_read_b64_tr_b16 v[90:91], v5 offset:9216
    ds_read_b128 v[96:99], v8 offset:32768
    v_mfma_f32_16x16x32_bf16 v[36:39], v[64:67], v[76:79], v[36:39]
    v_mfma_f32_16x16x32_bf16 v[52:55], v[68:71], v[76:79], v[52:55]
    ds_read_b128 v[100:103], v8 offset:34816
    ds_read_b64_tr_b16 v[92:93], v6 offset:8192
    ds_read_b64_tr_b16 v[94:95], v6 offset:9216
    v_mfma_f32_16x16x32_bf16 v[40:43], v[64:67], v[80:83], v[40:43]
    v_mfma_f32_16x16x32_bf16 v[56:59], v[68:71], v[80:83], v[56:59]
    ds_read_b128 v[104:107], v8 offset:36864
    ds_read_b128 v[108:111], v8 offset:38912
    s_cmp_lt_u32 s42, 5
    s_cselect_b32 s12, 1051011932, 1.0
    s_mov_b32 s13, s12
    s_lshl_b32 s10, s42, 7
    s_lshl_b32 s34, s41, 3
    s_add_u32 s10, s10, s34
    s_add_u32 s10, s10, 4096
    s_mul_i32 s8, s42, 524288
    s_lshl_b32 s34, s41, 10
    s_add_u32 s8, s8, s34
    s_add_u32 s8, s8, 1048576
    s_add_u32 s9, s8, 65536
    s_cmp_ge_u32 s42, 10
    s_cselect_b32 s38, 10, 5
    s_cselect_b32 s35, 8, 0
    s_sub_u32 s34, s42, s38
    s_add_u32 s35, s35, s41
    s_cmp_lt_u32 s41, 4
    s_cselect_b32 s37, 1, 0
    v_mfma_f32_16x16x32_bf16 v[44:47], v[64:67], v[84:87], v[44:47]
    v_mfma_f32_16x16x32_bf16 v[60:63], v[68:71], v[84:87], v[60:63]
    s_waitcnt lgkmcnt(0)
    s_waitcnt vmcnt(1)
    s_barrier
    v_mfma_f32_16x16x32_bf16 v[32:35], v[88:91], v[96:99], v[32:35]
    v_mfma_f32_16x16x32_bf16 v[48:51], v[92:95], v[96:99], v[48:51]
    ds_read_b64_tr_b16 v[64:65], v5 offset:16384
    ds_read_b64_tr_b16 v[66:67], v5 offset:17408
    ds_read_b128 v[72:75], v7 offset:0
    v_mfma_f32_16x16x32_bf16 v[36:39], v[88:91], v[100:103], v[36:39]
    v_mfma_f32_16x16x32_bf16 v[52:55], v[92:95], v[100:103], v[52:55]
    ds_read_b128 v[76:79], v7 offset:2048
    ds_read_b64_tr_b16 v[68:69], v6 offset:16384
    ds_read_b64_tr_b16 v[70:71], v6 offset:17408
    v_mfma_f32_16x16x32_bf16 v[40:43], v[88:91], v[104:107], v[40:43]
    v_mfma_f32_16x16x32_bf16 v[56:59], v[92:95], v[104:107], v[56:59]
    ds_read_b128 v[80:83], v7 offset:4096
    ds_read_b128 v[84:87], v7 offset:6144
    s_and_b32 s38, s41, 1
    s_add_u32 s38, s38, 16
    s_cmp_lt_u32 s42, 5
    s_cselect_b32 s34, s42, s34
    s_cselect_b32 s35, s38, s35
    s_cselect_b32 s36, 2, 4
    s_cselect_b32 s37, 2, s37
    s_mul_i32 s38, s34, 209728
    s_lshr_b32 s38, s38, 15
    v_lshrrev_b32 v11, 3, v1
    v_add_u32 v11, s38, v11
    v_mul_u32_u24 v12, 5, v11
    v_lshrrev_b32 v13, 5, v12
    s_lshr_b32 s39, s41, 1
    v_mfma_f32_16x16x32_bf16 v[44:47], v[88:91], v[108:111], v[44:47]
    v_mfma_f32_16x16x32_bf16 v[60:63], v[92:95], v[108:111], v[60:63]
    s_waitcnt lgkmcnt(0)
    s_waitcnt vmcnt(0)
    s_barrier
    v_mfma_f32_16x16x32_bf16 v[32:35], v[64:67], v[72:75], v[32:35]
    v_mfma_f32_16x16x32_bf16 v[48:51], v[68:71], v[72:75], v[48:51]
    ds_read_b64_tr_b16 v[88:89], v5 offset:24576
    ds_read_b64_tr_b16 v[90:91], v5 offset:25600
    ds_read_b128 v[96:99], v8 offset:0
    v_mfma_f32_16x16x32_bf16 v[36:39], v[64:67], v[76:79], v[36:39]
    v_mfma_f32_16x16x32_bf16 v[52:55], v[68:71], v[76:79], v[52:55]
    ds_read_b128 v[100:103], v8 offset:2048
    ds_read_b64_tr_b16 v[92:93], v6 offset:24576
    ds_read_b64_tr_b16 v[94:95], v6 offset:25600
    v_mfma_f32_16x16x32_bf16 v[40:43], v[64:67], v[80:83], v[40:43]
    v_mfma_f32_16x16x32_bf16 v[56:59], v[68:71], v[80:83], v[56:59]
    ds_read_b128 v[104:107], v8 offset:4096
    ds_read_b128 v[108:111], v8 offset:6144
    v_cmp_ge_u32 s[68:69], s34, v13
    v_cmp_ne_u32 vcc, s34, v13
    v_and_b32 v13, 7, v1
    v_lshl_add_u32 v11, v11, 3, v13
    v_cndmask_b32 v12, 0, 1, vcc
    v_mul_u32_u24 v12, s36, v12
    v_add_u32 v12, s35, v12
    v_cmp_eq_u32 vcc, s39, v13
    s_cmp_eq_u32 s37, 2
    s_cselect_b64 vcc, vcc, -1
    s_and_b64 s[68:69], s[68:69], vcc
    s_cmp_eq_u32 s37, 0
    s_cselect_b64 s[68:69], 0, s[68:69]
    v_lshlrev_b32 v11, 8, v11
    v_lshl_add_u32 v11, v12, 3, v11
    v_add_u32 v11, 655360, v11
    v_mov_b32 v120, 2147483648
    v_cndmask_b32 v120, v120, v11, s[68:69]
    v_mfma_f32_16x16x32_bf16 v[44:47], v[64:67], v[84:87], v[44:47]
    v_mfma_f32_16x16x32_bf16 v[60:63], v[68:71], v[84:87], v[60:63]
    s_waitcnt lgkmcnt(0)
    v_mfma_f32_16x16x32_bf16 v[32:35], v[88:91], v[96:99], v[32:35]
    v_mfma_f32_16x16x32_bf16 v[48:51], v[92:95], v[96:99], v[48:51]
    v_mfma_f32_16x16x32_bf16 v[36:39], v[88:91], v[100:103], v[36:39]
    v_mfma_f32_16x16x32_bf16 v[52:55], v[92:95], v[100:103], v[52:55]
    v_mfma_f32_16x16x32_bf16 v[40:43], v[88:91], v[104:107], v[40:43]
    v_mfma_f32_16x16x32_bf16 v[56:59], v[92:95], v[104:107], v[56:59]
    v_mfma_f32_16x16x32_bf16 v[44:47], v[88:91], v[108:111], v[44:47]
    v_mfma_f32_16x16x32_bf16 v[60:63], v[92:95], v[108:111], v[60:63]
    s_nop 2
    v_pk_mul_f32 v[32:33], v[32:33], s[12:13]
    v_pk_mul_f32 v[34:35], v[34:35], s[12:13]
    v_cvt_pk_bf16_f32 v64, v32, v33
    v_cvt_pk_bf16_f32 v65, v34, v35
    v_pk_mul_f32 v[36:37], v[36:37], s[12:13]
    v_pk_mul_f32 v[38:39], v[38:39], s[12:13]
    v_cvt_pk_bf16_f32 v66, v36, v37
    v_cvt_pk_bf16_f32 v67, v38, v39
    buffer_store_dwordx4 v[64:67], v10, s[56:59], s8 offen offset:0 sc1
    v_pk_mul_f32 v[48:49], v[48:49], s[12:13]
    v_pk_mul_f32 v[50:51], v[50:51], s[12:13]
    v_cvt_pk_bf16_f32 v68, v48, v49
    v_cvt_pk_bf16_f32 v69, v50, v51
    v_pk_mul_f32 v[52:53], v[52:53], s[12:13]
    v_pk_mul_f32 v[54:55], v[54:55], s[12:13]
    v_cvt_pk_bf16_f32 v70, v52, v53
    v_cvt_pk_bf16_f32 v71, v54, v55
    buffer_store_dwordx4 v[68:71], v10, s[56:59], s9 offen offset:0 sc1
    v_pk_mul_f32 v[40:41], v[40:41], s[12:13]
    v_pk_mul_f32 v[42:43], v[42:43], s[12:13]
    v_cvt_pk_bf16_f32 v72, v40, v41
    v_cvt_pk_bf16_f32 v73, v42, v43
    v_pk_mul_f32 v[44:45], v[44:45], s[12:13]
    v_pk_mul_f32 v[46:47], v[46:47], s[12:13]
    v_cvt_pk_bf16_f32 v74, v44, v45
    v_cvt_pk_bf16_f32 v75, v46, v47
    buffer_store_dwordx4 v[72:75], v10, s[56:59], s8 offen offset:256 sc1
    v_pk_mul_f32 v[56:57], v[56:57], s[12:13]
    v_pk_mul_f32 v[58:59], v[58:59], s[12:13]
    v_cvt_pk_bf16_f32 v76, v56, v57
    v_cvt_pk_bf16_f32 v77, v58, v59
    v_pk_mul_f32 v[60:61], v[60:61], s[12:13]
    v_pk_mul_f32 v[62:63], v[62:63], s[12:13]
    v_cvt_pk_bf16_f32 v78, v60, v61
    v_cvt_pk_bf16_f32 v79, v62, v63
    buffer_store_dwordx4 v[76:79], v10, s[56:59], s9 offen offset:256 sc1
L_PUB:
    v_mov_b32 v4, 16256
    v_mov_b32 v5, 0
    v_mov_b32 v6, 16256
    v_mov_b32 v7, 0
    v_mov_b32 v2, s6
    v_mov_b32 v3, s7
    v_mov_b32 v8, 81912
    v_mov_b32 v9, 0
    s_waitcnt vmcnt(0)
    s_barrier
    s_lshl_b32 s3, s2, 7
    s_add_u32 s3, s3, 98304
    s_cmp_lg_u32 s40, 7
    s_cbranch_scc1 FS_1
    v_mov_b32 v10, s6
    v_mov_b32 v11, s7
    s_mov_b64 exec, 1
    buffer_store_dwordx2 v[10:11], off, s[56:59], s3 sc1
    s_mov_b64 exec, -1
FS_1:
    s_cmp_lg_u32 s40, 0
    s_cbranch_scc1 L_NOPUSH
    buffer_store_dwordx2 v[2:3], v120, s[56:59], 0 offen sc1
    s_mov_b64 exec, 1
    buffer_store_dwordx2 v[2:3], off, s[56:59], s10 sc1
    s_mov_b64 exec, -1
L_NOPUSH:
    s_and_b32 s34, s2, 7
    s_bfe_u32 s15, s2, 0x30003
    s_bfe_u32 s35, s2, 0x20006
    s_lshl_b32 s14, s34, 2
    s_add_u32 s14, s14, s35
    s_mul_i32 s36, s14, 5
    s_add_u32 s37, s36, 4
    s_lshr_b32 s38, s36, 5
    s_lshr_b32 s37, s37, 5
    s_sub_u32 s37, s37, s38
    s_lshl_b32 s25, s14, 3
    s_add_u32 s25, s25, s15
    s_lshl_b32 s25, s25, 8
    s_add_u32 s25, s25, 655360
    s_mov_b32 s26, 0xf0f0c
    s_cmp_eq_u32 s37, 0
    s_cselect_b32 s26, s26, 0xfffff
    s_mov_b32 s29, 0
    s_min_u32 s30, s40, 1
    v_bfe_u32 v11, v1, 4, 1
    v_mul_u32_u24 v11, s37, v11
    v_add_u32 v11, s38, v11
    v_lshrrev_b32 v14, 5, v1
    v_mul_u32_u24 v12, 15, v14
    v_max_u32 v12, v11, v12
    v_mul_u32_u24 v13, 5, v14
    v_add3_u32 v11, v11, v13, 5
    v_and_b32 v13, 15, v1
    v_lshlrev_b32 v15, 3, v13
    v_add_u32 v15, 4096, v15
    v_lshl_add_u32 v121, v11, 7, v15
    v_lshl_add_u32 v122, v12, 7, v15
    v_lshlrev_b32 v123, 4, v1
    s_lshl_b32 s27, s2, 7
    s_add_u32 s28, s27, 65536
    s_add_u32 s27, s27, 32768
    s_add_u32 s34, s40, 0
    s_lshr_b32 s35, s34, 1
    s_and_b32 s34, s34, 1
    s_lshl_b32 s34, s34, 10
    s_mul_i32 s19, s35, 2080
    s_add_u32 s19, s19, s34
    s_cmp_ge_u32 s35, 5
    s_cselect_b32 s39, 155, 0
    s_add_u32 s35, s35, s39
    s_add_u32 s35, s35, s36
    s_mul_i32 s35, s35, 16384
    s_add_u32 s35, s35, s34
    s_add_u32 s16, s35, 3670016
    s_add_u32 s34, s40, 8
    s_lshr_b32 s35, s34, 1
    s_and_b32 s34, s34, 1
    s_lshl_b32 s34, s34, 10
    s_mul_i32 s20, s35, 2080
    s_add_u32 s20, s20, s34
    s_cmp_ge_u32 s35, 5
    s_cselect_b32 s39, 155, 0
    s_add_u32 s35, s35, s39
    s_add_u32 s35, s35, s36
    s_mul_i32 s35, s35, 16384
    s_add_u32 s35, s35, s34
    s_add_u32 s17, s35, 3670016
    s_add_u32 s34, s40, 16
    s_lshr_b32 s35, s34, 1
    s_and_b32 s34, s34, 1
    s_lshl_b32 s34, s34, 10
    s_mul_i32 s21, s35, 2080
    s_add_u32 s21, s21, s34
    s_cmp_ge_u32 s35, 5
    s_cselect_b32 s39, 155, 0
    s_add_u32 s35, s35, s39
    s_add_u32 s35, s35, s36
    s_mul_i32 s35, s35, 16384
    s_add_u32 s35, s35, s34
    s_add_u32 s18, s35, 3670016
    s_lshr_b32 s34, s40, 1
    s_min_u32 s34, s34, 2
    s_mul_i32 s34, s34, 22880
    s_and_b32 s35, s40, 1
    s_lshl_b32 s35, s35, 10
    s_add_u32 s34, s34, s35
    s_add_u32 s34, s34, 20800
    v_add_u32 v116, s34, v123
    s_and_b32 s34, s40, 3
    s_lshl_b32 s34, s34, 6
    s_lshr_b32 s35, s40, 2
    s_lshl_b32 s39, s35, 5
    s_add_u32 s34, s34, s39
    s_lshl_b32 s35, s35, 7
    v_lshl_add_u32 v15, v13, 1, s34
    v_lshlrev_b32 v124, 3, v15
    v_bfe_u32 v12, v1, 4, 1
    v_lshl_add_u32 v15, v12, 3, v124
    v_xor_b32 v16, 256, v15
    v_mul_u32_u24 v17, 32768, v14
    v_add_u32 v112, v17, v15
    v_add_u32 v114, v17, v16
    v_lshlrev_b32 v17, 31, v14
    v_or_b32 v113, v17, v15
    v_or_b32 v115, v17, v16
    v_and_b32 v15, 31, v1
    v_add_u32 v15, s35, v15
    v_lshlrev_b32 v15, 3, v15
    v_mul_u32_u24 v16, 4160, v14
    v_add_u32 v125, v16, v15
    v_mul_u32_u24 v16, 12480, v14
    v_add_u32 v16, 8320, v16
    v_add_u32 v126, v16, v15
    v_and_b32 v16, 3, v1
    v_lshl_add_u32 v16, v12, 2, v16
    v_min_u32 v16, 5, v16
    v_add_u32 v16, 5, v16
    v_mul_u32_u24 v16, 2080, v16
    v_bfe_u32 v17, v1, 2, 2
    v_lshl_add_u32 v17, v14, 2, v17
    v_add_u32 v17, s35, v17
    v_lshl_add_u32 v127, v17, 3, v16
    s_mul_i32 s34, s36, 16384
    s_lshl_b32 s35, s15, 11
    s_add_u32 s34, s34, s35
    s_add_u32 s22, s34, 1048576
    s_add_u32 s23, s22, 16384
    s_add_u32 s24, s22, 65536
    s_add_u32 s31, s34, 10485760
    s_add_u32 s32, s31, 65536
    s_lshl_b32 s33, s15, 13
    s_lshl_b32 s35, s14, 3
    s_add_u32 s33, s33, s35
    s_add_u32 s33, s33, 720896
    ds_write_b128 v116, v[4:7]
    ds_write_b32 v8, v9
    ds_write_b32 v8, v9 offset:4
    s_waitcnt lgkmcnt(0)
    s_cmp_lg_u32 s40, 1
    s_cbranch_scc1 L_NOPOLL
    s_mov_b32 s64, 400000
SP_2:
    s_load_dwordx16 s[68:83], s[56:57], s25 offset:0 glc
    s_load_dwordx16 s[84:99], s[56:57], s25 offset:64 glc
    s_load_dwordx8 s[44:51], s[56:57], s25 offset:128 glc
    s_mov_b32 s65, 0
    s_waitcnt lgkmcnt(0)
    s_cmp_eq_u64 s[68:69], s[6:7]
    s_addc_u32 s65, s65, s65
    s_cmp_eq_u64 s[70:71], s[6:7]
    s_addc_u32 s65, s65, s65
    s_cmp_eq_u64 s[72:73], s[6:7]
    s_addc_u32 s65, s65, s65
    s_cmp_eq_u64 s[74:75], s[6:7]
    s_addc_u32 s65, s65, s65
    s_cmp_eq_u64 s[76:77], s[6:7]
    s_addc_u32 s65, s65, s65
    s_cmp_eq_u64 s[78:79], s[6:7]
    s_addc_u32 s65, s65, s65
    s_cmp_eq_u64 s[80:81], s[6:7]
    s_addc_u32 s65, s65, s65
    s_cmp_eq_u64 s[82:83], s[6:7]
    s_addc_u32 s65, s65, s65
    s_cmp_eq_u64 s[84:85], s[6:7]
    s_addc_u32 s65, s65, s65
    s_cmp_eq_u64 s[86:87], s[6:7]
    s_addc_u32 s65, s65, s65
    s_cmp_eq_u64 s[88:89], s[6:7]
    s_addc_u32 s65, s65, s65
    s_cmp_eq_u64 s[90:91], s[6:7]
    s_addc_u32 s65, s65, s65
    s_cmp_eq_u64 s[92:93], s[6:7]
    s_addc_u32 s65, s65, s65
    s_cmp_eq_u64 s[94:95], s[6:7]
    s_addc_u32 s65, s65, s65
    s_cmp_eq_u64 s[96:97], s[6:7]
    s_addc_u32 s65, s65, s65
    s_cmp_eq_u64 s[98:99], s[6:7]
    s_addc_u32 s65, s65, s65
    s_cmp_eq_u64 s[44:45], s[6:7]
    s_addc_u32 s65, s65, s65
    s_cmp_eq_u64 s[46:47], s[6:7]
    s_addc_u32 s65, s65, s65
    s_cmp_eq_u64 s[48:49], s[6:7]
    s_addc_u32 s65, s65, s65
    s_cmp_eq_u64 s[50:51], s[6:7]
    s_addc_u32 s65, s65, s65
    s_andn2_b32 s65, s26, s65
    s_cmp_eq_u32 s65, 0
    s_cbranch_scc1 SD_3
    s_sub_u32 s64, s64, 1
    s_cmp_lg_u32 s64, 0
    s_cbranch_scc1 SP_2
SD_3:
L_NOPOLL:
    s_barrier
    s_cmp_lt_u32 s40, 4
    s_cselect_b64 vcc, -1, 0
    s_add_u32 m0, s19, 0
    s_add_u32 s68, s16, 0
    buffer_load_dwordx4 v123, s[56:59], s68 offen sc1 lds
    s_add_u32 m0, s20, 0
    s_add_u32 s68, s17, 0
    buffer_load_dwordx4 v123, s[56:59], s68 offen sc1 lds
    s_cbranch_vccz D3_4
    s_add_u32 m0, s21, 0
    s_add_u32 s68, s18, 0
    buffer_load_dwordx4 v123, s[56:59], s68 offen sc1 lds
D3_4:
    buffer_load_dwordx2 v[8:9], v112, s[56:59], s22 offen sc1
    buffer_load_dwordx2 v[10:11], v112, s[56:59], s23 offen sc1
    buffer_load_dwordx2 v[12:13], v113, s[56:59], s24 offen sc1
    buffer_load_dwordx2 v[14:15], v114, s[56:59], s22 offen sc1
    buffer_load_dwordx2 v[16:17], v114, s[56:59], s23 offen sc1
    buffer_load_dwordx2 v[18:19], v115, s[56:59], s24 offen sc1
    s_cmp_lg_u32 s40, 7
    s_cbranch_scc1 FS_5
    v_mov_b32 v2, s6
    v_mov_b32 v3, s7
    s_mov_b64 exec, 1
    buffer_store_dwordx2 v[2:3], off, s[56:59], s27 sc1
    s_mov_b64 exec, -1
FS_5:
    s_branch L_ATT_GO
L_ATT_MAIN:
    s_cmp_lt_u32 s40, 4
    s_cselect_b64 vcc, -1, 0
    s_add_u32 m0, s19, 0
    s_add_u32 s68, s16, 0
    buffer_load_dwordx4 v123, s[56:59], s68 offen sc1 lds
    s_add_u32 m0, s20, 0
    s_add_u32 s68, s17, 0
    buffer_load_dwordx4 v123, s[56:59], s68 offen sc1 lds
    s_cbranch_vccz D3_6
    s_add_u32 m0, s21, 0
    s_add_u32 s68, s18, 0
    buffer_load_dwordx4 v123, s[56:59], s68 offen sc1 lds
D3_6:
L_ATT_GO:
    s_waitcnt vmcnt(0)
    s_barrier
    ds_read_b64 v[84:85], v125 offset:0
    ds_read_b64 v[86:87], v125 offset:2080
    ds_read_b64 v[88:89], v126 offset:0
    ds_read_b64_tr_b16 v[96:97], v127 offset:0
    ds_read_b64_tr_b16 v[98:99], v127 offset:64
    ds_read_b64_tr_b16 v[100:101], v127 offset:128
    ds_read_b64_tr_b16 v[102:103], v127 offset:192
    s_add_u32 m0, s19, 22880
    s_add_u32 s68, s16, 2048
    buffer_load_dwordx4 v123, s[56:59], s68 offen sc1 lds
    s_add_u32 m0, s20, 22880
    s_add_u32 s68, s17, 2048
    buffer_load_dwordx4 v123, s[56:59], s68 offen sc1 lds
    s_waitcnt lgkmcnt(4)
    v_mfma_f32_32x32x16_bf16 v[52:67], v[84:87], v[8:11], 0
    v_mfma_f32_32x32x8_bf16 v[52:67], v[88:89], v[12:13], v[52:67]
    s_cbranch_vccz D3_7
    s_add_u32 m0, s21, 22880
    s_add_u32 s68, s18, 2048
    buffer_load_dwordx4 v123, s[56:59], s68 offen sc1 lds
D3_7:
    s_nop 9
    v_mfma_f32_32x32x16_bf16 v[68:83], v[84:87], v[14:17], 0
    v_exp_f32 v52, v52
    v_exp_f32 v53, v53
    v_exp_f32 v54, v54
    v_exp_f32 v55, v55
    v_mfma_f32_32x32x8_bf16 v[68:83], v[88:89], v[18:19], v[68:83]
    v_cvt_pk_bf16_f32 v112, v52, v53
    v_cvt_pk_bf16_f32 v113, v54, v55
    v_exp_f32 v56, v56
    v_exp_f32 v57, v57
    v_exp_f32 v58, v58
    v_exp_f32 v59, v59
    ds_read_b64 v[90:91], v125 offset:256
    ds_read_b64 v[92:93], v125 offset:2336
    ds_read_b64 v[94:95], v126 offset:256
    s_setprio 3
    v_cvt_pk_bf16_f32 v114, v56, v57
    v_cvt_pk_bf16_f32 v115, v58, v59
    v_exp_f32 v60, v60
    v_exp_f32 v61, v61
    v_exp_f32 v62, v62
    v_exp_f32 v63, v63
    s_waitcnt lgkmcnt(3)
    v_mfma_f32_32x32x16_bf16 v[20:35], v[96:99], v[112:115], 0
    v_cvt_pk_bf16_f32 v116, v60, v61
    v_cvt_pk_bf16_f32 v117, v62, v63
    v_exp_f32 v64, v64
    v_exp_f32 v65, v65
    v_exp_f32 v66, v66
    v_exp_f32 v67, v67
    v_cvt_pk_bf16_f32 v118, v64, v65
    v_cvt_pk_bf16_f32 v119, v66, v67
    s_waitcnt lgkmcnt(0)
    v_mfma_f32_32x32x16_bf16 v[52:67], v[90:93], v[8:11], 0
    v_exp_f32 v68, v68
    v_exp_f32 v69, v69
    v_exp_f32 v70, v70
    v_exp_f32 v71, v71
    v_mfma_f32_32x32x8_bf16 v[52:67], v[94:95], v[12:13], v[52:67]
    v_cvt_pk_bf16_f32 v112, v68, v69
    v_cvt_pk_bf16_f32 v113, v70, v71
    v_exp_f32 v72, v72
    v_exp_f32 v73, v73
    v_exp_f32 v74, v74
    v_exp_f32 v75, v75
    v_mfma_f32_32x32x16_bf16 v[20:35], v[100:103], v[116:119], v[20:35]
    ds_read_b64_tr_b16 v[104:105], v127 offset:256
    ds_read_b64_tr_b16 v[106:107], v127 offset:320
    ds_read_b64_tr_b16 v[108:109], v127 offset:384
    ds_read_b64_tr_b16 v[110:111], v127 offset:448
    s_setprio 2
    v_cvt_pk_bf16_f32 v114, v72, v73
    v_cvt_pk_bf16_f32 v115, v74, v75
    v_exp_f32 v76, v76
    v_exp_f32 v77, v77
    v_exp_f32 v78, v78
    v_exp_f32 v79, v79
    v_mfma_f32_32x32x16_bf16 v[36:51], v[96:99], v[112:115], 0
    v_cvt_pk_bf16_f32 v116, v76, v77
    v_cvt_pk_bf16_f32 v117, v78, v79
    v_exp_f32 v80, v80
    v_exp_f32 v81, v81
    v_exp_f32 v82, v82
    v_exp_f32 v83, v83
    v_cvt_pk_bf16_f32 v118, v80, v81
    v_cvt_pk_bf16_f32 v119, v82, v83
    v_mfma_f32_32x32x16_bf16 v[68:83], v[90:93], v[14:17], 0
    v_exp_f32 v52, v52
    v_exp_f32 v53, v53
    v_exp_f32 v54, v54
    v_exp_f32 v55, v55
    v_mfma_f32_32x32x8_bf16 v[68:83], v[94:95], v[18:19], v[68:83]
    v_cvt_pk_bf16_f32 v112, v52, v53
    v_cvt_pk_bf16_f32 v113, v54, v55
    v_exp_f32 v56, v56
    v_exp_f32 v57, v57
    v_exp_f32 v58, v58
    v_exp_f32 v59, v59
    v_mfma_f32_32x32x16_bf16 v[36:51], v[100:103], v[116:119], v[36:51]
    ds_read_b64 v[84:85], v125 offset:512
    ds_read_b64 v[86:87], v125 offset:2592
    ds_read_b64 v[88:89], v126 offset:512
    v_cvt_pk_bf16_f32 v114, v56, v57
    v_cvt_pk_bf16_f32 v115, v58, v59
    v_exp_f32 v60, v60
    v_exp_f32 v61, v61
    v_exp_f32 v62, v62
    v_exp_f32 v63, v63
    s_waitcnt lgkmcnt(3)
    v_mfma_f32_32x32x16_bf16 v[20:35], v[104:107], v[112:115], v[20:35]
    v_cvt_pk_bf16_f32 v116, v60, v61
    v_cvt_pk_bf16_f32 v117, v62, v63
    v_exp_f32 v64, v64
    v_exp_f32 v65, v65
    v_exp_f32 v66, v66
    v_exp_f32 v67, v67
    v_cvt_pk_bf16_f32 v118, v64, v65
    v_cvt_pk_bf16_f32 v119, v66, v67
    s_waitcnt lgkmcnt(0)
    v_mfma_f32_32x32x16_bf16 v[52:67], v[84:87], v[8:11], 0
    v_exp_f32 v68, v68
    v_exp_f32 v69, v69
    v_exp_f32 v70, v70
    v_exp_f32 v71, v71
    v_mfma_f32_32x32x8_bf16 v[52:67], v[88:89], v[12:13], v[52:67]
    v_cvt_pk_bf16_f32 v112, v68, v69
    v_cvt_pk_bf16_f32 v113, v70, v71
    v_exp_f32 v72, v72
    v_exp_f32 v73, v73
    v_exp_f32 v74, v74
    v_exp_f32 v75, v75
    v_mfma_f32_32x32x16_bf16 v[20:35], v[108:111], v[116:119], v[20:35]
    ds_read_b64_tr_b16 v[96:97], v127 offset:512
    ds_read_b64_tr_b16 v[98:99], v127 offset:576
    ds_read_b64_tr_b16 v[100:101], v127 offset:640
    ds_read_b64_tr_b16 v[102:103], v127 offset:704
    s_setprio 1
    v_cvt_pk_bf16_f32 v114, v72, v73
    v_cvt_pk_bf16_f32 v115, v74, v75
    v_exp_f32 v76, v76
    v_exp_f32 v77, v77
    v_exp_f32 v78, v78
    v_exp_f32 v79, v79
    v_mfma_f32_32x32x16_bf16 v[36:51], v[104:107], v[112:115], v[36:51]
    v_cvt_pk_bf16_f32 v116, v76, v77
    v_cvt_pk_bf16_f32 v117, v78, v79
    v_exp_f32 v80, v80
    v_exp_f32 v81, v81
    v_exp_f32 v82, v82
    v_exp_f32 v83, v83
    v_cvt_pk_bf16_f32 v118, v80, v81
    v_cvt_pk_bf16_f32 v119, v82, v83
    v_mfma_f32_32x32x16_bf16 v[68:83], v[84:87], v[14:17], 0
    v_exp_f32 v52, v52
    v_exp_f32 v53, v53
    v_exp_f32 v54, v54
    v_exp_f32 v55, v55
    v_mfma_f32_32x32x8_bf16 v[68:83], v[88:89], v[18:19], v[68:83]
    v_cvt_pk_bf16_f32 v112, v52, v53
    v_cvt_pk_bf16_f32 v113, v54, v55
    v_exp_f32 v56, v56
    v_exp_f32 v57, v57
    v_exp_f32 v58, v58
    v_exp_f32 v59, v59
    v_mfma_f32_32x32x16_bf16 v[36:51], v[108:111], v[116:119], v[36:51]
    ds_read_b64 v[90:91], v125 offset:768
    ds_read_b64 v[92:93], v125 offset:2848
    ds_read_b64 v[94:95], v126 offset:768
    s_cmp_lg_u32 s30, 0
    s_cbranch_scc1 NF_8
    buffer_load_dwordx2 v[2:3], v121, s[56:59], 0 offen sc1
    buffer_load_dwordx2 v[4:5], v122, s[56:59], 0 offen sc1
NF_8:
    v_cvt_pk_bf16_f32 v114, v56, v57
    v_cvt_pk_bf16_f32 v115, v58, v59
    v_exp_f32 v60, v60
    v_exp_f32 v61, v61
    v_exp_f32 v62, v62
    v_exp_f32 v63, v63
    s_waitcnt lgkmcnt(3)
    v_mfma_f32_32x32x16_bf16 v[20:35], v[96:99], v[112:115], v[20:35]
    v_cvt_pk_bf16_f32 v116, v60, v61
    v_cvt_pk_bf16_f32 v117, v62, v63
    v_exp_f32 v64, v64
    v_exp_f32 v65, v65
    v_exp_f32 v66, v66
    v_exp_f32 v67, v67
    v_cvt_pk_bf16_f32 v118, v64, v65
    v_cvt_pk_bf16_f32 v119, v66, v67
    s_waitcnt lgkmcnt(0)
    v_mfma_f32_32x32x16_bf16 v[52:67], v[90:93], v[8:11], 0
    v_exp_f32 v68, v68
    v_exp_f32 v69, v69
    v_exp_f32 v70, v70
    v_exp_f32 v71, v71
    v_mfma_f32_32x32x8_bf16 v[52:67], v[94:95], v[12:13], v[52:67]
    v_cvt_pk_bf16_f32 v112, v68, v69
    v_cvt_pk_bf16_f32 v113, v70, v71
    v_exp_f32 v72, v72
    v_exp_f32 v73, v73
    v_exp_f32 v74, v74
    v_exp_f32 v75, v75
    v_mfma_f32_32x32x16_bf16 v[20:35], v[100:103], v[116:119], v[20:35]
    ds_read_b64_tr_b16 v[104:105], v127 offset:768
    ds_read_b64_tr_b16 v[106:107], v127 offset:832
    ds_read_b64_tr_b16 v[108:109], v127 offset:896
    ds_read_b64_tr_b16 v[110:111], v127 offset:960
    s_setprio 0
    v_cvt_pk_bf16_f32 v114, v72, v73
    v_cvt_pk_bf16_f32 v115, v74, v75
    v_exp_f32 v76, v76
    v_exp_f32 v77, v77
    v_exp_f32 v78, v78
    v_exp_f32 v79, v79
    v_mfma_f32_32x32x16_bf16 v[36:51], v[96:99], v[112:115], v[36:51]
    v_cvt_pk_bf16_f32 v116, v76, v77
    v_cvt_pk_bf16_f32 v117, v78, v79
    v_exp_f32 v80, v80
    v_exp_f32 v81, v81
    v_exp_f32 v82, v82
    v_exp_f32 v83, v83
    v_cvt_pk_bf16_f32 v118, v80, v81
    v_cvt_pk_bf16_f32 v119, v82, v83
    v_mfma_f32_32x32x16_bf16 v[68:83], v[90:93], v[14:17], 0
    v_exp_f32 v52, v52
    v_exp_f32 v53, v53
    v_exp_f32 v54, v54
    v_exp_f32 v55, v55
    v_mfma_f32_32x32x8_bf16 v[68:83], v[94:95], v[18:19], v[68:83]
    v_cvt_pk_bf16_f32 v112, v52, v53
    v_cvt_pk_bf16_f32 v113, v54, v55
    v_exp_f32 v56, v56
    v_exp_f32 v57, v57
    v_exp_f32 v58, v58
    v_exp_f32 v59, v59
    v_mfma_f32_32x32x16_bf16 v[36:51], v[100:103], v[116:119], v[36:51]
    s_waitcnt vmcnt(0)
    s_cmp_lg_u32 s30, 0
    s_cbranch_scc1 FC_9
    v_cmp_ne_u64 s[64:65], s[6:7], v[2:3]
    v_cmp_ne_u64 s[66:67], s[6:7], v[4:5]
    s_or_b64 s[64:65], s[64:65], s[66:67]
    s_cbranch_scc0 FC_9
    s_mov_b32 s64, 400000
PL_10:
    buffer_load_dwordx2 v[2:3], v121, s[56:59], 0 offen sc1
    buffer_load_dwordx2 v[4:5], v122, s[56:59], 0 offen sc1
    s_waitcnt vmcnt(0)
    v_cmp_ne_u64 vcc, s[6:7], v[2:3]
    v_cmp_ne_u64 s[66:67], s[6:7], v[4:5]
    s_or_b64 vcc, vcc, s[66:67]
    s_cbranch_vccz PD_11
    s_sub_u32 s64, s64, 1
    s_cmp_lg_u32 s64, 0
    s_cbranch_scc1 PL_10
PD_11:
    s_mov_b64 vcc, -1
FC_9:
    s_barrier
    ds_read_b64 v[84:85], v125 offset:22880
    ds_read_b64 v[86:87], v125 offset:24960
    ds_read_b64 v[88:89], v126 offset:22880
    s_setprio 3
    v_cvt_pk_bf16_f32 v114, v56, v57
    v_cvt_pk_bf16_f32 v115, v58, v59
    v_exp_f32 v60, v60
    v_exp_f32 v61, v61
    v_exp_f32 v62, v62
    v_exp_f32 v63, v63
    s_waitcnt lgkmcnt(3)
    v_mfma_f32_32x32x16_bf16 v[20:35], v[104:107], v[112:115], v[20:35]
    v_cvt_pk_bf16_f32 v116, v60, v61
    v_cvt_pk_bf16_f32 v117, v62, v63
    v_exp_f32 v64, v64
    v_exp_f32 v65, v65
    v_exp_f32 v66, v66
    v_exp_f32 v67, v67
    v_cvt_pk_bf16_f32 v118, v64, v65
    v_cvt_pk_bf16_f32 v119, v66, v67
    s_waitcnt lgkmcnt(0)
    v_mfma_f32_32x32x16_bf16 v[52:67], v[84:87], v[8:11], 0
    v_exp_f32 v68, v68
    v_exp_f32 v69, v69
    v_exp_f32 v70, v70
    v_exp_f32 v71, v71
    v_mfma_f32_32x32x8_bf16 v[52:67], v[88:89], v[12:13], v[52:67]
    v_cvt_pk_bf16_f32 v112, v68, v69
    v_cvt_pk_bf16_f32 v113, v70, v71
    v_exp_f32 v72, v72
    v_exp_f32 v73, v73
    v_exp_f32 v74, v74
    v_exp_f32 v75, v75
    v_mfma_f32_32x32x16_bf16 v[20:35], v[108:111], v[116:119], v[20:35]
    ds_read_b64_tr_b16 v[96:97], v127 offset:22880
    ds_read_b64_tr_b16 v[98:99], v127 offset:22944
    ds_read_b64_tr_b16 v[100:101], v127 offset:23008
    ds_read_b64_tr_b16 v[102:103], v127 offset:23072
    s_add_u32 m0, s19, 45760
    s_add_u32 s68, s16, 4096
    buffer_load_dwordx4 v123, s[56:59], s68 offen sc1 lds
    v_cvt_pk_bf16_f32 v114, v72, v73
    v_cvt_pk_bf16_f32 v115, v74, v75
    v_exp_f32 v76, v76
    v_exp_f32 v77, v77
    v_exp_f32 v78, v78
    v_exp_f32 v79, v79
    v_mfma_f32_32x32x16_bf16 v[36:51], v[104:107], v[112:115], v[36:51]
    v_cvt_pk_bf16_f32 v116, v76, v77
    v_cvt_pk_bf16_f32 v117, v78, v79
    v_exp_f32 v80, v80
    v_exp_f32 v81, v81
    v_exp_f32 v82, v82
    v_exp_f32 v83, v83
    v_cvt_pk_bf16_f32 v118, v80, v81
    v_cvt_pk_bf16_f32 v119, v82, v83
    v_mfma_f32_32x32x16_bf16 v[68:83], v[84:87], v[14:17], 0
    v_exp_f32 v52, v52
    v_exp_f32 v53, v53
    v_exp_f32 v54, v54
    v_exp_f32 v55, v55
    v_mfma_f32_32x32x8_bf16 v[68:83], v[88:89], v[18:19], v[68:83]
    v_cvt_pk_bf16_f32 v112, v52, v53
    v_cvt_pk_bf16_f32 v113, v54, v55
    v_exp_f32 v56, v56
    v_exp_f32 v57, v57
    v_exp_f32 v58, v58
    v_exp_f32 v59, v59
    v_mfma_f32_32x32x16_bf16 v[36:51], v[108:111], v[116:119], v[36:51]
    ds_read_b64 v[90:91], v125 offset:23136
    ds_read_b64 v[92:93], v125 offset:25216
    ds_read_b64 v[94:95], v126 offset:23136
    s_add_u32 m0, s20, 45760
    s_add_u32 s68, s17, 4096
    buffer_load_dwordx4 v123, s[56:59], s68 offen sc1 lds
    s_setprio 2
    v_cvt_pk_bf16_f32 v114, v56, v57
    v_cvt_pk_bf16_f32 v115, v58, v59
    v_exp_f32 v60, v60
    v_exp_f32 v61, v61
    v_exp_f32 v62, v62
    v_exp_f32 v63, v63
    s_waitcnt lgkmcnt(3)
    v_mfma_f32_32x32x16_bf16 v[20:35], v[96:99], v[112:115], v[20:35]
    v_cvt_pk_bf16_f32 v116, v60, v61
    v_cvt_pk_bf16_f32 v117, v62, v63
    v_exp_f32 v64, v64
    v_exp_f32 v65, v65
    v_exp_f32 v66, v66
    v_exp_f32 v67, v67
    v_cvt_pk_bf16_f32 v118, v64, v65
    v_cvt_pk_bf16_f32 v119, v66, v67
    s_waitcnt lgkmcnt(0)
    v_mfma_f32_32x32x16_bf16 v[52:67], v[90:93], v[8:11], 0
    v_exp_f32 v68, v68
    v_exp_f32 v69, v69
    v_exp_f32 v70, v70
    v_exp_f32 v71, v71
    v_mfma_f32_32x32x8_bf16 v[52:67], v[94:95], v[12:13], v[52:67]
    v_cvt_pk_bf16_f32 v112, v68, v69
    v_cvt_pk_bf16_f32 v113, v70, v71
    v_exp_f32 v72, v72
    v_exp_f32 v73, v73
    v_exp_f32 v74, v74
    v_exp_f32 v75, v75
    v_mfma_f32_32x32x16_bf16 v[20:35], v[100:103], v[116:119], v[20:35]
    ds_read_b64_tr_b16 v[104:105], v127 offset:23136
    ds_read_b64_tr_b16 v[106:107], v127 offset:23200
    ds_read_b64_tr_b16 v[108:109], v127 offset:23264
    ds_read_b64_tr_b16 v[110:111], v127 offset:23328
    s_cbranch_vccz D3_12
    s_add_u32 m0, s21, 45760
    s_add_u32 s68, s18, 4096
    buffer_load_dwordx4 v123, s[56:59], s68 offen sc1 lds
D3_12:
    v_cvt_pk_bf16_f32 v114, v72, v73
    v_cvt_pk_bf16_f32 v115, v74, v75
    v_exp_f32 v76, v76
    v_exp_f32 v77, v77
    v_exp_f32 v78, v78
    v_exp_f32 v79, v79
    v_mfma_f32_32x32x16_bf16 v[36:51], v[96:99], v[112:115], v[36:51]
    v_cvt_pk_bf16_f32 v116, v76, v77
    v_cvt_pk_bf16_f32 v117, v78, v79
    v_exp_f32 v80, v80
    v_exp_f32 v81, v81
    v_exp_f32 v82, v82
    v_exp_f32 v83, v83
    v_cvt_pk_bf16_f32 v118, v80, v81
    v_cvt_pk_bf16_f32 v119, v82, v83
    v_mfma_f32_32x32x16_bf16 v[68:83], v[90:93], v[14:17], 0
    v_exp_f32 v52, v52
    v_exp_f32 v53, v53
    v_exp_f32 v54, v54
    v_exp_f32 v55, v55
    v_mfma_f32_32x32x8_bf16 v[68:83], v[94:95], v[18:19], v[68:83]
    v_cvt_pk_bf16_f32 v112, v52, v53
    v_cvt_pk_bf16_f32 v113, v54, v55
    v_exp_f32 v56, v56
    v_exp_f32 v57, v57
    v_exp_f32 v58, v58
    v_exp_f32 v59, v59
    v_mfma_f32_32x32x16_bf16 v[36:51], v[100:103], v[116:119], v[36:51]
    ds_read_b64 v[84:85], v125 offset:23392
    ds_read_b64 v[86:87], v125 offset:25472
    ds_read_b64 v[88:89], v126 offset:23392
    s_setprio 1
    v_cvt_pk_bf16_f32 v114, v56, v57
    v_cvt_pk_bf16_f32 v115, v58, v59
    v_exp_f32 v60, v60
    v_exp_f32 v61, v61
    v_exp_f32 v62, v62
    v_exp_f32 v63, v63
    s_waitcnt lgkmcnt(3)
    v_mfma_f32_32x32x16_bf16 v[20:35], v[104:107], v[112:115], v[20:35]
    v_cvt_pk_bf16_f32 v116, v60, v61
    v_cvt_pk_bf16_f32 v117, v62, v63
    v_exp_f32 v64, v64
    v_exp_f32 v65, v65
    v_exp_f32 v66, v66
    v_exp_f32 v67, v67
    v_cvt_pk_bf16_f32 v118, v64, v65
    v_cvt_pk_bf16_f32 v119, v66, v67
    s_waitcnt lgkmcnt(0)
    v_mfma_f32_32x32x16_bf16 v[52:67], v[84:87], v[8:11], 0
    v_exp_f32 v68, v68
    v_exp_f32 v69, v69
    v_exp_f32 v70, v70
    v_exp_f32 v71, v71
    v_mfma_f32_32x32x8_bf16 v[52:67], v[88:89], v[12:13], v[52:67]
    v_cvt_pk_bf16_f32 v112, v68, v69
    v_cvt_pk_bf16_f32 v113, v70, v71
    v_exp_f32 v72, v72
    v_exp_f32 v73, v73
    v_exp_f32 v74, v74
    v_exp_f32 v75, v75
    v_mfma_f32_32x32x16_bf16 v[20:35], v[108:111], v[116:119], v[20:35]
    ds_read_b64_tr_b16 v[96:97], v127 offset:23392
    ds_read_b64_tr_b16 v[98:99], v127 offset:23456
    ds_read_b64_tr_b16 v[100:101], v127 offset:23520
    ds_read_b64_tr_b16 v[102:103], v127 offset:23584
    s_lshl_b32 s64, s40, 12
    s_add_u32 s64, s64, 45760
    s_xor_b32 s65, s40, 4
    s_lshl_b32 s65, s65, 12
    s_add_u32 s65, s65, 45760
    v_add_u32 v2, s64, v123
    v_add_u32 v3, s65, v123
    s_movk_i32 s69, 0x100
    v_cmp_gt_u32 s[66:67], s69, v123
    v_lshrrev_b32 v4, 9, v123
    v_bfe_u32 v5, v123, 8, 1
    v_lshl_add_u32 v5, v5, 1, v4
    v_mul_u32_u24 v5, 16384, v5
    v_add_u32 v5, v5, v124
    v_mov_b32 v4, 2147483648
    v_cndmask_b32 v4, v4, v124, s[66:67]
    v_cvt_pk_bf16_f32 v114, v72, v73
    v_cvt_pk_bf16_f32 v115, v74, v75
    v_exp_f32 v76, v76
    v_exp_f32 v77, v77
    v_exp_f32 v78, v78
    v_exp_f32 v79, v79
    v_mfma_f32_32x32x16_bf16 v[36:51], v[104:107], v[112:115], v[36:51]
    v_cvt_pk_bf16_f32 v116, v76, v77
    v_cvt_pk_bf16_f32 v117, v78, v79
    v_exp_f32 v80, v80
    v_exp_f32 v81, v81
    v_exp_f32 v82, v82
    v_exp_f32 v83, v83
    v_cvt_pk_bf16_f32 v118, v80, v81
    v_cvt_pk_bf16_f32 v119, v82, v83
    v_mfma_f32_32x32x16_bf16 v[68:83], v[84:87], v[14:17], 0
    v_exp_f32 v52, v52
    v_exp_f32 v53, v53
    v_exp_f32 v54, v54
    v_exp_f32 v55, v55
    v_mfma_f32_32x32x8_bf16 v[68:83], v[88:89], v[18:19], v[68:83]
    v_cvt_pk_bf16_f32 v112, v52, v53
    v_cvt_pk_bf16_f32 v113, v54, v55
    v_exp_f32 v56, v56
    v_exp_f32 v57, v57
    v_exp_f32 v58, v58
    v_exp_f32 v59, v59
    v_mfma_f32_32x32x16_bf16 v[36:51], v[108:111], v[116:119], v[36:51]
    ds_read_b64 v[90:91], v125 offset:23648
    ds_read_b64 v[92:93], v125 offset:25728
    ds_read_b64 v[94:95], v126 offset:23648
    s_setprio 0
    v_cvt_pk_bf16_f32 v114, v56, v57
    v_cvt_pk_bf16_f32 v115, v58, v59
    v_exp_f32 v60, v60
    v_exp_f32 v61, v61
    v_exp_f32 v62, v62
    v_exp_f32 v63, v63
    s_waitcnt lgkmcnt(3)
    v_mfma_f32_32x32x16_bf16 v[20:35], v[96:99], v[112:115], v[20:35]
    v_cvt_pk_bf16_f32 v116, v60, v61
    v_cvt_pk_bf16_f32 v117, v62, v63
    v_exp_f32 v64, v64
    v_exp_f32 v65, v65
    v_exp_f32 v66, v66
    v_exp_f32 v67, v67
    v_cvt_pk_bf16_f32 v118, v64, v65
    v_cvt_pk_bf16_f32 v119, v66, v67
    s_waitcnt lgkmcnt(0)
    v_mfma_f32_32x32x16_bf16 v[52:67], v[90:93], v[8:11], 0
    v_exp_f32 v68, v68
    v_exp_f32 v69, v69
    v_exp_f32 v70, v70
    v_exp_f32 v71, v71
    v_mfma_f32_32x32x8_bf16 v[52:67], v[94:95], v[12:13], v[52:67]
    v_cvt_pk_bf16_f32 v112, v68, v69
    v_cvt_pk_bf16_f32 v113, v70, v71
    v_exp_f32 v72, v72
    v_exp_f32 v73, v73
    v_exp_f32 v74, v74
    v_exp_f32 v75, v75
    v_mfma_f32_32x32x16_bf16 v[20:35], v[100:103], v[116:119], v[20:35]
    ds_read_b64_tr_b16 v[104:105], v127 offset:23648
    ds_read_b64_tr_b16 v[106:107], v127 offset:23712
    ds_read_b64_tr_b16 v[108:109], v127 offset:23776
    ds_read_b64_tr_b16 v[110:111], v127 offset:23840
    v_cvt_pk_bf16_f32 v114, v72, v73
    v_cvt_pk_bf16_f32 v115, v74, v75
    v_exp_f32 v76, v76
    v_exp_f32 v77, v77
    v_exp_f32 v78, v78
    v_exp_f32 v79, v79
    v_mfma_f32_32x32x16_bf16 v[36:51], v[96:99], v[112:115], v[36:51]
    v_cvt_pk_bf16_f32 v116, v76, v77
    v_cvt_pk_bf16_f32 v117, v78, v79
    v_exp_f32 v80, v80
    v_exp_f32 v81, v81
    v_exp_f32 v82, v82
    v_exp_f32 v83, v83
    v_cvt_pk_bf16_f32 v118, v80, v81
    v_cvt_pk_bf16_f32 v119, v82, v83
    v_mfma_f32_32x32x16_bf16 v[68:83], v[90:93], v[14:17], 0
    v_exp_f32 v52, v52
    v_exp_f32 v53, v53
    v_exp_f32 v54, v54
    v_exp_f32 v55, v55
    v_mfma_f32_32x32x8_bf16 v[68:83], v[94:95], v[18:19], v[68:83]
    v_cvt_pk_bf16_f32 v112, v52, v53
    v_cvt_pk_bf16_f32 v113, v54, v55
    v_exp_f32 v56, v56
    v_exp_f32 v57, v57
    v_exp_f32 v58, v58
    v_exp_f32 v59, v59
    v_mfma_f32_32x32x16_bf16 v[36:51], v[100:103], v[116:119], v[36:51]
    s_waitcnt vmcnt(0)
    s_barrier
    ds_read_b64 v[84:85], v125 offset:45760
    ds_read_b64 v[86:87], v125 offset:47840
    ds_read_b64 v[88:89], v126 offset:45760
    s_setprio 3
    v_cvt_pk_bf16_f32 v114, v56, v57
    v_cvt_pk_bf16_f32 v115, v58, v59
    v_exp_f32 v60, v60
    v_exp_f32 v61, v61
    v_exp_f32 v62, v62
    v_exp_f32 v63, v63
    s_waitcnt lgkmcnt(3)
    v_mfma_f32_32x32x16_bf16 v[20:35], v[104:107], v[112:115], v[20:35]
    v_cvt_pk_bf16_f32 v116, v60, v61
    v_cvt_pk_bf16_f32 v117, v62, v63
    v_exp_f32 v64, v64
    v_exp_f32 v65, v65
    v_exp_f32 v66, v66
    v_exp_f32 v67, v67
    v_cvt_pk_bf16_f32 v118, v64, v65
    v_cvt_pk_bf16_f32 v119, v66, v67
    s_waitcnt lgkmcnt(0)
    v_mfma_f32_32x32x16_bf16 v[52:67], v[84:87], v[8:11], 0
    v_exp_f32 v68, v68
    v_exp_f32 v69, v69
    v_exp_f32 v70, v70
    v_exp_f32 v71, v71
    v_mfma_f32_32x32x8_bf16 v[52:67], v[88:89], v[12:13], v[52:67]
    v_cvt_pk_bf16_f32 v112, v68, v69
    v_cvt_pk_bf16_f32 v113, v70, v71
    v_exp_f32 v72, v72
    v_exp_f32 v73, v73
    v_exp_f32 v74, v74
    v_exp_f32 v75, v75
    v_mfma_f32_32x32x16_bf16 v[20:35], v[108:111], v[116:119], v[20:35]
    ds_read_b64_tr_b16 v[96:97], v127 offset:45760
    ds_read_b64_tr_b16 v[98:99], v127 offset:45824
    ds_read_b64_tr_b16 v[100:101], v127 offset:45888
    ds_read_b64_tr_b16 v[102:103], v127 offset:45952
    s_add_u32 m0, s19, 0
    s_add_u32 s68, s16, 6144
    buffer_load_dwordx4 v123, s[56:59], s68 offen sc1 lds
    v_cvt_pk_bf16_f32 v114, v72, v73
    v_cvt_pk_bf16_f32 v115, v74, v75
    v_exp_f32 v76, v76
    v_exp_f32 v77, v77
    v_exp_f32 v78, v78
    v_exp_f32 v79, v79
    v_mfma_f32_32x32x16_bf16 v[36:51], v[104:107], v[112:115], v[36:51]
    v_cvt_pk_bf16_f32 v116, v76, v77
    v_cvt_pk_bf16_f32 v117, v78, v79
    v_exp_f32 v80, v80
    v_exp_f32 v81, v81
    v_exp_f32 v82, v82
    v_exp_f32 v83, v83
    v_cvt_pk_bf16_f32 v118, v80, v81
    v_cvt_pk_bf16_f32 v119, v82, v83
    v_mfma_f32_32x32x16_bf16 v[68:83], v[84:87], v[14:17], 0
    v_exp_f32 v52, v52
    v_exp_f32 v53, v53
    v_exp_f32 v54, v54
    v_exp_f32 v55, v55
    v_mfma_f32_32x32x8_bf16 v[68:83], v[88:89], v[18:19], v[68:83]
    v_cvt_pk_bf16_f32 v112, v52, v53
    v_cvt_pk_bf16_f32 v113, v54, v55
    v_exp_f32 v56, v56
    v_exp_f32 v57, v57
    v_exp_f32 v58, v58
    v_exp_f32 v59, v59
    v_mfma_f32_32x32x16_bf16 v[36:51], v[108:111], v[116:119], v[36:51]
    ds_read_b64 v[90:91], v125 offset:46016
    ds_read_b64 v[92:93], v125 offset:48096
    ds_read_b64 v[94:95], v126 offset:46016
    s_add_u32 m0, s20, 0
    s_add_u32 s68, s17, 6144
    buffer_load_dwordx4 v123, s[56:59], s68 offen sc1 lds
    s_setprio 2
    v_cvt_pk_bf16_f32 v114, v56, v57
    v_cvt_pk_bf16_f32 v115, v58, v59
    v_exp_f32 v60, v60
    v_exp_f32 v61, v61
    v_exp_f32 v62, v62
    v_exp_f32 v63, v63
    s_waitcnt lgkmcnt(3)
    v_mfma_f32_32x32x16_bf16 v[20:35], v[96:99], v[112:115], v[20:35]
    v_cvt_pk_bf16_f32 v116, v60, v61
    v_cvt_pk_bf16_f32 v117, v62, v63
    v_exp_f32 v64, v64
    v_exp_f32 v65, v65
    v_exp_f32 v66, v66
    v_exp_f32 v67, v67
    v_cvt_pk_bf16_f32 v118, v64, v65
    v_cvt_pk_bf16_f32 v119, v66, v67
    s_waitcnt lgkmcnt(0)
    v_mfma_f32_32x32x16_bf16 v[52:67], v[90:93], v[8:11], 0
    v_exp_f32 v68, v68
    v_exp_f32 v69, v69
    v_exp_f32 v70, v70
    v_exp_f32 v71, v71
    v_mfma_f32_32x32x8_bf16 v[52:67], v[94:95], v[12:13], v[52:67]
    v_cvt_pk_bf16_f32 v112, v68, v69
    v_cvt_pk_bf16_f32 v113, v70, v71
    v_exp_f32 v72, v72
    v_exp_f32 v73, v73
    v_exp_f32 v74, v74
    v_exp_f32 v75, v75
    v_mfma_f32_32x32x16_bf16 v[20:35], v[100:103], v[116:119], v[20:35]
    ds_read_b64_tr_b16 v[104:105], v127 offset:46016
    ds_read_b64_tr_b16 v[106:107], v127 offset:46080
    ds_read_b64_tr_b16 v[108:109], v127 offset:46144
    ds_read_b64_tr_b16 v[110:111], v127 offset:46208
    s_cbranch_vccz D3_13
    s_add_u32 m0, s21, 0
    s_add_u32 s68, s18, 6144
    buffer_load_dwordx4 v123, s[56:59], s68 offen sc1 lds
D3_13:
    v_cvt_pk_bf16_f32 v114, v72, v73
    v_cvt_pk_bf16_f32 v115, v74, v75
    v_exp_f32 v76, v76
    v_exp_f32 v77, v77
    v_exp_f32 v78, v78
    v_exp_f32 v79, v79
    v_mfma_f32_32x32x16_bf16 v[36:51], v[96:99], v[112:115], v[36:51]
    v_cvt_pk_bf16_f32 v116, v76, v77
    v_cvt_pk_bf16_f32 v117, v78, v79
    v_exp_f32 v80, v80
    v_exp_f32 v81, v81
    v_exp_f32 v82, v82
    v_exp_f32 v83, v83
    v_cvt_pk_bf16_f32 v118, v80, v81
    v_cvt_pk_bf16_f32 v119, v82, v83
    v_mfma_f32_32x32x16_bf16 v[68:83], v[90:93], v[14:17], 0
    v_exp_f32 v52, v52
    v_exp_f32 v53, v53
    v_exp_f32 v54, v54
    v_exp_f32 v55, v55
    v_mfma_f32_32x32x8_bf16 v[68:83], v[94:95], v[18:19], v[68:83]
    v_cvt_pk_bf16_f32 v112, v52, v53
    v_cvt_pk_bf16_f32 v113, v54, v55
    v_exp_f32 v56, v56
    v_exp_f32 v57, v57
    v_exp_f32 v58, v58
    v_exp_f32 v59, v59
    v_mfma_f32_32x32x16_bf16 v[36:51], v[100:103], v[116:119], v[36:51]
    ds_read_b64 v[84:85], v125 offset:46272
    ds_read_b64 v[86:87], v125 offset:48352
    ds_read_b64 v[88:89], v126 offset:46272
    s_setprio 1
    v_cvt_pk_bf16_f32 v114, v56, v57
    v_cvt_pk_bf16_f32 v115, v58, v59
    v_exp_f32 v60, v60
    v_exp_f32 v61, v61
    v_exp_f32 v62, v62
    v_exp_f32 v63, v63
    s_waitcnt lgkmcnt(3)
    v_mfma_f32_32x32x16_bf16 v[20:35], v[104:107], v[112:115], v[20:35]
    v_cvt_pk_bf16_f32 v116, v60, v61
    v_cvt_pk_bf16_f32 v117, v62, v63
    v_exp_f32 v64, v64
    v_exp_f32 v65, v65
    v_exp_f32 v66, v66
    v_exp_f32 v67, v67
    v_cvt_pk_bf16_f32 v118, v64, v65
    v_cvt_pk_bf16_f32 v119, v66, v67
    s_waitcnt lgkmcnt(0)
    v_mfma_f32_32x32x16_bf16 v[52:67], v[84:87], v[8:11], 0
    v_exp_f32 v68, v68
    v_exp_f32 v69, v69
    v_exp_f32 v70, v70
    v_exp_f32 v71, v71
    v_mfma_f32_32x32x8_bf16 v[52:67], v[88:89], v[12:13], v[52:67]
    v_cvt_pk_bf16_f32 v112, v68, v69
    v_cvt_pk_bf16_f32 v113, v70, v71
    v_exp_f32 v72, v72
    v_exp_f32 v73, v73
    v_exp_f32 v74, v74
    v_exp_f32 v75, v75
    v_mfma_f32_32x32x16_bf16 v[20:35], v[108:111], v[116:119], v[20:35]
    ds_read_b64_tr_b16 v[96:97], v127 offset:46272
    ds_read_b64_tr_b16 v[98:99], v127 offset:46336
    ds_read_b64_tr_b16 v[100:101], v127 offset:46400
    ds_read_b64_tr_b16 v[102:103], v127 offset:46464
    v_cvt_pk_bf16_f32 v114, v72, v73
    v_cvt_pk_bf16_f32 v115, v74, v75
    v_exp_f32 v76, v76
    v_exp_f32 v77, v77
    v_exp_f32 v78, v78
    v_exp_f32 v79, v79
    v_mfma_f32_32x32x16_bf16 v[36:51], v[104:107], v[112:115], v[36:51]
    v_cvt_pk_bf16_f32 v116, v76, v77
    v_cvt_pk_bf16_f32 v117, v78, v79
    v_exp_f32 v80, v80
    v_exp_f32 v81, v81
    v_exp_f32 v82, v82
    v_exp_f32 v83, v83
    v_cvt_pk_bf16_f32 v118, v80, v81
    v_cvt_pk_bf16_f32 v119, v82, v83
    v_mfma_f32_32x32x16_bf16 v[68:83], v[84:87], v[14:17], 0
    v_exp_f32 v52, v52
    v_exp_f32 v53, v53
    v_exp_f32 v54, v54
    v_exp_f32 v55, v55
    v_mfma_f32_32x32x8_bf16 v[68:83], v[88:89], v[18:19], v[68:83]
    v_cvt_pk_bf16_f32 v112, v52, v53
    v_cvt_pk_bf16_f32 v113, v54, v55
    v_exp_f32 v56, v56
    v_exp_f32 v57, v57
    v_exp_f32 v58, v58
    v_exp_f32 v59, v59
    v_mfma_f32_32x32x16_bf16 v[36:51], v[108:111], v[116:119], v[36:51]
    ds_read_b64 v[90:91], v125 offset:46528
    ds_read_b64 v[92:93], v125 offset:48608
    ds_read_b64 v[94:95], v126 offset:46528
    s_setprio 0
    v_cvt_pk_bf16_f32 v114, v56, v57
    v_cvt_pk_bf16_f32 v115, v58, v59
    v_exp_f32 v60, v60
    v_exp_f32 v61, v61
    v_exp_f32 v62, v62
    v_exp_f32 v63, v63
    s_waitcnt lgkmcnt(3)
    v_mfma_f32_32x32x16_bf16 v[20:35], v[96:99], v[112:115], v[20:35]
    v_cvt_pk_bf16_f32 v116, v60, v61
    v_cvt_pk_bf16_f32 v117, v62, v63
    v_exp_f32 v64, v64
    v_exp_f32 v65, v65
    v_exp_f32 v66, v66
    v_exp_f32 v67, v67
    v_cvt_pk_bf16_f32 v118, v64, v65
    v_cvt_pk_bf16_f32 v119, v66, v67
    s_waitcnt lgkmcnt(0)
    v_mfma_f32_32x32x16_bf16 v[52:67], v[90:93], v[8:11], 0
    v_exp_f32 v68, v68
    v_exp_f32 v69, v69
    v_exp_f32 v70, v70
    v_exp_f32 v71, v71
    v_mfma_f32_32x32x8_bf16 v[52:67], v[94:95], v[12:13], v[52:67]
    v_cvt_pk_bf16_f32 v112, v68, v69
    v_cvt_pk_bf16_f32 v113, v70, v71
    v_exp_f32 v72, v72
    v_exp_f32 v73, v73
    v_exp_f32 v74, v74
    v_exp_f32 v75, v75
    v_mfma_f32_32x32x16_bf16 v[20:35], v[100:103], v[116:119], v[20:35]
    ds_read_b64_tr_b16 v[104:105], v127 offset:46528
    ds_read_b64_tr_b16 v[106:107], v127 offset:46592
    ds_read_b64_tr_b16 v[108:109], v127 offset:46656
    ds_read_b64_tr_b16 v[110:111], v127 offset:46720
    v_cvt_pk_bf16_f32 v114, v72, v73
    v_cvt_pk_bf16_f32 v115, v74, v75
    v_exp_f32 v76, v76
    v_exp_f32 v77, v77
    v_exp_f32 v78, v78
    v_exp_f32 v79, v79
    v_mfma_f32_32x32x16_bf16 v[36:51], v[96:99], v[112:115], v[36:51]
    v_cvt_pk_bf16_f32 v116, v76, v77
    v_cvt_pk_bf16_f32 v117, v78, v79
    v_exp_f32 v80, v80
    v_exp_f32 v81, v81
    v_exp_f32 v82, v82
    v_exp_f32 v83, v83
    v_cvt_pk_bf16_f32 v118, v80, v81
    v_cvt_pk_bf16_f32 v119, v82, v83
    v_mfma_f32_32x32x16_bf16 v[68:83], v[90:93], v[14:17], 0
    v_exp_f32 v52, v52
    v_exp_f32 v53, v53
    v_exp_f32 v54, v54
    v_exp_f32 v55, v55
    v_mfma_f32_32x32x8_bf16 v[68:83], v[94:95], v[18:19], v[68:83]
    v_cvt_pk_bf16_f32 v112, v52, v53
    v_cvt_pk_bf16_f32 v113, v54, v55
    v_exp_f32 v56, v56
    v_exp_f32 v57, v57
    v_exp_f32 v58, v58
    v_exp_f32 v59, v59
    v_mfma_f32_32x32x16_bf16 v[36:51], v[100:103], v[116:119], v[36:51]
    s_waitcnt vmcnt(0)
    s_barrier
    ds_read_b64 v[84:85], v125 offset:0
    ds_read_b64 v[86:87], v125 offset:2080
    ds_read_b64 v[88:89], v126 offset:0
    s_setprio 3
    v_cvt_pk_bf16_f32 v114, v56, v57
    v_cvt_pk_bf16_f32 v115, v58, v59
    v_exp_f32 v60, v60
    v_exp_f32 v61, v61
    v_exp_f32 v62, v62
    v_exp_f32 v63, v63
    s_waitcnt lgkmcnt(3)
    v_mfma_f32_32x32x16_bf16 v[20:35], v[104:107], v[112:115], v[20:35]
    v_cvt_pk_bf16_f32 v116, v60, v61
    v_cvt_pk_bf16_f32 v117, v62, v63
    v_exp_f32 v64, v64
    v_exp_f32 v65, v65
    v_exp_f32 v66, v66
    v_exp_f32 v67, v67
    v_cvt_pk_bf16_f32 v118, v64, v65
    v_cvt_pk_bf16_f32 v119, v66, v67
    s_waitcnt lgkmcnt(0)
    v_mfma_f32_32x32x16_bf16 v[52:67], v[84:87], v[8:11], 0
    v_exp_f32 v68, v68
    v_exp_f32 v69, v69
    v_exp_f32 v70, v70
    v_exp_f32 v71, v71
    v_mfma_f32_32x32x8_bf16 v[52:67], v[88:89], v[12:13], v[52:67]
    v_cvt_pk_bf16_f32 v112, v68, v69
    v_cvt_pk_bf16_f32 v113, v70, v71
    v_exp_f32 v72, v72
    v_exp_f32 v73, v73
    v_exp_f32 v74, v74
    v_exp_f32 v75, v75
    v_mfma_f32_32x32x16_bf16 v[20:35], v[108:111], v[116:119], v[20:35]
    ds_read_b64_tr_b16 v[96:97], v127 offset:0
    ds_read_b64_tr_b16 v[98:99], v127 offset:64
    ds_read_b64_tr_b16 v[100:101], v127 offset:128
    ds_read_b64_tr_b16 v[102:103], v127 offset:192
    s_add_u32 m0, s19, 22880
    s_add_u32 s68, s16, 8192
    buffer_load_dwordx4 v123, s[56:59], s68 offen sc1 lds
    v_cvt_pk_bf16_f32 v114, v72, v73
    v_cvt_pk_bf16_f32 v115, v74, v75
    v_exp_f32 v76, v76
    v_exp_f32 v77, v77
    v_exp_f32 v78, v78
    v_exp_f32 v79, v79
    v_mfma_f32_32x32x16_bf16 v[36:51], v[104:107], v[112:115], v[36:51]
    v_cvt_pk_bf16_f32 v116, v76, v77
    v_cvt_pk_bf16_f32 v117, v78, v79
    v_exp_f32 v80, v80
    v_exp_f32 v81, v81
    v_exp_f32 v82, v82
    v_exp_f32 v83, v83
    v_cvt_pk_bf16_f32 v118, v80, v81
    v_cvt_pk_bf16_f32 v119, v82, v83
    v_mfma_f32_32x32x16_bf16 v[68:83], v[84:87], v[14:17], 0
    v_exp_f32 v52, v52
    v_exp_f32 v53, v53
    v_exp_f32 v54, v54
    v_exp_f32 v55, v55
    v_mfma_f32_32x32x8_bf16 v[68:83], v[88:89], v[18:19], v[68:83]
    v_cvt_pk_bf16_f32 v112, v52, v53
    v_cvt_pk_bf16_f32 v113, v54, v55
    v_exp_f32 v56, v56
    v_exp_f32 v57, v57
    v_exp_f32 v58, v58
    v_exp_f32 v59, v59
    v_mfma_f32_32x32x16_bf16 v[36:51], v[108:111], v[116:119], v[36:51]
    ds_read_b64 v[90:91], v125 offset:256
    ds_read_b64 v[92:93], v125 offset:2336
    ds_read_b64 v[94:95], v126 offset:256
    s_add_u32 m0, s20, 22880
    s_add_u32 s68, s17, 8192
    buffer_load_dwordx4 v123, s[56:59], s68 offen sc1 lds
    s_setprio 2
    v_cvt_pk_bf16_f32 v114, v56, v57
    v_cvt_pk_bf16_f32 v115, v58, v59
    v_exp_f32 v60, v60
    v_exp_f32 v61, v61
    v_exp_f32 v62, v62
    v_exp_f32 v63, v63
    s_waitcnt lgkmcnt(3)
    v_mfma_f32_32x32x16_bf16 v[20:35], v[96:99], v[112:115], v[20:35]
    v_cvt_pk_bf16_f32 v116, v60, v61
    v_cvt_pk_bf16_f32 v117, v62, v63
    v_exp_f32 v64, v64
    v_exp_f32 v65, v65
    v_exp_f32 v66, v66
    v_exp_f32 v67, v67
    v_cvt_pk_bf16_f32 v118, v64, v65
    v_cvt_pk_bf16_f32 v119, v66, v67
    s_waitcnt lgkmcnt(0)
    v_mfma_f32_32x32x16_bf16 v[52:67], v[90:93], v[8:11], 0
    v_exp_f32 v68, v68
    v_exp_f32 v69, v69
    v_exp_f32 v70, v70
    v_exp_f32 v71, v71
    v_mfma_f32_32x32x8_bf16 v[52:67], v[94:95], v[12:13], v[52:67]
    v_cvt_pk_bf16_f32 v112, v68, v69
    v_cvt_pk_bf16_f32 v113, v70, v71
    v_exp_f32 v72, v72
    v_exp_f32 v73, v73
    v_exp_f32 v74, v74
    v_exp_f32 v75, v75
    v_mfma_f32_32x32x16_bf16 v[20:35], v[100:103], v[116:119], v[20:35]
    ds_read_b64_tr_b16 v[104:105], v127 offset:256
    ds_read_b64_tr_b16 v[106:107], v127 offset:320
    ds_read_b64_tr_b16 v[108:109], v127 offset:384
    ds_read_b64_tr_b16 v[110:111], v127 offset:448
    s_cbranch_vccz D3_14
    s_add_u32 m0, s21, 22880
    s_add_u32 s68, s18, 8192
    buffer_load_dwordx4 v123, s[56:59], s68 offen sc1 lds
D3_14:
    v_cvt_pk_bf16_f32 v114, v72, v73
    v_cvt_pk_bf16_f32 v115, v74, v75
    v_exp_f32 v76, v76
    v_exp_f32 v77, v77
    v_exp_f32 v78, v78
    v_exp_f32 v79, v79
    v_mfma_f32_32x32x16_bf16 v[36:51], v[96:99], v[112:115], v[36:51]
    v_cvt_pk_bf16_f32 v116, v76, v77
    v_cvt_pk_bf16_f32 v117, v78, v79
    v_exp_f32 v80, v80
    v_exp_f32 v81, v81
    v_exp_f32 v82, v82
    v_exp_f32 v83, v83
    v_cvt_pk_bf16_f32 v118, v80, v81
    v_cvt_pk_bf16_f32 v119, v82, v83
    v_mfma_f32_32x32x16_bf16 v[68:83], v[90:93], v[14:17], 0
    v_exp_f32 v52, v52
    v_exp_f32 v53, v53
    v_exp_f32 v54, v54
    v_exp_f32 v55, v55
    v_mfma_f32_32x32x8_bf16 v[68:83], v[94:95], v[18:19], v[68:83]
    v_cvt_pk_bf16_f32 v112, v52, v53
    v_cvt_pk_bf16_f32 v113, v54, v55
    v_exp_f32 v56, v56
    v_exp_f32 v57, v57
    v_exp_f32 v58, v58
    v_exp_f32 v59, v59
    v_mfma_f32_32x32x16_bf16 v[36:51], v[100:103], v[116:119], v[36:51]
    ds_read_b64 v[84:85], v125 offset:512
    ds_read_b64 v[86:87], v125 offset:2592
    ds_read_b64 v[88:89], v126 offset:512
    s_setprio 1
    v_cvt_pk_bf16_f32 v114, v56, v57
    v_cvt_pk_bf16_f32 v115, v58, v59
    v_exp_f32 v60, v60
    v_exp_f32 v61, v61
    v_exp_f32 v62, v62
    v_exp_f32 v63, v63
    s_waitcnt lgkmcnt(3)
    v_mfma_f32_32x32x16_bf16 v[20:35], v[104:107], v[112:115], v[20:35]
    v_cvt_pk_bf16_f32 v116, v60, v61
    v_cvt_pk_bf16_f32 v117, v62, v63
    v_exp_f32 v64, v64
    v_exp_f32 v65, v65
    v_exp_f32 v66, v66
    v_exp_f32 v67, v67
    v_cvt_pk_bf16_f32 v118, v64, v65
    v_cvt_pk_bf16_f32 v119, v66, v67
    s_waitcnt lgkmcnt(0)
    v_mfma_f32_32x32x16_bf16 v[52:67], v[84:87], v[8:11], 0
    v_exp_f32 v68, v68
    v_exp_f32 v69, v69
    v_exp_f32 v70, v70
    v_exp_f32 v71, v71
    v_mfma_f32_32x32x8_bf16 v[52:67], v[88:89], v[12:13], v[52:67]
    v_cvt_pk_bf16_f32 v112, v68, v69
    v_cvt_pk_bf16_f32 v113, v70, v71
    v_exp_f32 v72, v72
    v_exp_f32 v73, v73
    v_exp_f32 v74, v74
    v_exp_f32 v75, v75
    v_mfma_f32_32x32x16_bf16 v[20:35], v[108:111], v[116:119], v[20:35]
    ds_read_b64_tr_b16 v[96:97], v127 offset:512
    ds_read_b64_tr_b16 v[98:99], v127 offset:576
    ds_read_b64_tr_b16 v[100:101], v127 offset:640
    ds_read_b64_tr_b16 v[102:103], v127 offset:704
    v_cvt_pk_bf16_f32 v114, v72, v73
    v_cvt_pk_bf16_f32 v115, v74, v75
    v_exp_f32 v76, v76
    v_exp_f32 v77, v77
    v_exp_f32 v78, v78
    v_exp_f32 v79, v79
    v_mfma_f32_32x32x16_bf16 v[36:51], v[104:107], v[112:115], v[36:51]
    v_cvt_pk_bf16_f32 v116, v76, v77
    v_cvt_pk_bf16_f32 v117, v78, v79
    v_exp_f32 v80, v80
    v_exp_f32 v81, v81
    v_exp_f32 v82, v82
    v_exp_f32 v83, v83
    v_cvt_pk_bf16_f32 v118, v80, v81
    v_cvt_pk_bf16_f32 v119, v82, v83
    v_mfma_f32_32x32x16_bf16 v[68:83], v[84:87], v[14:17], 0
    v_exp_f32 v52, v52
    v_exp_f32 v53, v53
    v_exp_f32 v54, v54
    v_exp_f32 v55, v55
    v_mfma_f32_32x32x8_bf16 v[68:83], v[88:89], v[18:19], v[68:83]
    v_cvt_pk_bf16_f32 v112, v52, v53
    v_cvt_pk_bf16_f32 v113, v54, v55
    v_exp_f32 v56, v56
    v_exp_f32 v57, v57
    v_exp_f32 v58, v58
    v_exp_f32 v59, v59
    v_mfma_f32_32x32x16_bf16 v[36:51], v[108:111], v[116:119], v[36:51]
    ds_read_b64 v[90:91], v125 offset:768
    ds_read_b64 v[92:93], v125 offset:2848
    ds_read_b64 v[94:95], v126 offset:768
    s_setprio 0
    v_cvt_pk_bf16_f32 v114, v56, v57
    v_cvt_pk_bf16_f32 v115, v58, v59
    v_exp_f32 v60, v60
    v_exp_f32 v61, v61
    v_exp_f32 v62, v62
    v_exp_f32 v63, v63
    s_waitcnt lgkmcnt(3)
    v_mfma_f32_32x32x16_bf16 v[20:35], v[96:99], v[112:115], v[20:35]
    v_cvt_pk_bf16_f32 v116, v60, v61
    v_cvt_pk_bf16_f32 v117, v62, v63
    v_exp_f32 v64, v64
    v_exp_f32 v65, v65
    v_exp_f32 v66, v66
    v_exp_f32 v67, v67
    v_cvt_pk_bf16_f32 v118, v64, v65
    v_cvt_pk_bf16_f32 v119, v66, v67
    s_waitcnt lgkmcnt(0)
    v_mfma_f32_32x32x16_bf16 v[52:67], v[90:93], v[8:11], 0
    v_exp_f32 v68, v68
    v_exp_f32 v69, v69
    v_exp_f32 v70, v70
    v_exp_f32 v71, v71
    v_mfma_f32_32x32x8_bf16 v[52:67], v[94:95], v[12:13], v[52:67]
    v_cvt_pk_bf16_f32 v112, v68, v69
    v_cvt_pk_bf16_f32 v113, v70, v71
    v_exp_f32 v72, v72
    v_exp_f32 v73, v73
    v_exp_f32 v74, v74
    v_exp_f32 v75, v75
    v_mfma_f32_32x32x16_bf16 v[20:35], v[100:103], v[116:119], v[20:35]
    ds_read_b64_tr_b16 v[104:105], v127 offset:768
    ds_read_b64_tr_b16 v[106:107], v127 offset:832
    ds_read_b64_tr_b16 v[108:109], v127 offset:896
    ds_read_b64_tr_b16 v[110:111], v127 offset:960
    v_cvt_pk_bf16_f32 v114, v72, v73
    v_cvt_pk_bf16_f32 v115, v74, v75
    v_exp_f32 v76, v76
    v_exp_f32 v77, v77
    v_exp_f32 v78, v78
    v_exp_f32 v79, v79
    v_mfma_f32_32x32x16_bf16 v[36:51], v[96:99], v[112:115], v[36:51]
    v_cvt_pk_bf16_f32 v116, v76, v77
    v_cvt_pk_bf16_f32 v117, v78, v79
    v_exp_f32 v80, v80
    v_exp_f32 v81, v81
    v_exp_f32 v82, v82
    v_exp_f32 v83, v83
    v_cvt_pk_bf16_f32 v118, v80, v81
    v_cvt_pk_bf16_f32 v119, v82, v83
    v_mfma_f32_32x32x16_bf16 v[68:83], v[90:93], v[14:17], 0
    v_exp_f32 v52, v52
    v_exp_f32 v53, v53
    v_exp_f32 v54, v54
    v_exp_f32 v55, v55
    v_mfma_f32_32x32x8_bf16 v[68:83], v[94:95], v[18:19], v[68:83]
    v_cvt_pk_bf16_f32 v112, v52, v53
    v_cvt_pk_bf16_f32 v113, v54, v55
    v_exp_f32 v56, v56
    v_exp_f32 v57, v57
    v_exp_f32 v58, v58
    v_exp_f32 v59, v59
    v_mfma_f32_32x32x16_bf16 v[36:51], v[100:103], v[116:119], v[36:51]
    s_waitcnt vmcnt(0)
    s_barrier
    ds_read_b64 v[84:85], v125 offset:22880
    ds_read_b64 v[86:87], v125 offset:24960
    ds_read_b64 v[88:89], v126 offset:22880
    s_setprio 3
    v_cvt_pk_bf16_f32 v114, v56, v57
    v_cvt_pk_bf16_f32 v115, v58, v59
    v_exp_f32 v60, v60
    v_exp_f32 v61, v61
    v_exp_f32 v62, v62
    v_exp_f32 v63, v63
    s_waitcnt lgkmcnt(3)
    v_mfma_f32_32x32x16_bf16 v[20:35], v[104:107], v[112:115], v[20:35]
    v_cvt_pk_bf16_f32 v116, v60, v61
    v_cvt_pk_bf16_f32 v117, v62, v63
    v_exp_f32 v64, v64
    v_exp_f32 v65, v65
    v_exp_f32 v66, v66
    v_exp_f32 v67, v67
    v_cvt_pk_bf16_f32 v118, v64, v65
    v_cvt_pk_bf16_f32 v119, v66, v67
    s_waitcnt lgkmcnt(0)
    v_mfma_f32_32x32x16_bf16 v[52:67], v[84:87], v[8:11], 0
    v_exp_f32 v68, v68
    v_exp_f32 v69, v69
    v_exp_f32 v70, v70
    v_exp_f32 v71, v71
    v_mfma_f32_32x32x8_bf16 v[52:67], v[88:89], v[12:13], v[52:67]
    v_cvt_pk_bf16_f32 v112, v68, v69
    v_cvt_pk_bf16_f32 v113, v70, v71
    v_exp_f32 v72, v72
    v_exp_f32 v73, v73
    v_exp_f32 v74, v74
    v_exp_f32 v75, v75
    v_mfma_f32_32x32x16_bf16 v[20:35], v[108:111], v[116:119], v[20:35]
    ds_read_b64_tr_b16 v[96:97], v127 offset:22880
    ds_read_b64_tr_b16 v[98:99], v127 offset:22944
    ds_read_b64_tr_b16 v[100:101], v127 offset:23008
    ds_read_b64_tr_b16 v[102:103], v127 offset:23072
    s_add_u32 m0, s19, 45760
    s_add_u32 s68, s16, 10240
    buffer_load_dwordx4 v123, s[56:59], s68 offen sc1 lds
    v_cvt_pk_bf16_f32 v114, v72, v73
    v_cvt_pk_bf16_f32 v115, v74, v75
    v_exp_f32 v76, v76
    v_exp_f32 v77, v77
    v_exp_f32 v78, v78
    v_exp_f32 v79, v79
    v_mfma_f32_32x32x16_bf16 v[36:51], v[104:107], v[112:115], v[36:51]
    v_cvt_pk_bf16_f32 v116, v76, v77
    v_cvt_pk_bf16_f32 v117, v78, v79
    v_exp_f32 v80, v80
    v_exp_f32 v81, v81
    v_exp_f32 v82, v82
    v_exp_f32 v83, v83
    v_cvt_pk_bf16_f32 v118, v80, v81
    v_cvt_pk_bf16_f32 v119, v82, v83
    v_mfma_f32_32x32x16_bf16 v[68:83], v[84:87], v[14:17], 0
    v_exp_f32 v52, v52
    v_exp_f32 v53, v53
    v_exp_f32 v54, v54
    v_exp_f32 v55, v55
    v_mfma_f32_32x32x8_bf16 v[68:83], v[88:89], v[18:19], v[68:83]
    v_cvt_pk_bf16_f32 v112, v52, v53
    v_cvt_pk_bf16_f32 v113, v54, v55
    v_exp_f32 v56, v56
    v_exp_f32 v57, v57
    v_exp_f32 v58, v58
    v_exp_f32 v59, v59
    v_mfma_f32_32x32x16_bf16 v[36:51], v[108:111], v[116:119], v[36:51]
    ds_read_b64 v[90:91], v125 offset:23136
    ds_read_b64 v[92:93], v125 offset:25216
    ds_read_b64 v[94:95], v126 offset:23136
    s_add_u32 m0, s20, 45760
    s_add_u32 s68, s17, 10240
    buffer_load_dwordx4 v123, s[56:59], s68 offen sc1 lds
    s_setprio 2
    v_cvt_pk_bf16_f32 v114, v56, v57
    v_cvt_pk_bf16_f32 v115, v58, v59
    v_exp_f32 v60, v60
    v_exp_f32 v61, v61
    v_exp_f32 v62, v62
    v_exp_f32 v63, v63
    s_waitcnt lgkmcnt(3)
    v_mfma_f32_32x32x16_bf16 v[20:35], v[96:99], v[112:115], v[20:35]
    v_cvt_pk_bf16_f32 v116, v60, v61
    v_cvt_pk_bf16_f32 v117, v62, v63
    v_exp_f32 v64, v64
    v_exp_f32 v65, v65
    v_exp_f32 v66, v66
    v_exp_f32 v67, v67
    v_cvt_pk_bf16_f32 v118, v64, v65
    v_cvt_pk_bf16_f32 v119, v66, v67
    s_waitcnt lgkmcnt(0)
    v_mfma_f32_32x32x16_bf16 v[52:67], v[90:93], v[8:11], 0
    v_exp_f32 v68, v68
    v_exp_f32 v69, v69
    v_exp_f32 v70, v70
    v_exp_f32 v71, v71
    v_mfma_f32_32x32x8_bf16 v[52:67], v[94:95], v[12:13], v[52:67]
    v_cvt_pk_bf16_f32 v112, v68, v69
    v_cvt_pk_bf16_f32 v113, v70, v71
    v_exp_f32 v72, v72
    v_exp_f32 v73, v73
    v_exp_f32 v74, v74
    v_exp_f32 v75, v75
    v_mfma_f32_32x32x16_bf16 v[20:35], v[100:103], v[116:119], v[20:35]
    ds_read_b64_tr_b16 v[104:105], v127 offset:23136
    ds_read_b64_tr_b16 v[106:107], v127 offset:23200
    ds_read_b64_tr_b16 v[108:109], v127 offset:23264
    ds_read_b64_tr_b16 v[110:111], v127 offset:23328
    s_cbranch_vccz D3_15
    s_add_u32 m0, s21, 45760
    s_add_u32 s68, s18, 10240
    buffer_load_dwordx4 v123, s[56:59], s68 offen sc1 lds
D3_15:
    v_cvt_pk_bf16_f32 v114, v72, v73
    v_cvt_pk_bf16_f32 v115, v74, v75
    v_exp_f32 v76, v76
    v_exp_f32 v77, v77
    v_exp_f32 v78, v78
    v_exp_f32 v79, v79
    v_mfma_f32_32x32x16_bf16 v[36:51], v[96:99], v[112:115], v[36:51]
    v_cvt_pk_bf16_f32 v116, v76, v77
    v_cvt_pk_bf16_f32 v117, v78, v79
    v_exp_f32 v80, v80
    v_exp_f32 v81, v81
    v_exp_f32 v82, v82
    v_exp_f32 v83, v83
    v_cvt_pk_bf16_f32 v118, v80, v81
    v_cvt_pk_bf16_f32 v119, v82, v83
    v_mfma_f32_32x32x16_bf16 v[68:83], v[90:93], v[14:17], 0
    v_exp_f32 v52, v52
    v_exp_f32 v53, v53
    v_exp_f32 v54, v54
    v_exp_f32 v55, v55
    v_mfma_f32_32x32x8_bf16 v[68:83], v[94:95], v[18:19], v[68:83]
    v_cvt_pk_bf16_f32 v112, v52, v53
    v_cvt_pk_bf16_f32 v113, v54, v55
    v_exp_f32 v56, v56
    v_exp_f32 v57, v57
    v_exp_f32 v58, v58
    v_exp_f32 v59, v59
    v_mfma_f32_32x32x16_bf16 v[36:51], v[100:103], v[116:119], v[36:51]
    ds_read_b64 v[84:85], v125 offset:23392
    ds_read_b64 v[86:87], v125 offset:25472
    ds_read_b64 v[88:89], v126 offset:23392
    s_setprio 1
    v_cvt_pk_bf16_f32 v114, v56, v57
    v_cvt_pk_bf16_f32 v115, v58, v59
    v_exp_f32 v60, v60
    v_exp_f32 v61, v61
    v_exp_f32 v62, v62
    v_exp_f32 v63, v63
    s_waitcnt lgkmcnt(3)
    v_mfma_f32_32x32x16_bf16 v[20:35], v[104:107], v[112:115], v[20:35]
    v_cvt_pk_bf16_f32 v116, v60, v61
    v_cvt_pk_bf16_f32 v117, v62, v63
    v_exp_f32 v64, v64
    v_exp_f32 v65, v65
    v_exp_f32 v66, v66
    v_exp_f32 v67, v67
    v_cvt_pk_bf16_f32 v118, v64, v65
    v_cvt_pk_bf16_f32 v119, v66, v67
    s_waitcnt lgkmcnt(0)
    v_mfma_f32_32x32x16_bf16 v[52:67], v[84:87], v[8:11], 0
    v_exp_f32 v68, v68
    v_exp_f32 v69, v69
    v_exp_f32 v70, v70
    v_exp_f32 v71, v71
    v_mfma_f32_32x32x8_bf16 v[52:67], v[88:89], v[12:13], v[52:67]
    v_cvt_pk_bf16_f32 v112, v68, v69
    v_cvt_pk_bf16_f32 v113, v70, v71
    v_exp_f32 v72, v72
    v_exp_f32 v73, v73
    v_exp_f32 v74, v74
    v_exp_f32 v75, v75
    v_mfma_f32_32x32x16_bf16 v[20:35], v[108:111], v[116:119], v[20:35]
    ds_read_b64_tr_b16 v[96:97], v127 offset:23392
    ds_read_b64_tr_b16 v[98:99], v127 offset:23456
    ds_read_b64_tr_b16 v[100:101], v127 offset:23520
    ds_read_b64_tr_b16 v[102:103], v127 offset:23584
    v_cvt_pk_bf16_f32 v114, v72, v73
    v_cvt_pk_bf16_f32 v115, v74, v75
    v_exp_f32 v76, v76
    v_exp_f32 v77, v77
    v_exp_f32 v78, v78
    v_exp_f32 v79, v79
    v_mfma_f32_32x32x16_bf16 v[36:51], v[104:107], v[112:115], v[36:51]
    v_cvt_pk_bf16_f32 v116, v76, v77
    v_cvt_pk_bf16_f32 v117, v78, v79
    v_exp_f32 v80, v80
    v_exp_f32 v81, v81
    v_exp_f32 v82, v82
    v_exp_f32 v83, v83
    v_cvt_pk_bf16_f32 v118, v80, v81
    v_cvt_pk_bf16_f32 v119, v82, v83
    v_mfma_f32_32x32x16_bf16 v[68:83], v[84:87], v[14:17], 0
    v_exp_f32 v52, v52
    v_exp_f32 v53, v53
    v_exp_f32 v54, v54
    v_exp_f32 v55, v55
    v_mfma_f32_32x32x8_bf16 v[68:83], v[88:89], v[18:19], v[68:83]
    v_cvt_pk_bf16_f32 v112, v52, v53
    v_cvt_pk_bf16_f32 v113, v54, v55
    v_exp_f32 v56, v56
    v_exp_f32 v57, v57
    v_exp_f32 v58, v58
    v_exp_f32 v59, v59
    v_mfma_f32_32x32x16_bf16 v[36:51], v[108:111], v[116:119], v[36:51]
    ds_read_b64 v[90:91], v125 offset:23648
    ds_read_b64 v[92:93], v125 offset:25728
    ds_read_b64 v[94:95], v126 offset:23648
    s_setprio 0
    v_cvt_pk_bf16_f32 v114, v56, v57
    v_cvt_pk_bf16_f32 v115, v58, v59
    v_exp_f32 v60, v60
    v_exp_f32 v61, v61
    v_exp_f32 v62, v62
    v_exp_f32 v63, v63
    s_waitcnt lgkmcnt(3)
    v_mfma_f32_32x32x16_bf16 v[20:35], v[96:99], v[112:115], v[20:35]
    v_cvt_pk_bf16_f32 v116, v60, v61
    v_cvt_pk_bf16_f32 v117, v62, v63
    v_exp_f32 v64, v64
    v_exp_f32 v65, v65
    v_exp_f32 v66, v66
    v_exp_f32 v67, v67
    v_cvt_pk_bf16_f32 v118, v64, v65
    v_cvt_pk_bf16_f32 v119, v66, v67
    s_waitcnt lgkmcnt(0)
    v_mfma_f32_32x32x16_bf16 v[52:67], v[90:93], v[8:11], 0
    v_exp_f32 v68, v68
    v_exp_f32 v69, v69
    v_exp_f32 v70, v70
    v_exp_f32 v71, v71
    v_mfma_f32_32x32x8_bf16 v[52:67], v[94:95], v[12:13], v[52:67]
    v_cvt_pk_bf16_f32 v112, v68, v69
    v_cvt_pk_bf16_f32 v113, v70, v71
    v_exp_f32 v72, v72
    v_exp_f32 v73, v73
    v_exp_f32 v74, v74
    v_exp_f32 v75, v75
    v_mfma_f32_32x32x16_bf16 v[20:35], v[100:103], v[116:119], v[20:35]
    ds_read_b64_tr_b16 v[104:105], v127 offset:23648
    ds_read_b64_tr_b16 v[106:107], v127 offset:23712
    ds_read_b64_tr_b16 v[108:109], v127 offset:23776
    ds_read_b64_tr_b16 v[110:111], v127 offset:23840
    v_cvt_pk_bf16_f32 v114, v72, v73
    v_cvt_pk_bf16_f32 v115, v74, v75
    v_exp_f32 v76, v76
    v_exp_f32 v77, v77
    v_exp_f32 v78, v78
    v_exp_f32 v79, v79
    v_mfma_f32_32x32x16_bf16 v[36:51], v[96:99], v[112:115], v[36:51]
    v_cvt_pk_bf16_f32 v116, v76, v77
    v_cvt_pk_bf16_f32 v117, v78, v79
    v_exp_f32 v80, v80
    v_exp_f32 v81, v81
    v_exp_f32 v82, v82
    v_exp_f32 v83, v83
    v_cvt_pk_bf16_f32 v118, v80, v81
    v_cvt_pk_bf16_f32 v119, v82, v83
    v_mfma_f32_32x32x16_bf16 v[68:83], v[90:93], v[14:17], 0
    v_exp_f32 v52, v52
    v_exp_f32 v53, v53
    v_exp_f32 v54, v54
    v_exp_f32 v55, v55
    v_mfma_f32_32x32x8_bf16 v[68:83], v[94:95], v[18:19], v[68:83]
    v_cvt_pk_bf16_f32 v112, v52, v53
    v_cvt_pk_bf16_f32 v113, v54, v55
    v_exp_f32 v56, v56
    v_exp_f32 v57, v57
    v_exp_f32 v58, v58
    v_exp_f32 v59, v59
    v_mfma_f32_32x32x16_bf16 v[36:51], v[100:103], v[116:119], v[36:51]
    s_waitcnt vmcnt(0)
    s_barrier
    ds_read_b64 v[84:85], v125 offset:45760
    ds_read_b64 v[86:87], v125 offset:47840
    ds_read_b64 v[88:89], v126 offset:45760
    s_setprio 3
    v_cvt_pk_bf16_f32 v114, v56, v57
    v_cvt_pk_bf16_f32 v115, v58, v59
    v_exp_f32 v60, v60
    v_exp_f32 v61, v61
    v_exp_f32 v62, v62
    v_exp_f32 v63, v63
    s_waitcnt lgkmcnt(3)
    v_mfma_f32_32x32x16_bf16 v[20:35], v[104:107], v[112:115], v[20:35]
    v_cvt_pk_bf16_f32 v116, v60, v61
    v_cvt_pk_bf16_f32 v117, v62, v63
    v_exp_f32 v64, v64
    v_exp_f32 v65, v65
    v_exp_f32 v66, v66
    v_exp_f32 v67, v67
    v_cvt_pk_bf16_f32 v118, v64, v65
    v_cvt_pk_bf16_f32 v119, v66, v67
    s_waitcnt lgkmcnt(0)
    v_mfma_f32_32x32x16_bf16 v[52:67], v[84:87], v[8:11], 0
    v_exp_f32 v68, v68
    v_exp_f32 v69, v69
    v_exp_f32 v70, v70
    v_exp_f32 v71, v71
    v_mfma_f32_32x32x8_bf16 v[52:67], v[88:89], v[12:13], v[52:67]
    v_cvt_pk_bf16_f32 v112, v68, v69
    v_cvt_pk_bf16_f32 v113, v70, v71
    v_exp_f32 v72, v72
    v_exp_f32 v73, v73
    v_exp_f32 v74, v74
    v_exp_f32 v75, v75
    v_mfma_f32_32x32x16_bf16 v[20:35], v[108:111], v[116:119], v[20:35]
    ds_read_b64_tr_b16 v[96:97], v127 offset:45760
    ds_read_b64_tr_b16 v[98:99], v127 offset:45824
    ds_read_b64_tr_b16 v[100:101], v127 offset:45888
    ds_read_b64_tr_b16 v[102:103], v127 offset:45952
    s_add_u32 m0, s19, 0
    s_add_u32 s68, s16, 12288
    buffer_load_dwordx4 v123, s[56:59], s68 offen sc1 lds
    v_cvt_pk_bf16_f32 v114, v72, v73
    v_cvt_pk_bf16_f32 v115, v74, v75
    v_exp_f32 v76, v76
    v_exp_f32 v77, v77
    v_exp_f32 v78, v78
    v_exp_f32 v79, v79
    v_mfma_f32_32x32x16_bf16 v[36:51], v[104:107], v[112:115], v[36:51]
    v_cvt_pk_bf16_f32 v116, v76, v77
    v_cvt_pk_bf16_f32 v117, v78, v79
    v_exp_f32 v80, v80
    v_exp_f32 v81, v81
    v_exp_f32 v82, v82
    v_exp_f32 v83, v83
    v_cvt_pk_bf16_f32 v118, v80, v81
    v_cvt_pk_bf16_f32 v119, v82, v83
    v_mfma_f32_32x32x16_bf16 v[68:83], v[84:87], v[14:17], 0
    v_exp_f32 v52, v52
    v_exp_f32 v53, v53
    v_exp_f32 v54, v54
    v_exp_f32 v55, v55
    v_mfma_f32_32x32x8_bf16 v[68:83], v[88:89], v[18:19], v[68:83]
    v_cvt_pk_bf16_f32 v112, v52, v53
    v_cvt_pk_bf16_f32 v113, v54, v55
    v_exp_f32 v56, v56
    v_exp_f32 v57, v57
    v_exp_f32 v58, v58
    v_exp_f32 v59, v59
    v_mfma_f32_32x32x16_bf16 v[36:51], v[108:111], v[116:119], v[36:51]
    ds_read_b64 v[90:91], v125 offset:46016
    ds_read_b64 v[92:93], v125 offset:48096
    ds_read_b64 v[94:95], v126 offset:46016
    s_add_u32 m0, s20, 0
    s_add_u32 s68, s17, 12288
    buffer_load_dwordx4 v123, s[56:59], s68 offen sc1 lds
    s_setprio 2
    v_cvt_pk_bf16_f32 v114, v56, v57
    v_cvt_pk_bf16_f32 v115, v58, v59
    v_exp_f32 v60, v60
    v_exp_f32 v61, v61
    v_exp_f32 v62, v62
    v_exp_f32 v63, v63
    s_waitcnt lgkmcnt(3)
    v_mfma_f32_32x32x16_bf16 v[20:35], v[96:99], v[112:115], v[20:35]
    v_cvt_pk_bf16_f32 v116, v60, v61
    v_cvt_pk_bf16_f32 v117, v62, v63
    v_exp_f32 v64, v64
    v_exp_f32 v65, v65
    v_exp_f32 v66, v66
    v_exp_f32 v67, v67
    v_cvt_pk_bf16_f32 v118, v64, v65
    v_cvt_pk_bf16_f32 v119, v66, v67
    s_waitcnt lgkmcnt(0)
    v_mfma_f32_32x32x16_bf16 v[52:67], v[90:93], v[8:11], 0
    v_exp_f32 v68, v68
    v_exp_f32 v69, v69
    v_exp_f32 v70, v70
    v_exp_f32 v71, v71
    v_mfma_f32_32x32x8_bf16 v[52:67], v[94:95], v[12:13], v[52:67]
    v_cvt_pk_bf16_f32 v112, v68, v69
    v_cvt_pk_bf16_f32 v113, v70, v71
    v_exp_f32 v72, v72
    v_exp_f32 v73, v73
    v_exp_f32 v74, v74
    v_exp_f32 v75, v75
    v_mfma_f32_32x32x16_bf16 v[20:35], v[100:103], v[116:119], v[20:35]
    ds_read_b64_tr_b16 v[104:105], v127 offset:46016
    ds_read_b64_tr_b16 v[106:107], v127 offset:46080
    ds_read_b64_tr_b16 v[108:109], v127 offset:46144
    ds_read_b64_tr_b16 v[110:111], v127 offset:46208
    s_cbranch_vccz D3_16
    s_add_u32 m0, s21, 0
    s_add_u32 s68, s18, 12288
    buffer_load_dwordx4 v123, s[56:59], s68 offen sc1 lds
D3_16:
    v_cvt_pk_bf16_f32 v114, v72, v73
    v_cvt_pk_bf16_f32 v115, v74, v75
    v_exp_f32 v76, v76
    v_exp_f32 v77, v77
    v_exp_f32 v78, v78
    v_exp_f32 v79, v79
    v_mfma_f32_32x32x16_bf16 v[36:51], v[96:99], v[112:115], v[36:51]
    v_cvt_pk_bf16_f32 v116, v76, v77
    v_cvt_pk_bf16_f32 v117, v78, v79
    v_exp_f32 v80, v80
    v_exp_f32 v81, v81
    v_exp_f32 v82, v82
    v_exp_f32 v83, v83
    v_cvt_pk_bf16_f32 v118, v80, v81
    v_cvt_pk_bf16_f32 v119, v82, v83
    v_mfma_f32_32x32x16_bf16 v[68:83], v[90:93], v[14:17], 0
    v_exp_f32 v52, v52
    v_exp_f32 v53, v53
    v_exp_f32 v54, v54
    v_exp_f32 v55, v55
    v_mfma_f32_32x32x8_bf16 v[68:83], v[94:95], v[18:19], v[68:83]
    v_cvt_pk_bf16_f32 v112, v52, v53
    v_cvt_pk_bf16_f32 v113, v54, v55
    v_exp_f32 v56, v56
    v_exp_f32 v57, v57
    v_exp_f32 v58, v58
    v_exp_f32 v59, v59
    v_mfma_f32_32x32x16_bf16 v[36:51], v[100:103], v[116:119], v[36:51]
    ds_read_b64 v[84:85], v125 offset:46272
    ds_read_b64 v[86:87], v125 offset:48352
    ds_read_b64 v[88:89], v126 offset:46272
    s_setprio 1
    v_cvt_pk_bf16_f32 v114, v56, v57
    v_cvt_pk_bf16_f32 v115, v58, v59
    v_exp_f32 v60, v60
    v_exp_f32 v61, v61
    v_exp_f32 v62, v62
    v_exp_f32 v63, v63
    s_waitcnt lgkmcnt(3)
    v_mfma_f32_32x32x16_bf16 v[20:35], v[104:107], v[112:115], v[20:35]
    v_cvt_pk_bf16_f32 v116, v60, v61
    v_cvt_pk_bf16_f32 v117, v62, v63
    v_exp_f32 v64, v64
    v_exp_f32 v65, v65
    v_exp_f32 v66, v66
    v_exp_f32 v67, v67
    v_cvt_pk_bf16_f32 v118, v64, v65
    v_cvt_pk_bf16_f32 v119, v66, v67
    s_waitcnt lgkmcnt(0)
    v_mfma_f32_32x32x16_bf16 v[52:67], v[84:87], v[8:11], 0
    v_exp_f32 v68, v68
    v_exp_f32 v69, v69
    v_exp_f32 v70, v70
    v_exp_f32 v71, v71
    v_mfma_f32_32x32x8_bf16 v[52:67], v[88:89], v[12:13], v[52:67]
    v_cvt_pk_bf16_f32 v112, v68, v69
    v_cvt_pk_bf16_f32 v113, v70, v71
    v_exp_f32 v72, v72
    v_exp_f32 v73, v73
    v_exp_f32 v74, v74
    v_exp_f32 v75, v75
    v_mfma_f32_32x32x16_bf16 v[20:35], v[108:111], v[116:119], v[20:35]
    ds_read_b64_tr_b16 v[96:97], v127 offset:46272
    ds_read_b64_tr_b16 v[98:99], v127 offset:46336
    ds_read_b64_tr_b16 v[100:101], v127 offset:46400
    ds_read_b64_tr_b16 v[102:103], v127 offset:46464
    v_cvt_pk_bf16_f32 v114, v72, v73
    v_cvt_pk_bf16_f32 v115, v74, v75
    v_exp_f32 v76, v76
    v_exp_f32 v77, v77
    v_exp_f32 v78, v78
    v_exp_f32 v79, v79
    v_mfma_f32_32x32x16_bf16 v[36:51], v[104:107], v[112:115], v[36:51]
    v_cvt_pk_bf16_f32 v116, v76, v77
    v_cvt_pk_bf16_f32 v117, v78, v79
    v_exp_f32 v80, v80
    v_exp_f32 v81, v81
    v_exp_f32 v82, v82
    v_exp_f32 v83, v83
    v_cvt_pk_bf16_f32 v118, v80, v81
    v_cvt_pk_bf16_f32 v119, v82, v83
    v_mfma_f32_32x32x16_bf16 v[68:83], v[84:87], v[14:17], 0
    v_exp_f32 v52, v52
    v_exp_f32 v53, v53
    v_exp_f32 v54, v54
    v_exp_f32 v55, v55
    v_mfma_f32_32x32x8_bf16 v[68:83], v[88:89], v[18:19], v[68:83]
    v_cvt_pk_bf16_f32 v112, v52, v53
    v_cvt_pk_bf16_f32 v113, v54, v55
    v_exp_f32 v56, v56
    v_exp_f32 v57, v57
    v_exp_f32 v58, v58
    v_exp_f32 v59, v59
    v_mfma_f32_32x32x16_bf16 v[36:51], v[108:111], v[116:119], v[36:51]
    ds_read_b64 v[90:91], v125 offset:46528
    ds_read_b64 v[92:93], v125 offset:48608
    ds_read_b64 v[94:95], v126 offset:46528
    s_setprio 0
    v_cvt_pk_bf16_f32 v114, v56, v57
    v_cvt_pk_bf16_f32 v115, v58, v59
    v_exp_f32 v60, v60
    v_exp_f32 v61, v61
    v_exp_f32 v62, v62
    v_exp_f32 v63, v63
    s_waitcnt lgkmcnt(3)
    v_mfma_f32_32x32x16_bf16 v[20:35], v[96:99], v[112:115], v[20:35]
    v_cvt_pk_bf16_f32 v116, v60, v61
    v_cvt_pk_bf16_f32 v117, v62, v63
    v_exp_f32 v64, v64
    v_exp_f32 v65, v65
    v_exp_f32 v66, v66
    v_exp_f32 v67, v67
    v_cvt_pk_bf16_f32 v118, v64, v65
    v_cvt_pk_bf16_f32 v119, v66, v67
    s_waitcnt lgkmcnt(0)
    v_mfma_f32_32x32x16_bf16 v[52:67], v[90:93], v[8:11], 0
    v_exp_f32 v68, v68
    v_exp_f32 v69, v69
    v_exp_f32 v70, v70
    v_exp_f32 v71, v71
    v_mfma_f32_32x32x8_bf16 v[52:67], v[94:95], v[12:13], v[52:67]
    v_cvt_pk_bf16_f32 v112, v68, v69
    v_cvt_pk_bf16_f32 v113, v70, v71
    v_exp_f32 v72, v72
    v_exp_f32 v73, v73
    v_exp_f32 v74, v74
    v_exp_f32 v75, v75
    v_mfma_f32_32x32x16_bf16 v[20:35], v[100:103], v[116:119], v[20:35]
    ds_read_b64_tr_b16 v[104:105], v127 offset:46528
    ds_read_b64_tr_b16 v[106:107], v127 offset:46592
    ds_read_b64_tr_b16 v[108:109], v127 offset:46656
    ds_read_b64_tr_b16 v[110:111], v127 offset:46720
    v_cvt_pk_bf16_f32 v114, v72, v73
    v_cvt_pk_bf16_f32 v115, v74, v75
    v_exp_f32 v76, v76
    v_exp_f32 v77, v77
    v_exp_f32 v78, v78
    v_exp_f32 v79, v79
    v_mfma_f32_32x32x16_bf16 v[36:51], v[96:99], v[112:115], v[36:51]
    v_cvt_pk_bf16_f32 v116, v76, v77
    v_cvt_pk_bf16_f32 v117, v78, v79
    v_exp_f32 v80, v80
    v_exp_f32 v81, v81
    v_exp_f32 v82, v82
    v_exp_f32 v83, v83
    v_cvt_pk_bf16_f32 v118, v80, v81
    v_cvt_pk_bf16_f32 v119, v82, v83
    v_mfma_f32_32x32x16_bf16 v[68:83], v[90:93], v[14:17], 0
    v_exp_f32 v52, v52
    v_exp_f32 v53, v53
    v_exp_f32 v54, v54
    v_exp_f32 v55, v55
    v_mfma_f32_32x32x8_bf16 v[68:83], v[94:95], v[18:19], v[68:83]
    v_cvt_pk_bf16_f32 v112, v52, v53
    v_cvt_pk_bf16_f32 v113, v54, v55
    v_exp_f32 v56, v56
    v_exp_f32 v57, v57
    v_exp_f32 v58, v58
    v_exp_f32 v59, v59
    v_mfma_f32_32x32x16_bf16 v[36:51], v[100:103], v[116:119], v[36:51]
    s_waitcnt vmcnt(0)
    s_barrier
    ds_read_b64 v[84:85], v125 offset:0
    ds_read_b64 v[86:87], v125 offset:2080
    ds_read_b64 v[88:89], v126 offset:0
    s_cmp_lg_u32 s40, 7
    s_cbranch_scc1 FS_17
    v_mov_b32 v6, s6
    v_mov_b32 v7, s7
    s_mov_b64 exec, 1
    buffer_store_dwordx2 v[6:7], off, s[56:59], s28 sc1
    s_mov_b64 exec, -1
FS_17:
    s_setprio 3
    v_cvt_pk_bf16_f32 v114, v56, v57
    v_cvt_pk_bf16_f32 v115, v58, v59
    v_exp_f32 v60, v60
    v_exp_f32 v61, v61
    v_exp_f32 v62, v62
    v_exp_f32 v63, v63
    s_waitcnt lgkmcnt(3)
    v_mfma_f32_32x32x16_bf16 v[20:35], v[104:107], v[112:115], v[20:35]
    v_cvt_pk_bf16_f32 v116, v60, v61
    v_cvt_pk_bf16_f32 v117, v62, v63
    v_exp_f32 v64, v64
    v_exp_f32 v65, v65
    v_exp_f32 v66, v66
    v_exp_f32 v67, v67
    v_cvt_pk_bf16_f32 v118, v64, v65
    v_cvt_pk_bf16_f32 v119, v66, v67
    s_waitcnt lgkmcnt(0)
    v_mfma_f32_32x32x16_bf16 v[52:67], v[84:87], v[8:11], 0
    v_exp_f32 v68, v68
    v_exp_f32 v69, v69
    v_exp_f32 v70, v70
    v_exp_f32 v71, v71
    v_mfma_f32_32x32x8_bf16 v[52:67], v[88:89], v[12:13], v[52:67]
    v_cvt_pk_bf16_f32 v112, v68, v69
    v_cvt_pk_bf16_f32 v113, v70, v71
    v_exp_f32 v72, v72
    v_exp_f32 v73, v73
    v_exp_f32 v74, v74
    v_exp_f32 v75, v75
    v_mfma_f32_32x32x16_bf16 v[20:35], v[108:111], v[116:119], v[20:35]
    ds_read_b64_tr_b16 v[96:97], v127 offset:0
    ds_read_b64_tr_b16 v[98:99], v127 offset:64
    ds_read_b64_tr_b16 v[100:101], v127 offset:128
    ds_read_b64_tr_b16 v[102:103], v127 offset:192
    s_add_u32 m0, s19, 22880
    s_add_u32 s68, s16, 14336
    buffer_load_dwordx4 v123, s[56:59], s68 offen sc1 lds
    v_cvt_pk_bf16_f32 v114, v72, v73
    v_cvt_pk_bf16_f32 v115, v74, v75
    v_exp_f32 v76, v76
    v_exp_f32 v77, v77
    v_exp_f32 v78, v78
    v_exp_f32 v79, v79
    v_mfma_f32_32x32x16_bf16 v[36:51], v[104:107], v[112:115], v[36:51]
    v_cvt_pk_bf16_f32 v116, v76, v77
    v_cvt_pk_bf16_f32 v117, v78, v79
    v_exp_f32 v80, v80
    v_exp_f32 v81, v81
    v_exp_f32 v82, v82
    v_exp_f32 v83, v83
    v_cvt_pk_bf16_f32 v118, v80, v81
    v_cvt_pk_bf16_f32 v119, v82, v83
    v_mfma_f32_32x32x16_bf16 v[68:83], v[84:87], v[14:17], 0
    v_exp_f32 v52, v52
    v_exp_f32 v53, v53
    v_exp_f32 v54, v54
    v_exp_f32 v55, v55
    v_mfma_f32_32x32x8_bf16 v[68:83], v[88:89], v[18:19], v[68:83]
    v_cvt_pk_bf16_f32 v112, v52, v53
    v_cvt_pk_bf16_f32 v113, v54, v55
    v_exp_f32 v56, v56
    v_exp_f32 v57, v57
    v_exp_f32 v58, v58
    v_exp_f32 v59, v59
    v_mfma_f32_32x32x16_bf16 v[36:51], v[108:111], v[116:119], v[36:51]
    ds_read_b64 v[90:91], v125 offset:256
    ds_read_b64 v[92:93], v125 offset:2336
    ds_read_b64 v[94:95], v126 offset:256
    s_add_u32 m0, s20, 22880
    s_add_u32 s68, s17, 14336
    buffer_load_dwordx4 v123, s[56:59], s68 offen sc1 lds
    s_setprio 2
    v_cvt_pk_bf16_f32 v114, v56, v57
    v_cvt_pk_bf16_f32 v115, v58, v59
    v_exp_f32 v60, v60
    v_exp_f32 v61, v61
    v_exp_f32 v62, v62
    v_exp_f32 v63, v63
    s_waitcnt lgkmcnt(3)
    v_mfma_f32_32x32x16_bf16 v[20:35], v[96:99], v[112:115], v[20:35]
    v_cvt_pk_bf16_f32 v116, v60, v61
    v_cvt_pk_bf16_f32 v117, v62, v63
    v_exp_f32 v64, v64
    v_exp_f32 v65, v65
    v_exp_f32 v66, v66
    v_exp_f32 v67, v67
    v_cvt_pk_bf16_f32 v118, v64, v65
    v_cvt_pk_bf16_f32 v119, v66, v67
    s_waitcnt lgkmcnt(0)
    v_mfma_f32_32x32x16_bf16 v[52:67], v[90:93], v[8:11], 0
    v_exp_f32 v68, v68
    v_exp_f32 v69, v69
    v_exp_f32 v70, v70
    v_exp_f32 v71, v71
    v_mfma_f32_32x32x8_bf16 v[52:67], v[94:95], v[12:13], v[52:67]
    v_cvt_pk_bf16_f32 v112, v68, v69
    v_cvt_pk_bf16_f32 v113, v70, v71
    v_exp_f32 v72, v72
    v_exp_f32 v73, v73
    v_exp_f32 v74, v74
    v_exp_f32 v75, v75
    v_mfma_f32_32x32x16_bf16 v[20:35], v[100:103], v[116:119], v[20:35]
    ds_read_b64_tr_b16 v[104:105], v127 offset:256
    ds_read_b64_tr_b16 v[106:107], v127 offset:320
    ds_read_b64_tr_b16 v[108:109], v127 offset:384
    ds_read_b64_tr_b16 v[110:111], v127 offset:448
    s_cbranch_vccz D3_18
    s_add_u32 m0, s21, 22880
    s_add_u32 s68, s18, 14336
    buffer_load_dwordx4 v123, s[56:59], s68 offen sc1 lds
D3_18:
    v_cvt_pk_bf16_f32 v114, v72, v73
    v_cvt_pk_bf16_f32 v115, v74, v75
    v_exp_f32 v76, v76
    v_exp_f32 v77, v77
    v_exp_f32 v78, v78
    v_exp_f32 v79, v79
    v_mfma_f32_32x32x16_bf16 v[36:51], v[96:99], v[112:115], v[36:51]
    v_cvt_pk_bf16_f32 v116, v76, v77
    v_cvt_pk_bf16_f32 v117, v78, v79
    v_exp_f32 v80, v80
    v_exp_f32 v81, v81
    v_exp_f32 v82, v82
    v_exp_f32 v83, v83
    v_cvt_pk_bf16_f32 v118, v80, v81
    v_cvt_pk_bf16_f32 v119, v82, v83
    v_mfma_f32_32x32x16_bf16 v[68:83], v[90:93], v[14:17], 0
    v_exp_f32 v52, v52
    v_exp_f32 v53, v53
    v_exp_f32 v54, v54
    v_exp_f32 v55, v55
    v_mfma_f32_32x32x8_bf16 v[68:83], v[94:95], v[18:19], v[68:83]
    v_cvt_pk_bf16_f32 v112, v52, v53
    v_cvt_pk_bf16_f32 v113, v54, v55
    v_exp_f32 v56, v56
    v_exp_f32 v57, v57
    v_exp_f32 v58, v58
    v_exp_f32 v59, v59
    v_mfma_f32_32x32x16_bf16 v[36:51], v[100:103], v[116:119], v[36:51]
    ds_read_b64 v[84:85], v125 offset:512
    ds_read_b64 v[86:87], v125 offset:2592
    ds_read_b64 v[88:89], v126 offset:512
    s_setprio 1
    v_cvt_pk_bf16_f32 v114, v56, v57
    v_cvt_pk_bf16_f32 v115, v58, v59
    v_exp_f32 v60, v60
    v_exp_f32 v61, v61
    v_exp_f32 v62, v62
    v_exp_f32 v63, v63
    s_waitcnt lgkmcnt(3)
    v_mfma_f32_32x32x16_bf16 v[20:35], v[104:107], v[112:115], v[20:35]
    v_cvt_pk_bf16_f32 v116, v60, v61
    v_cvt_pk_bf16_f32 v117, v62, v63
    v_exp_f32 v64, v64
    v_exp_f32 v65, v65
    v_exp_f32 v66, v66
    v_exp_f32 v67, v67
    v_cvt_pk_bf16_f32 v118, v64, v65
    v_cvt_pk_bf16_f32 v119, v66, v67
    s_waitcnt lgkmcnt(0)
    v_mfma_f32_32x32x16_bf16 v[52:67], v[84:87], v[8:11], 0
    v_exp_f32 v68, v68
    v_exp_f32 v69, v69
    v_exp_f32 v70, v70
    v_exp_f32 v71, v71
    v_mfma_f32_32x32x8_bf16 v[52:67], v[88:89], v[12:13], v[52:67]
    v_cvt_pk_bf16_f32 v112, v68, v69
    v_cvt_pk_bf16_f32 v113, v70, v71
    v_exp_f32 v72, v72
    v_exp_f32 v73, v73
    v_exp_f32 v74, v74
    v_exp_f32 v75, v75
    v_mfma_f32_32x32x16_bf16 v[20:35], v[108:111], v[116:119], v[20:35]
    ds_read_b64_tr_b16 v[96:97], v127 offset:512
    ds_read_b64_tr_b16 v[98:99], v127 offset:576
    ds_read_b64_tr_b16 v[100:101], v127 offset:640
    ds_read_b64_tr_b16 v[102:103], v127 offset:704
    v_cvt_pk_bf16_f32 v114, v72, v73
    v_cvt_pk_bf16_f32 v115, v74, v75
    v_exp_f32 v76, v76
    v_exp_f32 v77, v77
    v_exp_f32 v78, v78
    v_exp_f32 v79, v79
    v_mfma_f32_32x32x16_bf16 v[36:51], v[104:107], v[112:115], v[36:51]
    v_cvt_pk_bf16_f32 v116, v76, v77
    v_cvt_pk_bf16_f32 v117, v78, v79
    v_exp_f32 v80, v80
    v_exp_f32 v81, v81
    v_exp_f32 v82, v82
    v_exp_f32 v83, v83
    v_cvt_pk_bf16_f32 v118, v80, v81
    v_cvt_pk_bf16_f32 v119, v82, v83
    v_mfma_f32_32x32x16_bf16 v[68:83], v[84:87], v[14:17], 0
    v_exp_f32 v52, v52
    v_exp_f32 v53, v53
    v_exp_f32 v54, v54
    v_exp_f32 v55, v55
    v_mfma_f32_32x32x8_bf16 v[68:83], v[88:89], v[18:19], v[68:83]
    v_cvt_pk_bf16_f32 v112, v52, v53
    v_cvt_pk_bf16_f32 v113, v54, v55
    v_exp_f32 v56, v56
    v_exp_f32 v57, v57
    v_exp_f32 v58, v58
    v_exp_f32 v59, v59
    v_mfma_f32_32x32x16_bf16 v[36:51], v[108:111], v[116:119], v[36:51]
    ds_read_b64 v[90:91], v125 offset:768
    ds_read_b64 v[92:93], v125 offset:2848
    ds_read_b64 v[94:95], v126 offset:768
    s_setprio 0
    v_cvt_pk_bf16_f32 v114, v56, v57
    v_cvt_pk_bf16_f32 v115, v58, v59
    v_exp_f32 v60, v60
    v_exp_f32 v61, v61
    v_exp_f32 v62, v62
    v_exp_f32 v63, v63
    s_waitcnt lgkmcnt(3)
    v_mfma_f32_32x32x16_bf16 v[20:35], v[96:99], v[112:115], v[20:35]
    v_cvt_pk_bf16_f32 v116, v60, v61
    v_cvt_pk_bf16_f32 v117, v62, v63
    v_exp_f32 v64, v64
    v_exp_f32 v65, v65
    v_exp_f32 v66, v66
    v_exp_f32 v67, v67
    v_cvt_pk_bf16_f32 v118, v64, v65
    v_cvt_pk_bf16_f32 v119, v66, v67
    s_waitcnt lgkmcnt(0)
    v_mfma_f32_32x32x16_bf16 v[52:67], v[90:93], v[8:11], 0
    v_exp_f32 v68, v68
    v_exp_f32 v69, v69
    v_exp_f32 v70, v70
    v_exp_f32 v71, v71
    v_mfma_f32_32x32x8_bf16 v[52:67], v[94:95], v[12:13], v[52:67]
    v_cvt_pk_bf16_f32 v112, v68, v69
    v_cvt_pk_bf16_f32 v113, v70, v71
    v_exp_f32 v72, v72
    v_exp_f32 v73, v73
    v_exp_f32 v74, v74
    v_exp_f32 v75, v75
    v_mfma_f32_32x32x16_bf16 v[20:35], v[100:103], v[116:119], v[20:35]
    ds_read_b64_tr_b16 v[104:105], v127 offset:768
    ds_read_b64_tr_b16 v[106:107], v127 offset:832
    ds_read_b64_tr_b16 v[108:109], v127 offset:896
    ds_read_b64_tr_b16 v[110:111], v127 offset:960
    v_cvt_pk_bf16_f32 v114, v72, v73
    v_cvt_pk_bf16_f32 v115, v74, v75
    v_exp_f32 v76, v76
    v_exp_f32 v77, v77
    v_exp_f32 v78, v78
    v_exp_f32 v79, v79
    v_mfma_f32_32x32x16_bf16 v[36:51], v[96:99], v[112:115], v[36:51]
    v_cvt_pk_bf16_f32 v116, v76, v77
    v_cvt_pk_bf16_f32 v117, v78, v79
    v_exp_f32 v80, v80
    v_exp_f32 v81, v81
    v_exp_f32 v82, v82
    v_exp_f32 v83, v83
    v_cvt_pk_bf16_f32 v118, v80, v81
    v_cvt_pk_bf16_f32 v119, v82, v83
    v_mfma_f32_32x32x16_bf16 v[68:83], v[90:93], v[14:17], 0
    v_exp_f32 v52, v52
    v_exp_f32 v53, v53
    v_exp_f32 v54, v54
    v_exp_f32 v55, v55
    v_mfma_f32_32x32x8_bf16 v[68:83], v[94:95], v[18:19], v[68:83]
    v_cvt_pk_bf16_f32 v112, v52, v53
    v_cvt_pk_bf16_f32 v113, v54, v55
    v_exp_f32 v56, v56
    v_exp_f32 v57, v57
    v_exp_f32 v58, v58
    v_exp_f32 v59, v59
    v_mfma_f32_32x32x16_bf16 v[36:51], v[100:103], v[116:119], v[36:51]
    s_waitcnt vmcnt(0)
    s_barrier
    ds_read_b64 v[84:85], v125 offset:22880
    ds_read_b64 v[86:87], v125 offset:24960
    ds_read_b64 v[88:89], v126 offset:22880
    s_setprio 3
    v_cvt_pk_bf16_f32 v114, v56, v57
    v_cvt_pk_bf16_f32 v115, v58, v59
    v_exp_f32 v60, v60
    v_exp_f32 v61, v61
    v_exp_f32 v62, v62
    v_exp_f32 v63, v63
    s_waitcnt lgkmcnt(3)
    v_mfma_f32_32x32x16_bf16 v[20:35], v[104:107], v[112:115], v[20:35]
    v_cvt_pk_bf16_f32 v116, v60, v61
    v_cvt_pk_bf16_f32 v117, v62, v63
    v_exp_f32 v64, v64
    v_exp_f32 v65, v65
    v_exp_f32 v66, v66
    v_exp_f32 v67, v67
    v_cvt_pk_bf16_f32 v118, v64, v65
    v_cvt_pk_bf16_f32 v119, v66, v67
    s_waitcnt lgkmcnt(0)
    v_mfma_f32_32x32x16_bf16 v[52:67], v[84:87], v[8:11], 0
    v_exp_f32 v68, v68
    v_exp_f32 v69, v69
    v_exp_f32 v70, v70
    v_exp_f32 v71, v71
    v_mfma_f32_32x32x8_bf16 v[52:67], v[88:89], v[12:13], v[52:67]
    v_cvt_pk_bf16_f32 v112, v68, v69
    v_cvt_pk_bf16_f32 v113, v70, v71
    v_exp_f32 v72, v72
    v_exp_f32 v73, v73
    v_exp_f32 v74, v74
    v_exp_f32 v75, v75
    v_mfma_f32_32x32x16_bf16 v[20:35], v[108:111], v[116:119], v[20:35]
    ds_read_b64_tr_b16 v[96:97], v127 offset:22880
    ds_read_b64_tr_b16 v[98:99], v127 offset:22944
    ds_read_b64_tr_b16 v[100:101], v127 offset:23008
    ds_read_b64_tr_b16 v[102:103], v127 offset:23072
    v_cvt_pk_bf16_f32 v114, v72, v73
    v_cvt_pk_bf16_f32 v115, v74, v75
    v_exp_f32 v76, v76
    v_exp_f32 v77, v77
    v_exp_f32 v78, v78
    v_exp_f32 v79, v79
    v_mfma_f32_32x32x16_bf16 v[36:51], v[104:107], v[112:115], v[36:51]
    v_cvt_pk_bf16_f32 v116, v76, v77
    v_cvt_pk_bf16_f32 v117, v78, v79
    v_exp_f32 v80, v80
    v_exp_f32 v81, v81
    v_exp_f32 v82, v82
    v_exp_f32 v83, v83
    v_cvt_pk_bf16_f32 v118, v80, v81
    v_cvt_pk_bf16_f32 v119, v82, v83
    v_mfma_f32_32x32x16_bf16 v[68:83], v[84:87], v[14:17], 0
    v_exp_f32 v52, v52
    v_exp_f32 v53, v53
    v_exp_f32 v54, v54
    v_exp_f32 v55, v55
    v_mfma_f32_32x32x8_bf16 v[68:83], v[88:89], v[18:19], v[68:83]
    v_cvt_pk_bf16_f32 v112, v52, v53
    v_cvt_pk_bf16_f32 v113, v54, v55
    v_exp_f32 v56, v56
    v_exp_f32 v57, v57
    v_exp_f32 v58, v58
    v_exp_f32 v59, v59
    v_mfma_f32_32x32x16_bf16 v[36:51], v[108:111], v[116:119], v[36:51]
    ds_read_b64 v[90:91], v125 offset:23136
    ds_read_b64 v[92:93], v125 offset:25216
    ds_read_b64 v[94:95], v126 offset:23136
    v_cvt_pk_bf16_f32 v114, v56, v57
    v_cvt_pk_bf16_f32 v115, v58, v59
    v_exp_f32 v60, v60
    v_exp_f32 v61, v61
    v_exp_f32 v62, v62
    v_exp_f32 v63, v63
    s_waitcnt lgkmcnt(3)
    v_mfma_f32_32x32x16_bf16 v[20:35], v[96:99], v[112:115], v[20:35]
    v_cvt_pk_bf16_f32 v116, v60, v61
    v_cvt_pk_bf16_f32 v117, v62, v63
    v_exp_f32 v64, v64
    v_exp_f32 v65, v65
    v_exp_f32 v66, v66
    v_exp_f32 v67, v67
    v_cvt_pk_bf16_f32 v118, v64, v65
    v_cvt_pk_bf16_f32 v119, v66, v67
    s_waitcnt lgkmcnt(0)
    v_mfma_f32_32x32x16_bf16 v[52:67], v[90:93], v[8:11], 0
    v_exp_f32 v68, v68
    v_exp_f32 v69, v69
    v_exp_f32 v70, v70
    v_exp_f32 v71, v71
    v_mfma_f32_32x32x8_bf16 v[52:67], v[94:95], v[12:13], v[52:67]
    v_cvt_pk_bf16_f32 v112, v68, v69
    v_cvt_pk_bf16_f32 v113, v70, v71
    v_exp_f32 v72, v72
    v_exp_f32 v73, v73
    v_exp_f32 v74, v74
    v_exp_f32 v75, v75
    v_mfma_f32_32x32x16_bf16 v[20:35], v[100:103], v[116:119], v[20:35]
    ds_read_b64_tr_b16 v[104:105], v127 offset:23136
    ds_read_b64_tr_b16 v[106:107], v127 offset:23200
    ds_read_b64_tr_b16 v[108:109], v127 offset:23264
    ds_read_b64_tr_b16 v[110:111], v127 offset:23328
    s_setprio 2
    v_cvt_pk_bf16_f32 v114, v72, v73
    v_cvt_pk_bf16_f32 v115, v74, v75
    v_exp_f32 v76, v76
    v_exp_f32 v77, v77
    v_exp_f32 v78, v78
    v_exp_f32 v79, v79
    v_mfma_f32_32x32x16_bf16 v[36:51], v[96:99], v[112:115], v[36:51]
    v_cvt_pk_bf16_f32 v116, v76, v77
    v_cvt_pk_bf16_f32 v117, v78, v79
    v_exp_f32 v80, v80
    v_exp_f32 v81, v81
    v_exp_f32 v82, v82
    v_exp_f32 v83, v83
    v_cvt_pk_bf16_f32 v118, v80, v81
    v_cvt_pk_bf16_f32 v119, v82, v83
    v_mfma_f32_32x32x16_bf16 v[68:83], v[90:93], v[14:17], 0
    v_exp_f32 v52, v52
    v_exp_f32 v53, v53
    v_exp_f32 v54, v54
    v_exp_f32 v55, v55
    v_mfma_f32_32x32x8_bf16 v[68:83], v[94:95], v[18:19], v[68:83]
    v_cvt_pk_bf16_f32 v112, v52, v53
    v_cvt_pk_bf16_f32 v113, v54, v55
    v_exp_f32 v56, v56
    v_exp_f32 v57, v57
    v_exp_f32 v58, v58
    v_exp_f32 v59, v59
    v_mfma_f32_32x32x16_bf16 v[36:51], v[100:103], v[116:119], v[36:51]
    ds_read_b64 v[84:85], v125 offset:23392
    ds_read_b64 v[86:87], v125 offset:25472
    ds_read_b64 v[88:89], v126 offset:23392
    v_cvt_pk_bf16_f32 v114, v56, v57
    v_cvt_pk_bf16_f32 v115, v58, v59
    v_exp_f32 v60, v60
    v_exp_f32 v61, v61
    v_exp_f32 v62, v62
    v_exp_f32 v63, v63
    s_waitcnt lgkmcnt(3)
    v_mfma_f32_32x32x16_bf16 v[20:35], v[104:107], v[112:115], v[20:35]
    v_cvt_pk_bf16_f32 v116, v60, v61
    v_cvt_pk_bf16_f32 v117, v62, v63
    v_exp_f32 v64, v64
    v_exp_f32 v65, v65
    v_exp_f32 v66, v66
    v_exp_f32 v67, v67
    v_cvt_pk_bf16_f32 v118, v64, v65
    v_cvt_pk_bf16_f32 v119, v66, v67
    s_waitcnt lgkmcnt(0)
    v_mfma_f32_32x32x16_bf16 v[52:67], v[84:87], v[8:11], 0
    v_exp_f32 v68, v68
    v_exp_f32 v69, v69
    v_exp_f32 v70, v70
    v_exp_f32 v71, v71
    v_mfma_f32_32x32x8_bf16 v[52:67], v[88:89], v[12:13], v[52:67]
    v_cvt_pk_bf16_f32 v112, v68, v69
    v_cvt_pk_bf16_f32 v113, v70, v71
    v_exp_f32 v72, v72
    v_exp_f32 v73, v73
    v_exp_f32 v74, v74
    v_exp_f32 v75, v75
    v_mfma_f32_32x32x16_bf16 v[20:35], v[108:111], v[116:119], v[20:35]
    ds_read_b64_tr_b16 v[96:97], v127 offset:23392
    ds_read_b64_tr_b16 v[98:99], v127 offset:23456
    ds_read_b64_tr_b16 v[100:101], v127 offset:23520
    ds_read_b64_tr_b16 v[102:103], v127 offset:23584
    v_cvt_pk_bf16_f32 v114, v72, v73
    v_cvt_pk_bf16_f32 v115, v74, v75
    v_exp_f32 v76, v76
    v_exp_f32 v77, v77
    v_exp_f32 v78, v78
    v_exp_f32 v79, v79
    v_mfma_f32_32x32x16_bf16 v[36:51], v[104:107], v[112:115], v[36:51]
    v_cvt_pk_bf16_f32 v116, v76, v77
    v_cvt_pk_bf16_f32 v117, v78, v79
    v_exp_f32 v80, v80
    v_exp_f32 v81, v81
    v_exp_f32 v82, v82
    v_exp_f32 v83, v83
    v_cvt_pk_bf16_f32 v118, v80, v81
    v_cvt_pk_bf16_f32 v119, v82, v83
    v_mfma_f32_32x32x16_bf16 v[68:83], v[84:87], v[14:17], 0
    v_exp_f32 v52, v52
    v_exp_f32 v53, v53
    v_exp_f32 v54, v54
    v_exp_f32 v55, v55
    v_mfma_f32_32x32x8_bf16 v[68:83], v[88:89], v[18:19], v[68:83]
    v_cvt_pk_bf16_f32 v112, v52, v53
    v_cvt_pk_bf16_f32 v113, v54, v55
    v_exp_f32 v56, v56
    v_exp_f32 v57, v57
    v_exp_f32 v58, v58
    v_exp_f32 v59, v59
    v_mfma_f32_32x32x16_bf16 v[36:51], v[108:111], v[116:119], v[36:51]
    ds_read_b64 v[90:91], v125 offset:23648
    ds_read_b64 v[92:93], v125 offset:25728
    ds_read_b64 v[94:95], v126 offset:23648
    s_setprio 1
    v_cvt_pk_bf16_f32 v114, v56, v57
    v_cvt_pk_bf16_f32 v115, v58, v59
    v_exp_f32 v60, v60
    v_exp_f32 v61, v61
    v_exp_f32 v62, v62
    v_exp_f32 v63, v63
    s_waitcnt lgkmcnt(3)
    v_mfma_f32_32x32x16_bf16 v[20:35], v[96:99], v[112:115], v[20:35]
    v_cvt_pk_bf16_f32 v116, v60, v61
    v_cvt_pk_bf16_f32 v117, v62, v63
    v_exp_f32 v64, v64
    v_exp_f32 v65, v65
    v_exp_f32 v66, v66
    v_exp_f32 v67, v67
    v_cvt_pk_bf16_f32 v118, v64, v65
    v_cvt_pk_bf16_f32 v119, v66, v67
    s_waitcnt lgkmcnt(0)
    v_mfma_f32_32x32x16_bf16 v[52:67], v[90:93], v[8:11], 0
    v_exp_f32 v68, v68
    v_exp_f32 v69, v69
    v_exp_f32 v70, v70
    v_exp_f32 v71, v71
    v_mfma_f32_32x32x8_bf16 v[52:67], v[94:95], v[12:13], v[52:67]
    v_cvt_pk_bf16_f32 v112, v68, v69
    v_cvt_pk_bf16_f32 v113, v70, v71
    v_exp_f32 v72, v72
    v_exp_f32 v73, v73
    v_exp_f32 v74, v74
    v_exp_f32 v75, v75
    v_mfma_f32_32x32x16_bf16 v[20:35], v[100:103], v[116:119], v[20:35]
    ds_read_b64_tr_b16 v[104:105], v127 offset:23648
    ds_read_b64_tr_b16 v[106:107], v127 offset:23712
    ds_read_b64_tr_b16 v[108:109], v127 offset:23776
    ds_read_b64_tr_b16 v[110:111], v127 offset:23840
    v_cvt_pk_bf16_f32 v114, v72, v73
    v_cvt_pk_bf16_f32 v115, v74, v75
    v_exp_f32 v76, v76
    v_exp_f32 v77, v77
    v_exp_f32 v78, v78
    v_exp_f32 v79, v79
    v_mfma_f32_32x32x16_bf16 v[36:51], v[96:99], v[112:115], v[36:51]
    v_cvt_pk_bf16_f32 v116, v76, v77
    v_cvt_pk_bf16_f32 v117, v78, v79
    v_exp_f32 v80, v80
    v_exp_f32 v81, v81
    v_exp_f32 v82, v82
    v_exp_f32 v83, v83
    v_cvt_pk_bf16_f32 v118, v80, v81
    v_cvt_pk_bf16_f32 v119, v82, v83
    v_mfma_f32_32x32x16_bf16 v[68:83], v[90:93], v[14:17], 0
    v_exp_f32 v52, v52
    v_exp_f32 v53, v53
    v_exp_f32 v54, v54
    v_exp_f32 v55, v55
    v_mfma_f32_32x32x8_bf16 v[68:83], v[94:95], v[18:19], v[68:83]
    v_cvt_pk_bf16_f32 v112, v52, v53
    v_cvt_pk_bf16_f32 v113, v54, v55
    v_exp_f32 v56, v56
    v_exp_f32 v57, v57
    v_exp_f32 v58, v58
    v_exp_f32 v59, v59
    v_mfma_f32_32x32x16_bf16 v[36:51], v[100:103], v[116:119], v[36:51]
    s_setprio 0
    v_cvt_pk_bf16_f32 v114, v56, v57
    v_cvt_pk_bf16_f32 v115, v58, v59
    v_exp_f32 v60, v60
    v_exp_f32 v61, v61
    v_exp_f32 v62, v62
    v_exp_f32 v63, v63
    s_waitcnt lgkmcnt(0)
    v_mfma_f32_32x32x16_bf16 v[20:35], v[104:107], v[112:115], v[20:35]
    v_cvt_pk_bf16_f32 v116, v60, v61
    v_cvt_pk_bf16_f32 v117, v62, v63
    v_exp_f32 v64, v64
    v_exp_f32 v65, v65
    v_exp_f32 v66, v66
    v_exp_f32 v67, v67
    v_cvt_pk_bf16_f32 v118, v64, v65
    v_cvt_pk_bf16_f32 v119, v66, v67
    v_exp_f32 v68, v68
    v_exp_f32 v69, v69
    v_exp_f32 v70, v70
    v_exp_f32 v71, v71
    v_cvt_pk_bf16_f32 v112, v68, v69
    v_cvt_pk_bf16_f32 v113, v70, v71
    v_exp_f32 v72, v72
    v_exp_f32 v73, v73
    v_exp_f32 v74, v74
    v_exp_f32 v75, v75
    v_mfma_f32_32x32x16_bf16 v[20:35], v[108:111], v[116:119], v[20:35]
    v_cvt_pk_bf16_f32 v114, v72, v73
    v_cvt_pk_bf16_f32 v115, v74, v75
    v_exp_f32 v76, v76
    v_exp_f32 v77, v77
    v_exp_f32 v78, v78
    v_exp_f32 v79, v79
    v_mfma_f32_32x32x16_bf16 v[36:51], v[104:107], v[112:115], v[36:51]
    v_cvt_pk_bf16_f32 v116, v76, v77
    v_cvt_pk_bf16_f32 v117, v78, v79
    v_exp_f32 v80, v80
    v_exp_f32 v81, v81
    v_exp_f32 v82, v82
    v_exp_f32 v83, v83
    v_cvt_pk_bf16_f32 v118, v80, v81
    v_cvt_pk_bf16_f32 v119, v82, v83
    s_setprio 3
    s_nop 0
    v_mfma_f32_32x32x16_bf16 v[36:51], v[108:111], v[116:119], v[36:51]
    v_mov_b32 v70, 0
    v_mov_b32 v71, 0
    v_mov_b32 v80, 562036736
    v_mov_b32 v81, 1568669696
    v_mov_b32 v83, 81912
    v_lshlrev_b32 v82, 4, v123
    v_mov_b32 v84, s6
    v_mov_b32 v85, s7
    s_nop 3
    ds_write_b128 v2, v[36:39] offset:0
    ds_write_b128 v2, v[40:43] offset:1024
    ds_write_b128 v2, v[44:47] offset:2048
    ds_write_b128 v2, v[48:51] offset:3072
    s_waitcnt lgkmcnt(0)
    s_barrier
    ds_read_b128 v[64:67], v3 offset:3072
    ds_read_b128 v[52:55], v3 offset:0
    ds_read_b128 v[56:59], v3 offset:1024
    ds_read_b128 v[60:63], v3 offset:2048
    s_waitcnt lgkmcnt(3)
    v_add_f32 v32, v32, v64
    v_rcp_f32 v68, v32
    s_waitcnt lgkmcnt(2)
    v_pk_add_f32 v[20:21], v[20:21], v[52:53]
    v_pk_add_f32 v[22:23], v[22:23], v[54:55]
    v_pk_mul_f32 v[20:21], v[20:21], v[68:69] op_sel_hi:[1,0]
    v_pk_mul_f32 v[22:23], v[22:23], v[68:69] op_sel_hi:[1,0]
    v_cvt_pk_bf16_f32 v72, v20, v21
    v_cvt_pk_bf16_f32 v73, v22, v23
    s_waitcnt lgkmcnt(1)
    v_pk_add_f32 v[24:25], v[24:25], v[56:57]
    v_pk_add_f32 v[26:27], v[26:27], v[58:59]
    v_pk_mul_f32 v[24:25], v[24:25], v[68:69] op_sel_hi:[1,0]
    v_pk_mul_f32 v[26:27], v[26:27], v[68:69] op_sel_hi:[1,0]
    v_cvt_pk_bf16_f32 v74, v24, v25
    v_cvt_pk_bf16_f32 v75, v26, v27
    s_nop 0
    v_permlane16_swap_b32 v72, v74
    v_permlane16_swap_b32 v73, v75
    buffer_store_dwordx4 v[72:75], v5, s[56:59], s31 offen sc1
    s_waitcnt lgkmcnt(0)
    v_pk_add_f32 v[28:29], v[28:29], v[60:61]
    v_pk_add_f32 v[30:31], v[30:31], v[62:63]
    v_pk_mul_f32 v[28:29], v[28:29], v[68:69] op_sel_hi:[1,0]
    v_pk_mul_f32 v[30:31], v[30:31], v[68:69] op_sel_hi:[1,0]
    v_cvt_pk_bf16_f32 v76, v28, v29
    v_cvt_pk_bf16_f32 v77, v30, v31
    v_mov_b32 v78, v76
    v_mov_b32 v79, v77
    s_nop 0
    v_permlane16_swap_b32 v76, v78
    v_permlane16_swap_b32 v77, v79
    buffer_store_dwordx4 v[76:79], v4, s[56:59], s32 offen sc1
    v_pk_fma_f32 v[70:71], v[20:21], 0, v[70:71] op_sel_hi:[1,0,1]
    v_pk_fma_f32 v[70:71], v[22:23], 0, v[70:71] op_sel_hi:[1,0,1]
    v_pk_fma_f32 v[70:71], v[24:25], 0, v[70:71] op_sel_hi:[1,0,1]
    v_pk_fma_f32 v[70:71], v[26:27], 0, v[70:71] op_sel_hi:[1,0,1]
    v_pk_fma_f32 v[70:71], v[28:29], 0, v[70:71] op_sel_hi:[1,0,1]
    v_pk_fma_f32 v[70:71], v[30:31], 0, v[70:71] op_sel_hi:[1,0,1]
    v_cmp_u_f32 vcc, v70, v71
    v_cmp_ngt_f32 s[66:67], v32, v80
    s_or_b64 vcc, vcc, s[66:67]
    v_cmp_nlt_f32 s[66:67], v32, v81
    s_or_b64 vcc, vcc, s[66:67]
    s_cbranch_vccz L_NOBAD
    v_mov_b32 v81, 1
    ds_write_b32 v83, v81
L_NOBAD:
    s_waitcnt lgkmcnt(0)
    s_barrier
    ds_read_b32 v81, v83
    v_mov_b32 v86, 1
    s_waitcnt lgkmcnt(0)
    v_readfirstlane_b32 s64, v81
    s_cmp_gt_u32 s64, s29
    s_cbranch_scc1 L_ATT_FB0
    s_mov_b64 exec, 1
    s_waitcnt vmcnt(0)
    ds_add_rtn_u32 v86, v83, v86 offset:4
    s_waitcnt lgkmcnt(0)
    v_readfirstlane_b32 s64, v86
    s_mov_b64 exec, -1
    s_cmp_lg_u32 s64, 7
    s_cbranch_scc1 L_A_DONE
    s_mov_b32 exec_hi, 0
    buffer_store_dwordx2 v[84:85], v82, s[56:59], s33 offen sc1
    s_mov_b64 exec, -1
L_A_DONE:
    s_endpgm
L_ATT_FB0:
    s_waitcnt vmcnt(0)
L_ATT_FB:
    s_mov_b32 s29, 1
    s_mov_b32 s30, 1
    s_mov_b32 s34, 0
    s_cmp_lt_u32 s40, 4
    s_cselect_b64 vcc, -1, 0
    v_mov_b32 v20, 0xff800000
    v_mov_b32 v21, 0xff800000
L_FB_LOOP:
    s_barrier
    s_add_u32 m0, s19, 0
    s_add_u32 s68, s16, s34
    buffer_load_dwordx4 v123, s[56:59], s68 offen sc1 lds
    s_add_u32 m0, s20, 0
    s_add_u32 s68, s17, s34
    buffer_load_dwordx4 v123, s[56:59], s68 offen sc1 lds
    s_cbranch_vccz D3_19
    s_add_u32 m0, s21, 0
    s_add_u32 s68, s18, s34
    buffer_load_dwordx4 v123, s[56:59], s68 offen sc1 lds
D3_19:
    s_waitcnt vmcnt(0)
    s_barrier
    ds_read_b64 v[84:85], v125 offset:0
    ds_read_b64 v[86:87], v125 offset:2080
    ds_read_b64 v[88:89], v126 offset:0
    s_waitcnt lgkmcnt(0)
    v_mfma_f32_32x32x16_bf16 v[52:67], v[84:87], v[8:11], 0
    v_mfma_f32_32x32x8_bf16 v[52:67], v[88:89], v[12:13], v[52:67]
    v_mfma_f32_32x32x16_bf16 v[68:83], v[84:87], v[14:17], 0
    v_mfma_f32_32x32x8_bf16 v[68:83], v[88:89], v[18:19], v[68:83]
    s_nop 15
    v_max3_f32 v20, v52, v53, v20
    v_max3_f32 v20, v54, v55, v20
    v_max3_f32 v20, v56, v57, v20
    v_max3_f32 v20, v58, v59, v20
    v_max3_f32 v20, v60, v61, v20
    v_max3_f32 v20, v62, v63, v20
    v_max3_f32 v20, v64, v65, v20
    v_max3_f32 v20, v66, v67, v20
    v_max3_f32 v21, v68, v69, v21
    v_max3_f32 v21, v70, v71, v21
    v_max3_f32 v21, v72, v73, v21
    v_max3_f32 v21, v74, v75, v21
    v_max3_f32 v21, v76, v77, v21
    v_max3_f32 v21, v78, v79, v21
    v_max3_f32 v21, v80, v81, v21
    v_max3_f32 v21, v82, v83, v21
    ds_read_b64 v[84:85], v125 offset:256
    ds_read_b64 v[86:87], v125 offset:2336
    ds_read_b64 v[88:89], v126 offset:256
    s_waitcnt lgkmcnt(0)
    v_mfma_f32_32x32x16_bf16 v[52:67], v[84:87], v[8:11], 0
    v_mfma_f32_32x32x8_bf16 v[52:67], v[88:89], v[12:13], v[52:67]
    v_mfma_f32_32x32x16_bf16 v[68:83], v[84:87], v[14:17], 0
    v_mfma_f32_32x32x8_bf16 v[68:83], v[88:89], v[18:19], v[68:83]
    s_nop 15
    v_max3_f32 v20, v52, v53, v20
    v_max3_f32 v20, v54, v55, v20
    v_max3_f32 v20, v56, v57, v20
    v_max3_f32 v20, v58, v59, v20
    v_max3_f32 v20, v60, v61, v20
    v_max3_f32 v20, v62, v63, v20
    v_max3_f32 v20, v64, v65, v20
    v_max3_f32 v20, v66, v67, v20
    v_max3_f32 v21, v68, v69, v21
    v_max3_f32 v21, v70, v71, v21
    v_max3_f32 v21, v72, v73, v21
    v_max3_f32 v21, v74, v75, v21
    v_max3_f32 v21, v76, v77, v21
    v_max3_f32 v21, v78, v79, v21
    v_max3_f32 v21, v80, v81, v21
    v_max3_f32 v21, v82, v83, v21
    ds_read_b64 v[84:85], v125 offset:512
    ds_read_b64 v[86:87], v125 offset:2592
    ds_read_b64 v[88:89], v126 offset:512
    s_waitcnt lgkmcnt(0)
    v_mfma_f32_32x32x16_bf16 v[52:67], v[84:87], v[8:11], 0
    v_mfma_f32_32x32x8_bf16 v[52:67], v[88:89], v[12:13], v[52:67]
    v_mfma_f32_32x32x16_bf16 v[68:83], v[84:87], v[14:17], 0
    v_mfma_f32_32x32x8_bf16 v[68:83], v[88:89], v[18:19], v[68:83]
    s_nop 15
    v_max3_f32 v20, v52, v53, v20
    v_max3_f32 v20, v54, v55, v20
    v_max3_f32 v20, v56, v57, v20
    v_max3_f32 v20, v58, v59, v20
    v_max3_f32 v20, v60, v61, v20
    v_max3_f32 v20, v62, v63, v20
    v_max3_f32 v20, v64, v65, v20
    v_max3_f32 v20, v66, v67, v20
    v_max3_f32 v21, v68, v69, v21
    v_max3_f32 v21, v70, v71, v21
    v_max3_f32 v21, v72, v73, v21
    v_max3_f32 v21, v74, v75, v21
    v_max3_f32 v21, v76, v77, v21
    v_max3_f32 v21, v78, v79, v21
    v_max3_f32 v21, v80, v81, v21
    v_max3_f32 v21, v82, v83, v21
    ds_read_b64 v[84:85], v125 offset:768
    ds_read_b64 v[86:87], v125 offset:2848
    ds_read_b64 v[88:89], v126 offset:768
    s_waitcnt lgkmcnt(0)
    v_mfma_f32_32x32x16_bf16 v[52:67], v[84:87], v[8:11], 0
    v_mfma_f32_32x32x8_bf16 v[52:67], v[88:89], v[12:13], v[52:67]
    v_mfma_f32_32x32x16_bf16 v[68:83], v[84:87], v[14:17], 0
    v_mfma_f32_32x32x8_bf16 v[68:83], v[88:89], v[18:19], v[68:83]
    s_nop 15
    v_max3_f32 v20, v52, v53, v20
    v_max3_f32 v20, v54, v55, v20
    v_max3_f32 v20, v56, v57, v20
    v_max3_f32 v20, v58, v59, v20
    v_max3_f32 v20, v60, v61, v20
    v_max3_f32 v20, v62, v63, v20
    v_max3_f32 v20, v64, v65, v20
    v_max3_f32 v20, v66, v67, v20
    v_max3_f32 v21, v68, v69, v21
    v_max3_f32 v21, v70, v71, v21
    v_max3_f32 v21, v72, v73, v21
    v_max3_f32 v21, v74, v75, v21
    v_max3_f32 v21, v76, v77, v21
    v_max3_f32 v21, v78, v79, v21
    v_max3_f32 v21, v80, v81, v21
    v_max3_f32 v21, v82, v83, v21
    s_add_u32 s34, s34, 2048
    s_cmp_lt_u32 s34, 16384
    s_cbranch_scc1 L_FB_LOOP
    v_mov_b32 v22, v20
    s_nop 1
    v_permlane32_swap_b32 v20, v22
    v_max_f32 v20, v20, v22
    v_mov_b32 v22, v21
    s_nop 1
    v_permlane32_swap_b32 v21, v22
    v_max_f32 v21, v21, v22
    s_barrier
    ds_write_b64 v2, v[20:21]
    s_waitcnt lgkmcnt(0)
    s_barrier
    ds_read_b64 v[22:23], v3
    s_waitcnt lgkmcnt(0)
    v_max_f32 v20, v20, v23
    v_max_f32 v21, v21, v22
    v_cmp_le_u32 vcc, 32, v1
    v_sub_f32 v24, 0, v20
    v_and_b32 v25, 0xffff0000, v24
    v_sub_f32 v24, v24, v25
    v_and_b32 v26, 0xffff0000, v24
    v_sub_f32 v24, v24, v26
    v_lshrrev_b32 v25, 16, v25
    v_or_b32 v25, v25, v26
    v_lshrrev_b32 v24, 16, v24
    v_cndmask_b32 v12, v12, v25, vcc
    v_cndmask_b32 v13, v13, v24, vcc
    v_sub_f32 v24, 0, v21
    v_and_b32 v25, 0xffff0000, v24
    v_sub_f32 v24, v24, v25
    v_and_b32 v26, 0xffff0000, v24
    v_sub_f32 v24, v24, v26
    v_lshrrev_b32 v25, 16, v25
    v_or_b32 v25, v25, v26
    v_lshrrev_b32 v24, 16, v24
    v_cndmask_b32 v18, v18, v25, vcc
    v_cndmask_b32 v19, v19, v24, vcc
    s_lshr_b32 s64, s40, 1
    s_min_u32 s64, s64, 2
    s_mul_i32 s64, s64, 22880
    s_and_b32 s65, s40, 1
    s_lshl_b32 s65, s65, 10
    s_add_u32 s64, s64, s65
    s_add_u32 s64, s64, 20800
    v_add_u32 v24, s64, v123
    v_mov_b32 v28, 0x3f803f80
    v_mov_b32 v29, 0x3f803f80
    v_mov_b32 v30, 0x3f803f80
    v_mov_b32 v31, 0x3f803f80
    s_barrier
    ds_write_b128 v24, v[28:31]
    s_waitcnt lgkmcnt(0)
    s_branch L_ATT_MAIN
L_QKV_IDLE:
    s_waitcnt lgkmcnt(0)
    s_load_dword s6, s[56:57], 0
    s_mov_b32 s58, 19922944
    s_mov_b32 s59, 0x20000
    v_mov_b32 v120, 2147483648
    s_sub_u32 s10, s2, 240
    s_lshl_b32 s10, s10, 3
    s_add_u32 s10, s10, 6016
    s_waitcnt lgkmcnt(0)
    s_mul_i32 s6, s6, 0x9E3779B1
    s_add_u32 s6, s6, 0x7F4A7C15
    s_xor_b32 s7, s6, 0x5bd1e995
    s_branch L_PUB
L_ROLE_B:
    s_cmp_ge_u32 s2, 512
    s_cbranch_scc1 L_END
    s_load_dwordx16 s[8:23], s[0:1], 0
    s_load_dwordx8 s[24:31], s[0:1], 64
    s_load_dwordx2 s[32:33], s[0:1], 96
    s_load_dwordx2 s[56:57], s[0:1], 112
    v_lshrrev_b32 v2, 6, v0
    v_and_b32 v1, 63, v0
    v_readfirstlane_b32 s40, v2
    s_setprio 3
    s_cmp_lg_u32 s40, 7
    s_cbranch_scc1 CP_20
    s_getpc_b64 s[64:65]
L_PC:
    s_sub_u32 s64, s64, L_PC-concat_heads__softmax_full_mha__ssm_conv_s5__prompt_kernel
    s_subb_u32 s65, s65, 0
    s_bfe_u32 s66, s2, 0x50003
    s_lshl_b32 s66, s66, 11
    v_and_b32 v2, 15, v1
    v_lshlrev_b32 v2, 7, v2
    v_add_u32 v2, s66, v2
    v_min_u32 v2, L_END-concat_heads__softmax_full_mha__ssm_conv_s5__prompt_kernel, v2
    v_mov_b32 v3, s65
    v_add_co_u32 v2, vcc, s64, v2
    s_nop 1
    v_addc_co_u32 v3, vcc, 0, v3, vcc
    global_load_dword v4, v[2:3], off
CP_20:
    s_and_b32 s41, s2, 3
    s_lshl_b32 s41, s41, 3
    s_bfe_u32 s64, s2, 0x30003
    s_add_u32 s41, s41, s64
    s_and_b32 s42, s2, 4
    s_bfe_u32 s64, s2, 0x20006
    s_add_u32 s42, s42, s64
    s_mul_i32 s37, s42, 3
    s_add_u32 s37, s37, s41
    s_mul_i32 s64, s37, 205
    s_lshr_b32 s64, s64, 11
    s_mul_i32 s64, s64, 10
    s_sub_u32 s37, s37, s64
    s_mov_b32 s37, 0
    s_mov_b32 s58, 19922944
    s_mov_b32 s59, 0x20000
    s_waitcnt lgkmcnt(0)
    s_load_dword s6, s[56:57], 0
    s_min_u32 s36, s40, 4
    s_lshl_b32 s36, s36, 4
    s_mul_i32 s64, s42, 80
    s_add_u32 s64, s64, s36
    v_and_b32 v16, 15, v1
    v_add_u32 v16, s64, v16
    v_lshlrev_b32 v21, 1, v16
    s_mov_b32 s8, s16
    s_mov_b32 s9, s17
    s_mov_b32 s10, 1280
    s_mov_b32 s11, 0x20000
    buffer_load_ushort v22, v21, s[8:11], 0 offen
    s_mov_b32 s8, s18
    s_mov_b32 s9, s19
    s_mov_b32 s10, 1280
    s_mov_b32 s11, 0x20000
    buffer_load_ushort v23, v21, s[8:11], 0 offen
    s_mov_b32 s8, s28
    s_mov_b32 s9, s29
    s_mov_b32 s10, 1280
    s_mov_b32 s11, 0x20000
    buffer_load_ushort v24, v21, s[8:11], 0 offen
    s_waitcnt vmcnt(0) lgkmcnt(0)
    s_mul_i32 s6, s6, 0x9E3779B1
    s_add_u32 s6, s6, 0x7F4A7C15
    s_xor_b32 s7, s6, 0x5bd1e995
    v_lshlrev_b32 v22, 16, v22
    v_lshlrev_b32 v23, 16, v23
    v_lshlrev_b32 v24, 16, v24
    v_mul_f32 v24, 1069066811, v24
    v_exp_f32 v24, v24
    s_nop 0
    v_cvt_pk_bf16_f32 v24, v24, v24
    v_lshlrev_b32 v24, 16, v24
    v_mul_f32 v25, v24, v22
    v_mul_f32 v26, v24, v23
    v_mul_f32 v25, 1069066811, v25
    v_exp_f32 v25, v25
    v_mul_f32 v26, 0.15915494, v26
    v_fract_f32 v26, v26
    v_cos_f32 v27, v26
    v_sin_f32 v28, v26
    s_nop 0
    v_mul_f32 v2, v25, v27
    v_mul_f32 v28, v25, v28
    v_sub_f32 v3, 0, v28
    v_add_f32 v27, -1.0, v2
    v_mul_f32 v25, v22, v22
    v_fmac_f32 v25, v23, v23
    v_rcp_f32 v25, v25
    v_mul_f32 v26, v27, v22
    v_fmac_f32 v26, v28, v23
    v_mul_f32 v29, v28, v22
    v_fma_f32 v29, -v27, v23, v29
    v_add_f32 v25, v25, v25
    v_mul_f32 v4, v26, v25
    v_mul_f32 v29, v29, v25
    v_sub_f32 v5, 0, v29
    v_pk_mul_f32 v[22:23], v[2:3], v[2:3] op_sel:[0,0] op_sel_hi:[1,0]
    v_pk_fma_f32 v[6:7], v[2:3], v[2:3], v[22:23] op_sel:[1,1,0] op_sel_hi:[0,1,1] neg_lo:[0,1,0]
    v_pk_mul_f32 v[22:23], v[6:7], v[6:7] op_sel:[0,0] op_sel_hi:[1,0]
    v_pk_fma_f32 v[6:7], v[6:7], v[6:7], v[22:23] op_sel:[1,1,0] op_sel_hi:[0,1,1] neg_lo:[0,1,0]
    v_pk_mul_f32 v[22:23], v[6:7], v[6:7] op_sel:[0,0] op_sel_hi:[1,0]
    v_pk_fma_f32 v[6:7], v[6:7], v[6:7], v[22:23] op_sel:[1,1,0] op_sel_hi:[0,1,1] neg_lo:[0,1,0]
    v_pk_mul_f32 v[22:23], v[6:7], v[6:7] op_sel:[0,0] op_sel_hi:[1,0]
    v_pk_fma_f32 v[6:7], v[6:7], v[6:7], v[22:23] op_sel:[1,1,0] op_sel_hi:[0,1,1] neg_lo:[0,1,0]
    v_pk_mul_f32 v[22:23], v[6:7], v[6:7] op_sel:[0,0] op_sel_hi:[1,0]
    v_pk_fma_f32 v[24:25], v[6:7], v[6:7], v[22:23] op_sel:[1,1,0] op_sel_hi:[0,1,1] neg_lo:[0,1,0]
    v_pk_mul_f32 v[22:23], v[24:25], v[6:7] op_sel:[0,0] op_sel_hi:[1,0]
    v_pk_fma_f32 v[26:27], v[24:25], v[6:7], v[22:23] op_sel:[1,1,0] op_sel_hi:[0,1,1] neg_lo:[0,1,0]
    v_pk_mul_f32 v[22:23], v[24:25], v[24:25] op_sel:[0,0] op_sel_hi:[1,0]
    v_pk_fma_f32 v[10:11], v[24:25], v[24:25], v[22:23] op_sel:[1,1,0] op_sel_hi:[0,1,1] neg_lo:[0,1,0]
    v_pk_mul_f32 v[22:23], v[10:11], v[10:11] op_sel:[0,0] op_sel_hi:[1,0]
    v_pk_fma_f32 v[12:13], v[10:11], v[10:11], v[22:23] op_sel:[1,1,0] op_sel_hi:[0,1,1] neg_lo:[0,1,0]
    v_pk_mul_f32 v[22:23], v[12:13], v[12:13] op_sel:[0,0] op_sel_hi:[1,0]
    v_pk_fma_f32 v[12:13], v[12:13], v[12:13], v[22:23] op_sel:[1,1,0] op_sel_hi:[0,1,1] neg_lo:[0,1,0]
    v_pk_mul_f32 v[22:23], v[12:13], v[12:13] op_sel:[0,0] op_sel_hi:[1,0]
    v_pk_fma_f32 v[12:13], v[12:13], v[12:13], v[22:23] op_sel:[1,1,0] op_sel_hi:[0,1,1] neg_lo:[0,1,0]
    v_lshrrev_b32 v28, 4, v1
    v_cmp_eq_u32 s[96:97], 1, v28
    v_cmp_eq_u32 s[98:99], 2, v28
    v_cmp_eq_u32 s[100:101], 3, v28
    v_mov_b32 v8, 1.0
    v_mov_b32 v9, 0
    v_cndmask_b32 v8, v8, v6, s[96:97]
    v_cndmask_b32 v9, v9, v7, s[96:97]
    v_cndmask_b32 v8, v8, v24, s[98:99]
    v_cndmask_b32 v9, v9, v25, s[98:99]
    v_cndmask_b32 v8, v8, v26, s[100:101]
    v_cndmask_b32 v9, v9, v27, s[100:101]
    v_and_b32 v26, 15, v1
    v_add_u32 v123, s36, v26
    v_lshlrev_b32 v123, 3, v123
    v_lshrrev_b32 v27, 4, v1
    v_mul_u32_u24 v28, 5120, v27
    s_sub_u32 s65, 32, s41
    s_mul_i32 s65, s65, 640
    v_add3_u32 v124, v123, v28, s65
    v_mul_u32_u24 v28, 40960, v27
    v_lshl_add_u32 v125, v16, 4, v28
    s_lshl_b32 s65, s40, 6
    v_add_u32 v28, s65, v1
    v_mul_u32_u24 v29, 6554, v28
    v_lshrrev_b32 v29, 16, v29
    v_mul_u32_u24 v30, 10, v29
    v_sub_u32 v30, v28, v30
    v_and_b32 v28, 0x78, v29
    v_and_b32 v31, 1, v29
    v_lshl_add_u32 v28, v31, 2, v28
    v_bfe_u32 v31, v29, 1, 2
    v_add_u32 v28, v28, v31
    v_mul_u32_u24 v28, 1280, v28
    v_lshl_add_u32 v28, v30, 4, v28
    s_mul_i32 s65, s42, 160
    v_add_u32 v117, s65, v28
    v_lshrrev_b32 v28, 5, v1
    v_mul_u32_u24 v28, 16384, v28
    v_and_b32 v29, 31, v1
    v_lshlrev_b32 v29, 4, v29
    s_and_b32 s65, s40, 1
    s_lshl_b32 s65, s65, 7
    v_xor_b32 v29, s65, v29
    v_add_u32 v119, v28, v29
    v_bfe_u32 v30, v1, 2, 2
    v_and_b32 v31, 3, v1
    s_cmp_ge_u32 s40, 4
    s_cbranch_scc1 HS_21
    v_lshrrev_b32 v27, 5, v1
    v_and_b32 v26, 31, v1
    s_lshr_b32 s65, s40, 1
    s_and_b32 s66, s40, 1
    s_lshl_b32 s67, s65, 5
    s_lshl_b32 s68, s66, 5
    s_lshl_b32 s69, s65, 2
    v_bfe_u32 v28, v1, 4, 1
    v_lshlrev_b32 v28, 1, v28
    v_lshrrev_b32 v29, 1, v31
    v_add3_u32 v28, v28, v29, s69
    v_mul_u32_u24 v28, 1088, v28
    v_lshl_add_u32 v29, v27, 3, v30
    v_lshl_add_u32 v28, v29, 4, v28
    v_and_b32 v29, 1, v31
    v_lshl_add_u32 v112, v29, 3, v28
    v_add_u32 v28, s68, v26
    v_lshlrev_b32 v28, 7, v28
    v_add_u32 v28, 8704, v28
    v_bfe_u32 v29, v26, 1, 3
    v_xor_b32 v29, v29, v27
    v_lshl_add_u32 v113, v29, 4, v28
    s_lshl_b32 s69, s41, 6
    s_add_u32 s69, s69, s67
    v_lshl_add_u32 v28, v27, 2, s69
    s_mul_i32 s69, s42, 80
    s_add_u32 s69, s69, s68
    v_add_u32 v29, s69, v26
    v_mul_u32_u24 v114, 1280, v28
    v_lshl_add_u32 v114, v29, 1, v114
    v_mul_u32_u24 v115, 5120, v28
    v_lshl_add_u32 v115, v29, 2, v115
    v_lshlrev_b32 v126, 1, v29
    v_lshlrev_b32 v28, 1, v30
    v_lshl_add_u32 v28, v27, 3, v28
    v_mul_u32_u24 v28, 160, v28
    v_lshl_add_u32 v28, v31, 3, v28
    v_bfe_u32 v29, v1, 4, 1
    v_lshl_add_u32 v28, v29, 5, v28
    s_lshl_b32 s69, s66, 6
    v_add_u32 v116, s69, v28
    v_add_u32 v28, s67, v26
    v_lshlrev_b32 v28, 3, v28
    v_lshlrev_b32 v29, 7, v27
    v_xor_b32 v28, v28, v29
    v_lshl_add_u32 v28, v27, 10, v28
    s_mul_i32 s69, s65, 40960
    v_add_u32 v118, s69, v28
    v_lshlrev_b32 v122, 4, v1
    v_mov_b32 v127, 0
    v_mov_b32 v26, 0
    v_mov_b32 v27, 0
    v_mov_b32 v28, 0
    s_branch HD_22
HS_21:
    s_sub_u32 s65, s40, 4
    s_lshl_b32 s67, s65, 4
    s_mov_b32 s68, 64
    s_lshl_b32 s69, s65, 1
    v_lshrrev_b32 v28, 1, v31
    v_add_u32 v28, s69, v28
    v_mul_u32_u24 v28, 1088, v28
    v_lshl_add_u32 v29, v27, 3, v30
    v_lshl_add_u32 v28, v29, 4, v28
    v_and_b32 v29, 1, v31
    v_lshl_add_u32 v112, v29, 3, v28
    v_add_u32 v28, s68, v26
    v_lshlrev_b32 v28, 7, v28
    v_add_u32 v28, 8704, v28
    v_bfe_u32 v29, v26, 1, 3
    v_xor_b32 v29, v29, v27
    v_lshl_add_u32 v113, v29, 4, v28
    s_lshl_b32 s69, s41, 6
    s_add_u32 s69, s69, s67
    v_lshl_add_u32 v28, v27, 2, s69
    s_mul_i32 s69, s42, 80
    s_add_u32 s69, s69, s68
    v_add_u32 v29, s69, v26
    v_mul_u32_u24 v114, 1280, v28
    v_lshl_add_u32 v114, v29, 1, v114
    v_mul_u32_u24 v115, 5120, v28
    v_lshl_add_u32 v115, v29, 2, v115
    v_lshlrev_b32 v126, 1, v29
    v_lshlrev_b32 v28, 1, v30
    v_lshl_add_u32 v28, v27, 3, v28
    v_mul_u32_u24 v28, 160, v28
    v_lshl_add_u32 v28, v31, 3, v28
    v_add_u32 v116, 128, v28
    v_add_u32 v28, s67, v26
    v_lshlrev_b32 v28, 3, v28
    v_and_b32 v29, 1, v27
    v_lshlrev_b32 v29, 7, v29
    v_xor_b32 v28, v28, v29
    v_lshl_add_u32 v118, v27, 10, v28
    v_lshrrev_b32 v28, 3, v1
    s_mul_i32 s69, s42, 80
    s_lshl_b32 s66, s65, 3
    s_add_u32 s69, s69, s66
    v_add_u32 v28, s69, v28
    v_mul_u32_u24 v28, 1280, v28
    v_and_b32 v29, 7, v1
    v_xor_b32 v29, v29, v27
    s_and_b32 s69, s65, 1
    s_lshl_b32 s69, s69, 2
    v_xor_b32 v29, s69, v29
    v_lshl_add_u32 v122, v29, 4, v28
    v_xor_b32 v127, 64, v113
    v_add_u32 v26, 40960, v122
    v_add_u32 v27, 81920, v122
    v_add_u32 v28, 40960, v118
HD_22:
    s_mov_b32 s44, s14
    s_mov_b32 s45, s15
    s_mov_b32 s46, 2621440
    s_mov_b32 s47, 0x20000
    s_mov_b32 s48, s20
    s_mov_b32 s49, s21
    s_mov_b32 s50, 819200
    s_mov_b32 s51, 0x20000
    s_mov_b32 s52, s22
    s_mov_b32 s53, s23
    s_mov_b32 s54, 819200
    s_mov_b32 s55, 0x20000
    s_cmp_eq_u32 s40, 5
    s_cselect_b32 s60, s48, s52
    s_cselect_b32 s61, s49, s53
    s_mov_b32 s62, 819200
    s_mov_b32 s63, 0x20000
    s_lshl_b32 s43, s37, 7
    v_mov_b32 v54, 0
    v_mov_b32 v55, 0
    v_lshrrev_b32 v30, 4, v1
    v_and_b32 v31, 7, v1
    v_xor_b32 v31, v31, v30
    v_lshlrev_b32 v31, 4, v31
    v_and_b32 v30, 31, v1
    v_lshlrev_b32 v30, 7, v30
    v_lshrrev_b32 v17, 5, v1
    v_bfe_u32 v29, v1, 1, 3
    v_xor_b32 v29, v17, v29
    v_lshl_add_u32 v18, v29, 4, v30
    s_cmp_ge_u32 s40, 4
    s_cbranch_scc1 L_G1_AUX
    v_lshrrev_b32 v30, 3, v1
    v_add_u32 v30, s64, v30
    v_mul_u32_u24 v30, 1280, v30
    v_add_u32 v14, v30, v31
    v_xor_b32 v15, 64, v14
    v_add_u32 v15, 10240, v15
    s_lshl_b32 s38, s40, 13
    s_add_u32 s38, s38, 36864
    v_xor_b32 v19, 32, v18
    v_xor_b32 v20, 64, v18
    v_xor_b32 v21, 96, v18
    v_add_u32 v22, s38, v18
    v_add_u32 v23, s38, v19
    v_add_u32 v24, s38, v20
    v_add_u32 v25, s38, v21
    s_mul_i32 s66, s36, 576
    s_add_u32 s66, s66, 20480
    s_lshl_b32 s67, s36, 5
    s_add_u32 s67, s67, 66560
    v_and_b32 v0, 15, v1
    v_lshl_add_u32 v29, v17, 5, v0
    v_mul_u32_u24 v29, 144, v29
    v_bfe_u32 v30, v1, 4, 1
    v_lshl_add_u32 v29, v30, 2, v29
    v_add_u32 v29, s66, v29
    v_add_u32 v30, 2304, v29
    v_mul_u32_u24 v31, 144, v1
    v_add_u32 v31, s66, v31
    v_lshl_add_u32 v17, v0, 3, s67
    v_lshl_add_u32 v0, v1, 3, s67
    s_cmp_lg_u32 s40, 0
    s_cbranch_scc1 L_NOHINT
    s_sub_u32 s66, s2, 256
    s_lshl_b32 s66, s66, 7
    s_add_u32 s66, s66, 98304
    s_mov_b32 s64, 400000
SP_23:
    s_load_dwordx2 s[8:9], s[56:57], s66 offset:0 glc
    s_mov_b32 s65, 0
    s_waitcnt lgkmcnt(0)
    s_cmp_eq_u64 s[8:9], s[6:7]
    s_addc_u32 s65, s65, s65
    s_cmp_eq_u32 s65, 1
    s_cbranch_scc1 SD_24
    s_sleep 2
    s_sub_u32 s64, s64, 1
    s_cmp_lg_u32 s64, 0
    s_cbranch_scc1 SP_23
SD_24:
L_NOHINT:
    s_waitcnt vmcnt(0)
    s_barrier
    s_setprio 3
    s_add_u32 m0, s38, 0
    s_nop 0
    buffer_load_dwordx4 v14, s[48:51], s43 offen lds
    s_add_u32 m0, s38, 1024
    s_nop 0
    buffer_load_dwordx4 v15, s[48:51], s43 offen lds
    s_add_u32 m0, s38, 2048
    s_nop 0
    buffer_load_dwordx4 v14, s[52:55], s43 offen lds
    s_add_u32 m0, s38, 3072
    s_nop 0
    buffer_load_dwordx4 v15, s[52:55], s43 offen lds
    s_add_u32 s43, s43, 128
    s_cmp_eq_u32 s43, 1280
    s_cselect_b32 s43, 0, s43
    s_add_u32 m0, s38, 4096
    s_nop 0
    buffer_load_dwordx4 v14, s[48:51], s43 offen lds
    s_add_u32 m0, s38, 5120
    s_nop 0
    buffer_load_dwordx4 v15, s[48:51], s43 offen lds
    s_add_u32 m0, s38, 6144
    s_nop 0
    buffer_load_dwordx4 v14, s[52:55], s43 offen lds
    s_add_u32 m0, s38, 7168
    s_nop 0
    buffer_load_dwordx4 v15, s[52:55], s43 offen lds
    s_add_u32 s43, s43, 128
    s_cmp_eq_u32 s43, 1280
    s_cselect_b32 s43, 0, s43
    s_waitcnt vmcnt(4)
    ds_read_b128 v[64:67], v22 offset:0
    ds_read_b128 v[68:71], v23 offset:0
    ds_read_b128 v[72:75], v24 offset:0
    s_barrier
    ds_read_b128 v[80:83], v18 offset:0
    ds_read_b128 v[84:87], v18 offset:4096
    ds_read_b128 v[88:91], v19 offset:0
    ds_read_b128 v[92:95], v19 offset:4096
    ds_read_b128 v[96:99], v20 offset:0
    ds_read_b128 v[100:103], v20 offset:4096
    ds_read_b128 v[76:79], v25 offset:0
    ds_read_b128 v[104:107], v21 offset:0
    ds_read_b128 v[108:111], v21 offset:4096
    s_waitcnt lgkmcnt(7)
    s_setprio 0
    v_mfma_f32_32x32x16_bf16 v[32:47], v[80:83], v[64:67], 0
    v_mfma_f32_32x32x16_bf16 v[48:63], v[84:87], v[64:67], 0
    s_setprio 3
    s_waitcnt lgkmcnt(5)
    s_setprio 0
    v_mfma_f32_32x32x16_bf16 v[32:47], v[88:91], v[68:71], v[32:47]
    v_mfma_f32_32x32x16_bf16 v[48:63], v[92:95], v[68:71], v[48:63]
    s_setprio 3
    s_waitcnt lgkmcnt(3)
    s_setprio 0
    v_mfma_f32_32x32x16_bf16 v[32:47], v[96:99], v[72:75], v[32:47]
    v_mfma_f32_32x32x16_bf16 v[48:63], v[100:103], v[72:75], v[48:63]
    s_setprio 3
    s_waitcnt lgkmcnt(0)
    s_waitcnt vmcnt(0)
    ds_read_b128 v[64:67], v22 offset:4096
    ds_read_b128 v[68:71], v23 offset:4096
    ds_read_b128 v[72:75], v24 offset:4096
    s_barrier
    s_setprio 0
    v_mfma_f32_32x32x16_bf16 v[32:47], v[104:107], v[76:79], v[32:47]
    s_setprio 3
    ds_read_b128 v[80:83], v18 offset:12288
    ds_read_b128 v[84:87], v18 offset:16384
    ds_read_b128 v[88:91], v19 offset:12288
    ds_read_b128 v[92:95], v19 offset:16384
    ds_read_b128 v[96:99], v20 offset:12288
    ds_read_b128 v[100:103], v20 offset:16384
    s_setprio 0
    v_mfma_f32_32x32x16_bf16 v[48:63], v[108:111], v[76:79], v[48:63]
    s_setprio 3
    ds_read_b128 v[76:79], v25 offset:4096
    ds_read_b128 v[104:107], v21 offset:12288
    ds_read_b128 v[108:111], v21 offset:16384
    s_waitcnt lgkmcnt(7)
    s_setprio 0
    v_mfma_f32_32x32x16_bf16 v[32:47], v[80:83], v[64:67], v[32:47]
    v_mfma_f32_32x32x16_bf16 v[48:63], v[84:87], v[64:67], v[48:63]
    s_setprio 3
    s_waitcnt lgkmcnt(5)
    s_setprio 0
    v_mfma_f32_32x32x16_bf16 v[32:47], v[88:91], v[68:71], v[32:47]
    v_mfma_f32_32x32x16_bf16 v[48:63], v[92:95], v[68:71], v[48:63]
    s_setprio 3
    s_waitcnt lgkmcnt(3)
    s_setprio 0
    v_mfma_f32_32x32x16_bf16 v[32:47], v[96:99], v[72:75], v[32:47]
    v_mfma_f32_32x32x16_bf16 v[48:63], v[100:103], v[72:75], v[48:63]
    s_setprio 3
    s_waitcnt lgkmcnt(0)
    s_barrier
    s_add_u32 m0, s38, 0
    s_nop 0
    buffer_load_dwordx4 v14, s[48:51], s43 offen lds
    s_add_u32 m0, s38, 1024
    s_nop 0
    buffer_load_dwordx4 v15, s[48:51], s43 offen lds
    s_add_u32 m0, s38, 2048
    s_nop 0
    buffer_load_dwordx4 v14, s[52:55], s43 offen lds
    s_add_u32 m0, s38, 3072
    s_nop 0
    buffer_load_dwordx4 v15, s[52:55], s43 offen lds
    s_add_u32 s43, s43, 128
    s_cmp_eq_u32 s43, 1280
    s_cselect_b32 s43, 0, s43
    s_add_u32 m0, s38, 4096
    s_nop 0
    buffer_load_dwordx4 v14, s[48:51], s43 offen lds
    s_add_u32 m0, s38, 5120
    s_nop 0
    buffer_load_dwordx4 v15, s[48:51], s43 offen lds
    s_add_u32 m0, s38, 6144
    s_nop 0
    buffer_load_dwordx4 v14, s[52:55], s43 offen lds
    s_add_u32 m0, s38, 7168
    s_nop 0
    buffer_load_dwordx4 v15, s[52:55], s43 offen lds
    s_add_u32 s43, s43, 128
    s_cmp_eq_u32 s43, 1280
    s_cselect_b32 s43, 0, s43
    s_waitcnt vmcnt(4)
    ds_read_b128 v[64:67], v22 offset:0
    ds_read_b128 v[68:71], v23 offset:0
    ds_read_b128 v[72:75], v24 offset:0
    s_barrier
    s_setprio 0
    v_mfma_f32_32x32x16_bf16 v[32:47], v[104:107], v[76:79], v[32:47]
    s_setprio 3
    ds_read_b128 v[80:83], v18 offset:24576
    ds_read_b128 v[84:87], v18 offset:28672
    ds_read_b128 v[88:91], v19 offset:24576
    ds_read_b128 v[92:95], v19 offset:28672
    ds_read_b128 v[96:99], v20 offset:24576
    ds_read_b128 v[100:103], v20 offset:28672
    s_setprio 0
    v_mfma_f32_32x32x16_bf16 v[48:63], v[108:111], v[76:79], v[48:63]
    s_setprio 3
    ds_read_b128 v[76:79], v25 offset:0
    ds_read_b128 v[104:107], v21 offset:24576
    ds_read_b128 v[108:111], v21 offset:28672
    s_waitcnt lgkmcnt(7)
    s_setprio 0
    v_mfma_f32_32x32x16_bf16 v[32:47], v[80:83], v[64:67], v[32:47]
    v_mfma_f32_32x32x16_bf16 v[48:63], v[84:87], v[64:67], v[48:63]
    s_setprio 3
    s_waitcnt lgkmcnt(5)
    s_setprio 0
    v_mfma_f32_32x32x16_bf16 v[32:47], v[88:91], v[68:71], v[32:47]
    v_mfma_f32_32x32x16_bf16 v[48:63], v[92:95], v[68:71], v[48:63]
    s_setprio 3
    s_waitcnt lgkmcnt(3)
    s_setprio 0
    v_mfma_f32_32x32x16_bf16 v[32:47], v[96:99], v[72:75], v[32:47]
    v_mfma_f32_32x32x16_bf16 v[48:63], v[100:103], v[72:75], v[48:63]
    s_setprio 3
    s_waitcnt lgkmcnt(0)
    s_add_u32 m0, s38, 0
    s_nop 0
    buffer_load_dwordx4 v14, s[48:51], s43 offen lds
    s_add_u32 m0, s38, 1024
    s_nop 0
    buffer_load_dwordx4 v15, s[48:51], s43 offen lds
    s_add_u32 m0, s38, 2048
    s_nop 0
    buffer_load_dwordx4 v14, s[52:55], s43 offen lds
    s_add_u32 m0, s38, 3072
    s_nop 0
    buffer_load_dwordx4 v15, s[52:55], s43 offen lds
    s_add_u32 s43, s43, 128
    s_cmp_eq_u32 s43, 1280
    s_cselect_b32 s43, 0, s43
    s_waitcnt vmcnt(4)
    ds_read_b128 v[64:67], v22 offset:4096
    ds_read_b128 v[68:71], v23 offset:4096
    ds_read_b128 v[72:75], v24 offset:4096
    s_barrier
    s_setprio 0
    v_mfma_f32_32x32x16_bf16 v[32:47], v[104:107], v[76:79], v[32:47]
    s_setprio 3
    ds_read_b128 v[80:83], v18 offset:0
    ds_read_b128 v[84:87], v18 offset:4096
    ds_read_b128 v[88:91], v19 offset:0
    ds_read_b128 v[92:95], v19 offset:4096
    ds_read_b128 v[96:99], v20 offset:0
    ds_read_b128 v[100:103], v20 offset:4096
    s_setprio 0
    v_mfma_f32_32x32x16_bf16 v[48:63], v[108:111], v[76:79], v[48:63]
    s_setprio 3
    ds_read_b128 v[76:79], v25 offset:4096
    ds_read_b128 v[104:107], v21 offset:0
    ds_read_b128 v[108:111], v21 offset:4096
    s_waitcnt lgkmcnt(7)
    s_setprio 0
    v_mfma_f32_32x32x16_bf16 v[32:47], v[80:83], v[64:67], v[32:47]
    v_mfma_f32_32x32x16_bf16 v[48:63], v[84:87], v[64:67], v[48:63]
    s_setprio 3
    s_waitcnt lgkmcnt(5)
    s_setprio 0
    v_mfma_f32_32x32x16_bf16 v[32:47], v[88:91], v[68:71], v[32:47]
    v_mfma_f32_32x32x16_bf16 v[48:63], v[92:95], v[68:71], v[48:63]
    s_setprio 3
    s_waitcnt lgkmcnt(3)
    s_setprio 0
    v_mfma_f32_32x32x16_bf16 v[32:47], v[96:99], v[72:75], v[32:47]
    v_mfma_f32_32x32x16_bf16 v[48:63], v[100:103], v[72:75], v[48:63]
    s_setprio 3
    s_waitcnt lgkmcnt(0)
    s_add_u32 m0, s38, 4096
    s_nop 0
    buffer_load_dwordx4 v14, s[48:51], s43 offen lds
    s_add_u32 m0, s38, 5120
    s_nop 0
    buffer_load_dwordx4 v15, s[48:51], s43 offen lds
    s_add_u32 m0, s38, 6144
    s_nop 0
    buffer_load_dwordx4 v14, s[52:55], s43 offen lds
    s_add_u32 m0, s38, 7168
    s_nop 0
    buffer_load_dwordx4 v15, s[52:55], s43 offen lds
    s_add_u32 s43, s43, 128
    s_cmp_eq_u32 s43, 1280
    s_cselect_b32 s43, 0, s43
    s_waitcnt vmcnt(4)
    ds_read_b128 v[64:67], v22 offset:0
    ds_read_b128 v[68:71], v23 offset:0
    ds_read_b128 v[72:75], v24 offset:0
    s_barrier
    s_setprio 0
    v_mfma_f32_32x32x16_bf16 v[32:47], v[104:107], v[76:79], v[32:47]
    s_setprio 3
    ds_read_b128 v[80:83], v18 offset:12288
    ds_read_b128 v[84:87], v18 offset:16384
    ds_read_b128 v[88:91], v19 offset:12288
    ds_read_b128 v[92:95], v19 offset:16384
    ds_read_b128 v[96:99], v20 offset:12288
    ds_read_b128 v[100:103], v20 offset:16384
    s_setprio 0
    v_mfma_f32_32x32x16_bf16 v[48:63], v[108:111], v[76:79], v[48:63]
    s_setprio 3
    ds_read_b128 v[76:79], v25 offset:0
    ds_read_b128 v[104:107], v21 offset:12288
    ds_read_b128 v[108:111], v21 offset:16384
    s_waitcnt lgkmcnt(7)
    s_setprio 0
    v_mfma_f32_32x32x16_bf16 v[32:47], v[80:83], v[64:67], v[32:47]
    v_mfma_f32_32x32x16_bf16 v[48:63], v[84:87], v[64:67], v[48:63]
    s_setprio 3
    s_waitcnt lgkmcnt(5)
    s_setprio 0
    v_mfma_f32_32x32x16_bf16 v[32:47], v[88:91], v[68:71], v[32:47]
    v_mfma_f32_32x32x16_bf16 v[48:63], v[92:95], v[68:71], v[48:63]
    s_setprio 3
    s_waitcnt lgkmcnt(3)
    s_setprio 0
    v_mfma_f32_32x32x16_bf16 v[32:47], v[96:99], v[72:75], v[32:47]
    v_mfma_f32_32x32x16_bf16 v[48:63], v[100:103], v[72:75], v[48:63]
    s_setprio 3
    s_waitcnt lgkmcnt(0)
    s_add_u32 m0, s38, 0
    s_nop 0
    buffer_load_dwordx4 v14, s[48:51], s43 offen lds
    s_add_u32 m0, s38, 1024
    s_nop 0
    buffer_load_dwordx4 v15, s[48:51], s43 offen lds
    s_add_u32 m0, s38, 2048
    s_nop 0
    buffer_load_dwordx4 v14, s[52:55], s43 offen lds
    s_add_u32 m0, s38, 3072
    s_nop 0
    buffer_load_dwordx4 v15, s[52:55], s43 offen lds
    s_add_u32 s43, s43, 128
    s_cmp_eq_u32 s43, 1280
    s_cselect_b32 s43, 0, s43
    s_waitcnt vmcnt(4)
    ds_read_b128 v[64:67], v22 offset:4096
    ds_read_b128 v[68:71], v23 offset:4096
    ds_read_b128 v[72:75], v24 offset:4096
    s_barrier
    s_setprio 0
    v_mfma_f32_32x32x16_bf16 v[32:47], v[104:107], v[76:79], v[32:47]
    s_setprio 3
    ds_read_b128 v[80:83], v18 offset:24576
    ds_read_b128 v[84:87], v18 offset:28672
    ds_read_b128 v[88:91], v19 offset:24576
    ds_read_b128 v[92:95], v19 offset:28672
    ds_read_b128 v[96:99], v20 offset:24576
    ds_read_b128 v[100:103], v20 offset:28672
    s_setprio 0
    v_mfma_f32_32x32x16_bf16 v[48:63], v[108:111], v[76:79], v[48:63]
    s_setprio 3
    ds_read_b128 v[76:79], v25 offset:4096
    ds_read_b128 v[104:107], v21 offset:24576
    ds_read_b128 v[108:111], v21 offset:28672
    s_waitcnt lgkmcnt(7)
    s_setprio 0
    v_mfma_f32_32x32x16_bf16 v[32:47], v[80:83], v[64:67], v[32:47]
    v_mfma_f32_32x32x16_bf16 v[48:63], v[84:87], v[64:67], v[48:63]
    s_setprio 3
    s_waitcnt lgkmcnt(5)
    s_setprio 0
    v_mfma_f32_32x32x16_bf16 v[32:47], v[88:91], v[68:71], v[32:47]
    v_mfma_f32_32x32x16_bf16 v[48:63], v[92:95], v[68:71], v[48:63]
    s_setprio 3
    s_waitcnt lgkmcnt(3)
    s_setprio 0
    v_mfma_f32_32x32x16_bf16 v[32:47], v[96:99], v[72:75], v[32:47]
    v_mfma_f32_32x32x16_bf16 v[48:63], v[100:103], v[72:75], v[48:63]
    s_setprio 3
    s_waitcnt lgkmcnt(0)
    s_add_u32 m0, s38, 4096
    s_nop 0
    buffer_load_dwordx4 v14, s[48:51], s43 offen lds
    s_add_u32 m0, s38, 5120
    s_nop 0
    buffer_load_dwordx4 v15, s[48:51], s43 offen lds
    s_add_u32 m0, s38, 6144
    s_nop 0
    buffer_load_dwordx4 v14, s[52:55], s43 offen lds
    s_add_u32 m0, s38, 7168
    s_nop 0
    buffer_load_dwordx4 v15, s[52:55], s43 offen lds
    s_add_u32 s43, s43, 128
    s_cmp_eq_u32 s43, 1280
    s_cselect_b32 s43, 0, s43
    s_waitcnt vmcnt(4)
    ds_read_b128 v[64:67], v22 offset:0
    ds_read_b128 v[68:71], v23 offset:0
    ds_read_b128 v[72:75], v24 offset:0
    s_barrier
    s_setprio 0
    v_mfma_f32_32x32x16_bf16 v[32:47], v[104:107], v[76:79], v[32:47]
    s_setprio 3
    ds_read_b128 v[80:83], v18 offset:0
    ds_read_b128 v[84:87], v18 offset:4096
    ds_read_b128 v[88:91], v19 offset:0
    ds_read_b128 v[92:95], v19 offset:4096
    ds_read_b128 v[96:99], v20 offset:0
    ds_read_b128 v[100:103], v20 offset:4096
    s_setprio 0
    v_mfma_f32_32x32x16_bf16 v[48:63], v[108:111], v[76:79], v[48:63]
    s_setprio 3
    ds_read_b128 v[76:79], v25 offset:0
    ds_read_b128 v[104:107], v21 offset:0
    ds_read_b128 v[108:111], v21 offset:4096
    s_waitcnt lgkmcnt(7)
    s_setprio 0
    v_mfma_f32_32x32x16_bf16 v[32:47], v[80:83], v[64:67], v[32:47]
    v_mfma_f32_32x32x16_bf16 v[48:63], v[84:87], v[64:67], v[48:63]
    s_setprio 3
    s_waitcnt lgkmcnt(5)
    s_setprio 0
    v_mfma_f32_32x32x16_bf16 v[32:47], v[88:91], v[68:71], v[32:47]
    v_mfma_f32_32x32x16_bf16 v[48:63], v[92:95], v[68:71], v[48:63]
    s_setprio 3
    s_waitcnt lgkmcnt(3)
    s_setprio 0
    v_mfma_f32_32x32x16_bf16 v[32:47], v[96:99], v[72:75], v[32:47]
    v_mfma_f32_32x32x16_bf16 v[48:63], v[100:103], v[72:75], v[48:63]
    s_setprio 3
    s_waitcnt lgkmcnt(0)
    s_add_u32 m0, s38, 0
    s_nop 0
    buffer_load_dwordx4 v14, s[48:51], s43 offen lds
    s_add_u32 m0, s38, 1024
    s_nop 0
    buffer_load_dwordx4 v15, s[48:51], s43 offen lds
    s_add_u32 m0, s38, 2048
    s_nop 0
    buffer_load_dwordx4 v14, s[52:55], s43 offen lds
    s_add_u32 m0, s38, 3072
    s_nop 0
    buffer_load_dwordx4 v15, s[52:55], s43 offen lds
    s_add_u32 s43, s43, 128
    s_cmp_eq_u32 s43, 1280
    s_cselect_b32 s43, 0, s43
    s_waitcnt vmcnt(4)
    ds_read_b128 v[64:67], v22 offset:4096
    ds_read_b128 v[68:71], v23 offset:4096
    ds_read_b128 v[72:75], v24 offset:4096
    s_barrier
    s_setprio 0
    v_mfma_f32_32x32x16_bf16 v[32:47], v[104:107], v[76:79], v[32:47]
    s_setprio 3
    ds_read_b128 v[80:83], v18 offset:12288
    ds_read_b128 v[84:87], v18 offset:16384
    ds_read_b128 v[88:91], v19 offset:12288
    ds_read_b128 v[92:95], v19 offset:16384
    ds_read_b128 v[96:99], v20 offset:12288
    ds_read_b128 v[100:103], v20 offset:16384
    s_setprio 0
    v_mfma_f32_32x32x16_bf16 v[48:63], v[108:111], v[76:79], v[48:63]
    s_setprio 3
    ds_read_b128 v[76:79], v25 offset:4096
    ds_read_b128 v[104:107], v21 offset:12288
    ds_read_b128 v[108:111], v21 offset:16384
    s_waitcnt lgkmcnt(7)
    s_setprio 0
    v_mfma_f32_32x32x16_bf16 v[32:47], v[80:83], v[64:67], v[32:47]
    v_mfma_f32_32x32x16_bf16 v[48:63], v[84:87], v[64:67], v[48:63]
    s_setprio 3
    s_waitcnt lgkmcnt(5)
    s_setprio 0
    v_mfma_f32_32x32x16_bf16 v[32:47], v[88:91], v[68:71], v[32:47]
    v_mfma_f32_32x32x16_bf16 v[48:63], v[92:95], v[68:71], v[48:63]
    s_setprio 3
    s_waitcnt lgkmcnt(3)
    s_setprio 0
    v_mfma_f32_32x32x16_bf16 v[32:47], v[96:99], v[72:75], v[32:47]
    v_mfma_f32_32x32x16_bf16 v[48:63], v[100:103], v[72:75], v[48:63]
    s_setprio 3
    s_waitcnt lgkmcnt(0)
    s_add_u32 m0, s38, 4096
    s_nop 0
    buffer_load_dwordx4 v14, s[48:51], s43 offen lds
    s_add_u32 m0, s38, 5120
    s_nop 0
    buffer_load_dwordx4 v15, s[48:51], s43 offen lds
    s_add_u32 m0, s38, 6144
    s_nop 0
    buffer_load_dwordx4 v14, s[52:55], s43 offen lds
    s_add_u32 m0, s38, 7168
    s_nop 0
    buffer_load_dwordx4 v15, s[52:55], s43 offen lds
    s_add_u32 s43, s43, 128
    s_cmp_eq_u32 s43, 1280
    s_cselect_b32 s43, 0, s43
    s_waitcnt vmcnt(4)
    ds_read_b128 v[64:67], v22 offset:0
    ds_read_b128 v[68:71], v23 offset:0
    ds_read_b128 v[72:75], v24 offset:0
    s_barrier
    s_setprio 0
    v_mfma_f32_32x32x16_bf16 v[32:47], v[104:107], v[76:79], v[32:47]
    s_setprio 3
    ds_read_b128 v[80:83], v18 offset:24576
    ds_read_b128 v[84:87], v18 offset:28672
    ds_read_b128 v[88:91], v19 offset:24576
    ds_read_b128 v[92:95], v19 offset:28672
    ds_read_b128 v[96:99], v20 offset:24576
    ds_read_b128 v[100:103], v20 offset:28672
    s_setprio 0
    v_mfma_f32_32x32x16_bf16 v[48:63], v[108:111], v[76:79], v[48:63]
    s_setprio 3
    ds_read_b128 v[76:79], v25 offset:0
    ds_read_b128 v[104:107], v21 offset:24576
    ds_read_b128 v[108:111], v21 offset:28672
    s_waitcnt lgkmcnt(7)
    s_setprio 0
    v_mfma_f32_32x32x16_bf16 v[32:47], v[80:83], v[64:67], v[32:47]
    v_mfma_f32_32x32x16_bf16 v[48:63], v[84:87], v[64:67], v[48:63]
    s_setprio 3
    s_waitcnt lgkmcnt(5)
    s_setprio 0
    v_mfma_f32_32x32x16_bf16 v[32:47], v[88:91], v[68:71], v[32:47]
    v_mfma_f32_32x32x16_bf16 v[48:63], v[92:95], v[68:71], v[48:63]
    s_setprio 3
    s_waitcnt lgkmcnt(3)
    s_setprio 0
    v_mfma_f32_32x32x16_bf16 v[32:47], v[96:99], v[72:75], v[32:47]
    v_mfma_f32_32x32x16_bf16 v[48:63], v[100:103], v[72:75], v[48:63]
    s_setprio 3
    s_waitcnt lgkmcnt(0)
    s_waitcnt vmcnt(0)
    ds_read_b128 v[64:67], v22 offset:4096
    ds_read_b128 v[68:71], v23 offset:4096
    ds_read_b128 v[72:75], v24 offset:4096
    s_barrier
    s_setprio 0
    v_mfma_f32_32x32x16_bf16 v[32:47], v[104:107], v[76:79], v[32:47]
    s_setprio 3
    ds_read_b128 v[80:83], v18 offset:0
    ds_read_b128 v[84:87], v18 offset:4096
    ds_read_b128 v[88:91], v19 offset:0
    ds_read_b128 v[92:95], v19 offset:4096
    ds_read_b128 v[96:99], v20 offset:0
    ds_read_b128 v[100:103], v20 offset:4096
    s_setprio 0
    v_mfma_f32_32x32x16_bf16 v[48:63], v[108:111], v[76:79], v[48:63]
    s_setprio 3
    ds_read_b128 v[76:79], v25 offset:4096
    ds_read_b128 v[104:107], v21 offset:0
    ds_read_b128 v[108:111], v21 offset:4096
    s_waitcnt lgkmcnt(7)
    s_setprio 0
    v_mfma_f32_32x32x16_bf16 v[32:47], v[80:83], v[64:67], v[32:47]
    v_mfma_f32_32x32x16_bf16 v[48:63], v[84:87], v[64:67], v[48:63]
    s_setprio 3
    s_waitcnt lgkmcnt(5)
    s_setprio 0
    v_mfma_f32_32x32x16_bf16 v[32:47], v[88:91], v[68:71], v[32:47]
    v_mfma_f32_32x32x16_bf16 v[48:63], v[92:95], v[68:71], v[48:63]
    s_setprio 3
    s_waitcnt lgkmcnt(3)
    s_setprio 0
    v_mfma_f32_32x32x16_bf16 v[32:47], v[96:99], v[72:75], v[32:47]
    v_mfma_f32_32x32x16_bf16 v[48:63], v[100:103], v[72:75], v[48:63]
    s_setprio 3
    s_waitcnt lgkmcnt(0)
    s_setprio 0
    v_mfma_f32_32x32x16_bf16 v[32:47], v[104:107], v[76:79], v[32:47]
    v_mfma_f32_32x32x16_bf16 v[48:63], v[108:111], v[76:79], v[48:63]
    s_setprio 3
    s_barrier
    s_nop 10
    s_branch L_SCAN
L_G1_AUX:
    s_cmp_eq_u32 s40, 4
    s_cbranch_scc1 L_G1_LD
    s_cmp_eq_u32 s40, 7
    s_cbranch_scc1 L_G1_LD
    v_lshrrev_b32 v30, 3, v1
    v_add_u32 v30, s64, v30
    v_mul_u32_u24 v30, 1280, v30
    v_add_u32 v14, v30, v31
    v_xor_b32 v15, 64, v14
    v_add_u32 v15, 10240, v15
    s_sub_u32 s38, s40, 5
    s_lshl_b32 s38, s38, 11
    s_lshl_b32 s66, s38, 1
    v_xor_b32 v19, 32, v18
    v_xor_b32 v20, 64, v18
    v_xor_b32 v21, 96, v18
    v_add_u32 v22, s66, v18
    v_add_u32 v23, s66, v19
    v_add_u32 v24, s66, v20
    v_add_u32 v25, s66, v21
    s_mul_i32 s66, s36, 576
    s_add_u32 s66, s66, 20480
    s_lshl_b32 s67, s36, 5
    s_add_u32 s67, s67, 66560
    v_and_b32 v0, 15, v1
    v_lshl_add_u32 v29, v17, 5, v0
    v_mul_u32_u24 v29, 144, v29
    v_bfe_u32 v30, v1, 4, 1
    v_lshl_add_u32 v29, v30, 2, v29
    v_add_u32 v29, s66, v29
    v_add_u32 v30, 2304, v29
    v_mul_u32_u24 v31, 144, v1
    v_add_u32 v31, s66, v31
    v_lshl_add_u32 v17, v0, 3, s67
    v_lshl_add_u32 v0, v1, 3, s67
    s_cmp_eq_u32 s40, 6
    s_cselect_b32 s34, 1, 4
    s_cselect_b32 s35, 2, 0
    s_cmp_eq_u32 s40, 7
    s_cselect_b32 s34, 3, s34
    s_lshl_b32 s68, s34, 6
    v_add_u32 v50, s68, v1
    v_mul_u32_u24 v51, 6554, v50
    v_lshrrev_b32 v51, 16, v51
    v_mul_u32_u24 v52, 10, v51
    v_sub_u32 v52, v50, v52
    v_and_b32 v50, 0x78, v51
    v_and_b32 v53, 1, v51
    v_lshl_add_u32 v50, v53, 2, v50
    v_bfe_u32 v53, v51, 1, 2
    v_add_u32 v50, v50, v53
    v_mul_u32_u24 v50, 1280, v50
    v_lshl_add_u32 v50, v52, 4, v50
    s_mul_i32 s69, s42, 160
    v_add_u32 v48, s69, v50
    s_lshl_b32 s34, s34, 10
    s_lshl_b32 s68, s35, 6
    v_add_u32 v50, s68, v1
    v_mul_u32_u24 v51, 6554, v50
    v_lshrrev_b32 v51, 16, v51
    v_mul_u32_u24 v52, 10, v51
    v_sub_u32 v52, v50, v52
    v_and_b32 v50, 0x78, v51
    v_and_b32 v53, 1, v51
    v_lshl_add_u32 v50, v53, 2, v50
    v_bfe_u32 v53, v51, 1, 2
    v_add_u32 v50, v50, v53
    v_mul_u32_u24 v50, 1280, v50
    v_lshl_add_u32 v50, v52, 4, v50
    s_mul_i32 s69, s42, 160
    v_add_u32 v49, s69, v50
    s_lshl_b32 s35, s35, 10
    s_waitcnt vmcnt(0)
    s_barrier
    s_setprio 3
    s_add_u32 m0, s38, 8192
    s_nop 0
    buffer_load_dwordx4 v14, s[60:63], s43 offen lds
    s_add_u32 m0, s38, 9216
    s_nop 0
    buffer_load_dwordx4 v15, s[60:63], s43 offen lds
    s_add_u32 s43, s43, 128
    s_cmp_eq_u32 s43, 1280
    s_cselect_b32 s43, 0, s43
    s_add_u32 m0, s38, 20480
    s_nop 0
    buffer_load_dwordx4 v14, s[60:63], s43 offen lds
    s_add_u32 m0, s38, 21504
    s_nop 0
    buffer_load_dwordx4 v15, s[60:63], s43 offen lds
    s_add_u32 s43, s43, 128
    s_cmp_eq_u32 s43, 1280
    s_cselect_b32 s43, 0, s43
    s_waitcnt vmcnt(2)
    s_barrier
    ds_read_b128 v[64:67], v18 offset:8192
    ds_read_b128 v[80:83], v22 offset:0
    ds_read_b128 v[68:71], v19 offset:8192
    ds_read_b128 v[84:87], v23 offset:0
    ds_read_b128 v[72:75], v20 offset:8192
    ds_read_b128 v[88:91], v24 offset:0
    ds_read_b128 v[76:79], v21 offset:8192
    ds_read_b128 v[92:95], v25 offset:0
    s_waitcnt lgkmcnt(6)
    s_setprio 0
    v_mfma_f32_32x32x16_bf16 v[32:47], v[80:83], v[64:67], 0
    s_setprio 3
    s_waitcnt lgkmcnt(4)
    s_setprio 0
    v_mfma_f32_32x32x16_bf16 v[32:47], v[84:87], v[68:71], v[32:47]
    s_setprio 3
    s_waitcnt lgkmcnt(2)
    s_setprio 0
    v_mfma_f32_32x32x16_bf16 v[32:47], v[88:91], v[72:75], v[32:47]
    s_setprio 3
    s_waitcnt lgkmcnt(0)
    s_setprio 0
    v_mfma_f32_32x32x16_bf16 v[32:47], v[92:95], v[76:79], v[32:47]
    s_setprio 3
    s_waitcnt vmcnt(0)
    s_barrier
    ds_read_b128 v[64:67], v18 offset:20480
    ds_read_b128 v[80:83], v22 offset:12288
    ds_read_b128 v[68:71], v19 offset:20480
    ds_read_b128 v[84:87], v23 offset:12288
    ds_read_b128 v[72:75], v20 offset:20480
    ds_read_b128 v[88:91], v24 offset:12288
    ds_read_b128 v[76:79], v21 offset:20480
    ds_read_b128 v[92:95], v25 offset:12288
    s_waitcnt lgkmcnt(6)
    s_setprio 0
    v_mfma_f32_32x32x16_bf16 v[32:47], v[80:83], v[64:67], v[32:47]
    s_setprio 3
    s_waitcnt lgkmcnt(4)
    s_setprio 0
    v_mfma_f32_32x32x16_bf16 v[32:47], v[84:87], v[68:71], v[32:47]
    s_setprio 3
    s_waitcnt lgkmcnt(2)
    s_setprio 0
    v_mfma_f32_32x32x16_bf16 v[32:47], v[88:91], v[72:75], v[32:47]
    s_setprio 3
    s_waitcnt lgkmcnt(0)
    s_setprio 0
    v_mfma_f32_32x32x16_bf16 v[32:47], v[92:95], v[76:79], v[32:47]
    s_setprio 3
    s_barrier
    s_add_u32 m0, s38, 32768
    s_nop 0
    buffer_load_dwordx4 v14, s[60:63], s43 offen lds
    s_add_u32 m0, s38, 33792
    s_nop 0
    buffer_load_dwordx4 v15, s[60:63], s43 offen lds
    s_add_u32 s43, s43, 128
    s_cmp_eq_u32 s43, 1280
    s_cselect_b32 s43, 0, s43
    s_add_u32 m0, s38, 8192
    s_nop 0
    buffer_load_dwordx4 v14, s[60:63], s43 offen lds
    s_add_u32 m0, s38, 9216
    s_nop 0
    buffer_load_dwordx4 v15, s[60:63], s43 offen lds
    s_add_u32 s43, s43, 128
    s_cmp_eq_u32 s43, 1280
    s_cselect_b32 s43, 0, s43
    s_waitcnt vmcnt(2)
    s_barrier
    ds_read_b128 v[64:67], v18 offset:32768
    ds_read_b128 v[80:83], v22 offset:24576
    ds_read_b128 v[68:71], v19 offset:32768
    ds_read_b128 v[84:87], v23 offset:24576
    ds_read_b128 v[72:75], v20 offset:32768
    ds_read_b128 v[88:91], v24 offset:24576
    ds_read_b128 v[76:79], v21 offset:32768
    ds_read_b128 v[92:95], v25 offset:24576
    s_waitcnt lgkmcnt(6)
    s_setprio 0
    v_mfma_f32_32x32x16_bf16 v[32:47], v[80:83], v[64:67], v[32:47]
    s_setprio 3
    s_waitcnt lgkmcnt(4)
    s_setprio 0
    v_mfma_f32_32x32x16_bf16 v[32:47], v[84:87], v[68:71], v[32:47]
    s_setprio 3
    s_waitcnt lgkmcnt(2)
    s_setprio 0
    v_mfma_f32_32x32x16_bf16 v[32:47], v[88:91], v[72:75], v[32:47]
    s_setprio 3
    s_waitcnt lgkmcnt(0)
    s_setprio 0
    v_mfma_f32_32x32x16_bf16 v[32:47], v[92:95], v[76:79], v[32:47]
    s_setprio 3
    s_add_u32 m0, s38, 20480
    s_nop 0
    buffer_load_dwordx4 v14, s[60:63], s43 offen lds
    s_add_u32 m0, s38, 21504
    s_nop 0
    buffer_load_dwordx4 v15, s[60:63], s43 offen lds
    s_add_u32 s43, s43, 128
    s_cmp_eq_u32 s43, 1280
    s_cselect_b32 s43, 0, s43
    s_waitcnt vmcnt(2)
    s_barrier
    ds_read_b128 v[64:67], v18 offset:8192
    ds_read_b128 v[80:83], v22 offset:0
    ds_read_b128 v[68:71], v19 offset:8192
    ds_read_b128 v[84:87], v23 offset:0
    ds_read_b128 v[72:75], v20 offset:8192
    ds_read_b128 v[88:91], v24 offset:0
    ds_read_b128 v[76:79], v21 offset:8192
    ds_read_b128 v[92:95], v25 offset:0
    s_waitcnt lgkmcnt(6)
    s_setprio 0
    v_mfma_f32_32x32x16_bf16 v[32:47], v[80:83], v[64:67], v[32:47]
    s_setprio 3
    s_waitcnt lgkmcnt(4)
    s_setprio 0
    v_mfma_f32_32x32x16_bf16 v[32:47], v[84:87], v[68:71], v[32:47]
    s_setprio 3
    s_waitcnt lgkmcnt(2)
    s_setprio 0
    v_mfma_f32_32x32x16_bf16 v[32:47], v[88:91], v[72:75], v[32:47]
    s_setprio 3
    s_waitcnt lgkmcnt(0)
    s_setprio 0
    v_mfma_f32_32x32x16_bf16 v[32:47], v[92:95], v[76:79], v[32:47]
    s_setprio 3
    s_add_u32 m0, s38, 32768
    s_nop 0
    buffer_load_dwordx4 v14, s[60:63], s43 offen lds
    s_add_u32 m0, s38, 33792
    s_nop 0
    buffer_load_dwordx4 v15, s[60:63], s43 offen lds
    s_add_u32 s43, s43, 128
    s_cmp_eq_u32 s43, 1280
    s_cselect_b32 s43, 0, s43
    s_waitcnt vmcnt(2)
    s_barrier
    ds_read_b128 v[64:67], v18 offset:20480
    ds_read_b128 v[80:83], v22 offset:12288
    ds_read_b128 v[68:71], v19 offset:20480
    ds_read_b128 v[84:87], v23 offset:12288
    ds_read_b128 v[72:75], v20 offset:20480
    ds_read_b128 v[88:91], v24 offset:12288
    ds_read_b128 v[76:79], v21 offset:20480
    ds_read_b128 v[92:95], v25 offset:12288
    s_waitcnt lgkmcnt(6)
    s_setprio 0
    v_mfma_f32_32x32x16_bf16 v[32:47], v[80:83], v[64:67], v[32:47]
    s_setprio 3
    s_waitcnt lgkmcnt(4)
    s_setprio 0
    v_mfma_f32_32x32x16_bf16 v[32:47], v[84:87], v[68:71], v[32:47]
    s_setprio 3
    s_waitcnt lgkmcnt(2)
    s_setprio 0
    v_mfma_f32_32x32x16_bf16 v[32:47], v[88:91], v[72:75], v[32:47]
    s_setprio 3
    s_waitcnt lgkmcnt(0)
    s_setprio 0
    v_mfma_f32_32x32x16_bf16 v[32:47], v[92:95], v[76:79], v[32:47]
    s_setprio 3
    s_add_u32 m0, s38, 8192
    s_nop 0
    buffer_load_dwordx4 v14, s[60:63], s43 offen lds
    s_add_u32 m0, s38, 9216
    s_nop 0
    buffer_load_dwordx4 v15, s[60:63], s43 offen lds
    s_add_u32 s43, s43, 128
    s_cmp_eq_u32 s43, 1280
    s_cselect_b32 s43, 0, s43
    s_waitcnt vmcnt(2)
    s_barrier
    ds_read_b128 v[64:67], v18 offset:32768
    ds_read_b128 v[80:83], v22 offset:24576
    ds_read_b128 v[68:71], v19 offset:32768
    ds_read_b128 v[84:87], v23 offset:24576
    ds_read_b128 v[72:75], v20 offset:32768
    ds_read_b128 v[88:91], v24 offset:24576
    ds_read_b128 v[76:79], v21 offset:32768
    ds_read_b128 v[92:95], v25 offset:24576
    s_waitcnt lgkmcnt(6)
    s_setprio 0
    v_mfma_f32_32x32x16_bf16 v[32:47], v[80:83], v[64:67], v[32:47]
    s_setprio 3
    s_waitcnt lgkmcnt(4)
    s_setprio 0
    v_mfma_f32_32x32x16_bf16 v[32:47], v[84:87], v[68:71], v[32:47]
    s_setprio 3
    s_waitcnt lgkmcnt(2)
    s_setprio 0
    v_mfma_f32_32x32x16_bf16 v[32:47], v[88:91], v[72:75], v[32:47]
    s_setprio 3
    s_waitcnt lgkmcnt(0)
    s_setprio 0
    v_mfma_f32_32x32x16_bf16 v[32:47], v[92:95], v[76:79], v[32:47]
    s_setprio 3
    s_add_u32 m0, s38, 20480
    s_nop 0
    buffer_load_dwordx4 v14, s[60:63], s43 offen lds
    s_add_u32 m0, s38, 21504
    s_nop 0
    buffer_load_dwordx4 v15, s[60:63], s43 offen lds
    s_add_u32 s43, s43, 128
    s_cmp_eq_u32 s43, 1280
    s_cselect_b32 s43, 0, s43
    s_waitcnt vmcnt(2)
    s_barrier
    ds_read_b128 v[64:67], v18 offset:8192
    ds_read_b128 v[80:83], v22 offset:0
    ds_read_b128 v[68:71], v19 offset:8192
    ds_read_b128 v[84:87], v23 offset:0
    ds_read_b128 v[72:75], v20 offset:8192
    ds_read_b128 v[88:91], v24 offset:0
    ds_read_b128 v[76:79], v21 offset:8192
    ds_read_b128 v[92:95], v25 offset:0
    s_waitcnt lgkmcnt(6)
    s_setprio 0
    v_mfma_f32_32x32x16_bf16 v[32:47], v[80:83], v[64:67], v[32:47]
    s_setprio 3
    s_waitcnt lgkmcnt(4)
    s_setprio 0
    v_mfma_f32_32x32x16_bf16 v[32:47], v[84:87], v[68:71], v[32:47]
    s_setprio 3
    s_waitcnt lgkmcnt(2)
    s_setprio 0
    v_mfma_f32_32x32x16_bf16 v[32:47], v[88:91], v[72:75], v[32:47]
    s_setprio 3
    s_waitcnt lgkmcnt(0)
    s_setprio 0
    v_mfma_f32_32x32x16_bf16 v[32:47], v[92:95], v[76:79], v[32:47]
    s_setprio 3
    s_add_u32 m0, s38, 32768
    s_nop 0
    buffer_load_dwordx4 v14, s[60:63], s43 offen lds
    s_add_u32 m0, s38, 33792
    s_nop 0
    buffer_load_dwordx4 v15, s[60:63], s43 offen lds
    s_add_u32 s43, s43, 128
    s_cmp_eq_u32 s43, 1280
    s_cselect_b32 s43, 0, s43
    s_waitcnt vmcnt(2)
    s_barrier
    ds_read_b128 v[64:67], v18 offset:20480
    ds_read_b128 v[80:83], v22 offset:12288
    ds_read_b128 v[68:71], v19 offset:20480
    ds_read_b128 v[84:87], v23 offset:12288
    ds_read_b128 v[72:75], v20 offset:20480
    ds_read_b128 v[88:91], v24 offset:12288
    ds_read_b128 v[76:79], v21 offset:20480
    ds_read_b128 v[92:95], v25 offset:12288
    s_waitcnt lgkmcnt(6)
    s_setprio 0
    v_mfma_f32_32x32x16_bf16 v[32:47], v[80:83], v[64:67], v[32:47]
    s_setprio 3
    s_waitcnt lgkmcnt(4)
    s_setprio 0
    v_mfma_f32_32x32x16_bf16 v[32:47], v[84:87], v[68:71], v[32:47]
    s_setprio 3
    s_waitcnt lgkmcnt(2)
    s_setprio 0
    v_mfma_f32_32x32x16_bf16 v[32:47], v[88:91], v[72:75], v[32:47]
    s_setprio 3
    s_waitcnt lgkmcnt(0)
    s_setprio 0
    v_mfma_f32_32x32x16_bf16 v[32:47], v[92:95], v[76:79], v[32:47]
    s_setprio 3
    s_add_u32 m0, s38, 8192
    s_nop 0
    buffer_load_dwordx4 v14, s[60:63], s43 offen lds
    s_add_u32 m0, s38, 9216
    s_nop 0
    buffer_load_dwordx4 v15, s[60:63], s43 offen lds
    s_add_u32 s43, s43, 128
    s_cmp_eq_u32 s43, 1280
    s_cselect_b32 s43, 0, s43
    s_waitcnt vmcnt(2)
    s_barrier
    ds_read_b128 v[64:67], v18 offset:32768
    ds_read_b128 v[80:83], v22 offset:24576
    ds_read_b128 v[68:71], v19 offset:32768
    ds_read_b128 v[84:87], v23 offset:24576
    ds_read_b128 v[72:75], v20 offset:32768
    ds_read_b128 v[88:91], v24 offset:24576
    ds_read_b128 v[76:79], v21 offset:32768
    ds_read_b128 v[92:95], v25 offset:24576
    s_waitcnt lgkmcnt(6)
    s_setprio 0
    v_mfma_f32_32x32x16_bf16 v[32:47], v[80:83], v[64:67], v[32:47]
    s_setprio 3
    s_waitcnt lgkmcnt(4)
    s_setprio 0
    v_mfma_f32_32x32x16_bf16 v[32:47], v[84:87], v[68:71], v[32:47]
    s_setprio 3
    s_waitcnt lgkmcnt(2)
    s_setprio 0
    v_mfma_f32_32x32x16_bf16 v[32:47], v[88:91], v[72:75], v[32:47]
    s_setprio 3
    s_waitcnt lgkmcnt(0)
    s_setprio 0
    v_mfma_f32_32x32x16_bf16 v[32:47], v[92:95], v[76:79], v[32:47]
    s_setprio 3
    s_waitcnt vmcnt(0)
    s_barrier
    ds_read_b128 v[64:67], v18 offset:8192
    ds_read_b128 v[80:83], v22 offset:0
    ds_read_b128 v[68:71], v19 offset:8192
    ds_read_b128 v[84:87], v23 offset:0
    ds_read_b128 v[72:75], v20 offset:8192
    ds_read_b128 v[88:91], v24 offset:0
    ds_read_b128 v[76:79], v21 offset:8192
    ds_read_b128 v[92:95], v25 offset:0
    s_waitcnt lgkmcnt(6)
    s_setprio 0
    v_mfma_f32_32x32x16_bf16 v[32:47], v[80:83], v[64:67], v[32:47]
    s_setprio 3
    s_waitcnt lgkmcnt(4)
    s_setprio 0
    v_mfma_f32_32x32x16_bf16 v[32:47], v[84:87], v[68:71], v[32:47]
    s_setprio 3
    s_waitcnt lgkmcnt(2)
    s_setprio 0
    v_mfma_f32_32x32x16_bf16 v[32:47], v[88:91], v[72:75], v[32:47]
    s_setprio 3
    s_waitcnt lgkmcnt(0)
    s_setprio 0
    v_mfma_f32_32x32x16_bf16 v[32:47], v[92:95], v[76:79], v[32:47]
    s_setprio 3
    s_setprio 3
    s_lshl_b32 s66, s40, 12
    s_add_u32 s66, s66, 49152
    v_lshlrev_b32 v30, 4, v1
    v_add_u32 v30, s66, v30
    s_nop 7
    ds_write_b128 v30, v[32:35] offset:0
    ds_write_b128 v30, v[36:39] offset:1024
    ds_write_b128 v30, v[40:43] offset:2048
    ds_write_b128 v30, v[44:47] offset:3072
    s_waitcnt lgkmcnt(0)
    s_branch L_G1_AUXEND
L_G1_LD:
    s_cmp_eq_u32 s40, 7
    s_cselect_b32 s38, 1, 0
    v_lshrrev_b32 v30, 5, v1
    v_bfe_u32 v29, v1, 3, 1
    v_lshl_add_u32 v30, v30, 1, v29
    v_lshlrev_b32 v30, 4, v30
    v_bfe_u32 v29, v1, 4, 1
    v_add_u32 v30, v30, v29
    s_lshl_b32 s66, s41, 6
    s_lshl_b32 s67, s38, 3
    s_add_u32 s66, s66, s67
    v_add_u32 v30, s66, v30
    v_mul_u32_u24 v30, 1280, v30
    v_add_u32 v14, v30, v31
    v_xor_b32 v15, 64, v14
    v_add_u32 v15, 2560, v15
    v_add_u32 v54, 5120, v14
    v_add_u32 v55, 5120, v15
    s_lshl_b32 s38, s38, 12
    s_cmp_eq_u32 s40, 6
    s_cselect_b32 s34, 1, 4
    s_cselect_b32 s35, 2, 0
    s_cmp_eq_u32 s40, 7
    s_cselect_b32 s34, 3, s34
    s_lshl_b32 s68, s34, 6
    v_add_u32 v50, s68, v1
    v_mul_u32_u24 v51, 6554, v50
    v_lshrrev_b32 v51, 16, v51
    v_mul_u32_u24 v52, 10, v51
    v_sub_u32 v52, v50, v52
    v_and_b32 v50, 0x78, v51
    v_and_b32 v53, 1, v51
    v_lshl_add_u32 v50, v53, 2, v50
    v_bfe_u32 v53, v51, 1, 2
    v_add_u32 v50, v50, v53
    v_mul_u32_u24 v50, 1280, v50
    v_lshl_add_u32 v50, v52, 4, v50
    s_mul_i32 s69, s42, 160
    v_add_u32 v48, s69, v50
    s_lshl_b32 s34, s34, 10
    s_lshl_b32 s68, s35, 6
    v_add_u32 v50, s68, v1
    v_mul_u32_u24 v51, 6554, v50
    v_lshrrev_b32 v51, 16, v51
    v_mul_u32_u24 v52, 10, v51
    v_sub_u32 v52, v50, v52
    v_and_b32 v50, 0x78, v51
    v_and_b32 v53, 1, v51
    v_lshl_add_u32 v50, v53, 2, v50
    v_bfe_u32 v53, v51, 1, 2
    v_add_u32 v50, v50, v53
    v_mul_u32_u24 v50, 1280, v50
    v_lshl_add_u32 v50, v52, 4, v50
    s_mul_i32 s69, s42, 160
    v_add_u32 v49, s69, v50
    s_lshl_b32 s35, s35, 10
    v_lshrrev_b32 v52, 2, v1
    v_mul_u32_u24 v52, 1280, v52
    v_and_b32 v53, 3, v1
    v_lshl_add_u32 v52, v53, 7, v52
    s_cmp_eq_u32 s40, 7
    s_cbranch_scc1 T7_25
    s_and_b32 s66, s42, 3
    s_lshl_b32 s66, s66, 4
    s_lshl_b32 s67, s41, 6
    s_add_u32 s66, s66, s67
    s_mul_i32 s66, s66, 1280
    s_mov_b32 exec_hi, -1
    buffer_load_dword v56, v52, s[44:47], s66 offen
    s_branch TD_26
T7_25:
    s_and_b32 s66, s41, 7
    s_mul_i32 s66, s66, 10
    s_mul_i32 s67, s42, 80
    s_add_u32 s66, s66, s67
    s_mul_i32 s66, s66, 1280
    s_mov_b64 exec, 0xfffff
    s_mov_b32 exec_lo, -1
    s_mov_b32 exec_hi, 0xff
    buffer_load_dword v56, v52, s[48:51], s66 offen
    buffer_load_dword v57, v52, s[52:55], s66 offen
TD_26:
    s_mov_b64 exec, -1
    s_waitcnt vmcnt(0)
    s_barrier
    s_add_u32 m0, s38, 0
    s_nop 0
    buffer_load_dwordx4 v14, s[44:47], s43 offen lds
    s_add_u32 m0, s38, 1024
    s_nop 0
    buffer_load_dwordx4 v15, s[44:47], s43 offen lds
    s_add_u32 m0, s38, 2048
    s_nop 0
    buffer_load_dwordx4 v54, s[44:47], s43 offen lds
    s_add_u32 m0, s38, 3072
    s_nop 0
    buffer_load_dwordx4 v55, s[44:47], s43 offen lds
    s_add_u32 s43, s43, 128
    s_cmp_eq_u32 s43, 1280
    s_cselect_b32 s43, 0, s43
    s_add_u32 m0, s38, 12288
    s_nop 0
    buffer_load_dwordx4 v14, s[44:47], s43 offen lds
    s_add_u32 m0, s38, 13312
    s_nop 0
    buffer_load_dwordx4 v15, s[44:47], s43 offen lds
    s_add_u32 m0, s38, 14336
    s_nop 0
    buffer_load_dwordx4 v54, s[44:47], s43 offen lds
    s_add_u32 m0, s38, 15360
    s_nop 0
    buffer_load_dwordx4 v55, s[44:47], s43 offen lds
    s_add_u32 s43, s43, 128
    s_cmp_eq_u32 s43, 1280
    s_cselect_b32 s43, 0, s43
    s_waitcnt vmcnt(4)
    s_barrier
    s_waitcnt vmcnt(0)
    s_barrier
    s_cmp_lg_u32 s40, 4
    s_cbranch_scc1 L_NOGATE
    s_sub_u32 s66, s2, 256
    s_lshl_b32 s66, s66, 7
    s_add_u32 s66, s66, 32768
    s_mov_b32 s64, 400000
SP_27:
    s_load_dwordx2 s[8:9], s[56:57], s66 offset:0 glc
    s_mov_b32 s65, 0
    s_waitcnt lgkmcnt(0)
    s_cmp_eq_u64 s[8:9], s[6:7]
    s_addc_u32 s65, s65, s65
    s_cmp_eq_u32 s65, 1
    s_cbranch_scc1 SD_28
    s_sleep 2
    s_sub_u32 s64, s64, 1
    s_cmp_lg_u32 s64, 0
    s_cbranch_scc1 SP_27
SD_28:
L_NOGATE:
    s_barrier
    s_add_u32 m0, s38, 24576
    s_nop 0
    buffer_load_dwordx4 v14, s[44:47], s43 offen lds
    s_add_u32 m0, s38, 25600
    s_nop 0
    buffer_load_dwordx4 v15, s[44:47], s43 offen lds
    s_add_u32 m0, s38, 26624
    s_nop 0
    buffer_load_dwordx4 v54, s[44:47], s43 offen lds
    s_add_u32 m0, s38, 27648
    s_nop 0
    buffer_load_dwordx4 v55, s[44:47], s43 offen lds
    s_add_u32 s43, s43, 128
    s_cmp_eq_u32 s43, 1280
    s_cselect_b32 s43, 0, s43
    s_add_u32 m0, s38, 0
    s_nop 0
    buffer_load_dwordx4 v14, s[44:47], s43 offen lds
    s_add_u32 m0, s38, 1024
    s_nop 0
    buffer_load_dwordx4 v15, s[44:47], s43 offen lds
    s_add_u32 m0, s38, 2048
    s_nop 0
    buffer_load_dwordx4 v54, s[44:47], s43 offen lds
    s_add_u32 m0, s38, 3072
    s_nop 0
    buffer_load_dwordx4 v55, s[44:47], s43 offen lds
    s_add_u32 s43, s43, 128
    s_cmp_eq_u32 s43, 1280
    s_cselect_b32 s43, 0, s43
    s_waitcnt vmcnt(4)
    s_barrier
    s_add_u32 m0, s38, 12288
    s_nop 0
    buffer_load_dwordx4 v14, s[44:47], s43 offen lds
    s_add_u32 m0, s38, 13312
    s_nop 0
    buffer_load_dwordx4 v15, s[44:47], s43 offen lds
    s_add_u32 m0, s38, 14336
    s_nop 0
    buffer_load_dwordx4 v54, s[44:47], s43 offen lds
    s_add_u32 m0, s38, 15360
    s_nop 0
    buffer_load_dwordx4 v55, s[44:47], s43 offen lds
    s_add_u32 s43, s43, 128
    s_cmp_eq_u32 s43, 1280
    s_cselect_b32 s43, 0, s43
    s_waitcnt vmcnt(4)
    s_barrier
    s_add_u32 m0, s38, 24576
    s_nop 0
    buffer_load_dwordx4 v14, s[44:47], s43 offen lds
    s_add_u32 m0, s38, 25600
    s_nop 0
    buffer_load_dwordx4 v15, s[44:47], s43 offen lds
    s_add_u32 m0, s38, 26624
    s_nop 0
    buffer_load_dwordx4 v54, s[44:47], s43 offen lds
    s_add_u32 m0, s38, 27648
    s_nop 0
    buffer_load_dwordx4 v55, s[44:47], s43 offen lds
    s_add_u32 s43, s43, 128
    s_cmp_eq_u32 s43, 1280
    s_cselect_b32 s43, 0, s43
    s_waitcnt vmcnt(4)
    s_barrier
    s_add_u32 m0, s38, 0
    s_nop 0
    buffer_load_dwordx4 v14, s[44:47], s43 offen lds
    s_add_u32 m0, s38, 1024
    s_nop 0
    buffer_load_dwordx4 v15, s[44:47], s43 offen lds
    s_add_u32 m0, s38, 2048
    s_nop 0
    buffer_load_dwordx4 v54, s[44:47], s43 offen lds
    s_add_u32 m0, s38, 3072
    s_nop 0
    buffer_load_dwordx4 v55, s[44:47], s43 offen lds
    s_add_u32 s43, s43, 128
    s_cmp_eq_u32 s43, 1280
    s_cselect_b32 s43, 0, s43
    s_waitcnt vmcnt(4)
    s_barrier
    s_add_u32 m0, s38, 12288
    s_nop 0
    buffer_load_dwordx4 v14, s[44:47], s43 offen lds
    s_add_u32 m0, s38, 13312
    s_nop 0
    buffer_load_dwordx4 v15, s[44:47], s43 offen lds
    s_add_u32 m0, s38, 14336
    s_nop 0
    buffer_load_dwordx4 v54, s[44:47], s43 offen lds
    s_add_u32 m0, s38, 15360
    s_nop 0
    buffer_load_dwordx4 v55, s[44:47], s43 offen lds
    s_add_u32 s43, s43, 128
    s_cmp_eq_u32 s43, 1280
    s_cselect_b32 s43, 0, s43
    s_sub_u32 s66, s2, 256
    s_mul_i32 s66, s66, 3200
    v_min_u32 v66, 24, v1
    v_lshlrev_b32 v66, 7, v66
    s_cmp_eq_u32 s40, 7
    s_cselect_b32 s60, s12, s24
    s_cselect_b32 s61, s13, s25
    s_mov_b32 s62, 819200
    s_mov_b32 s63, 0x20000
    buffer_load_dword v60, v66, s[60:63], s66 offen
    s_cselect_b32 s60, s12, s26
    s_cselect_b32 s61, s13, s27
    buffer_load_dword v61, v66, s[60:63], s66 offen
    s_waitcnt vmcnt(6)
    s_barrier
    s_add_u32 m0, s38, 24576
    s_nop 0
    buffer_load_dwordx4 v14, s[44:47], s43 offen lds
    s_add_u32 m0, s38, 25600
    s_nop 0
    buffer_load_dwordx4 v15, s[44:47], s43 offen lds
    s_add_u32 m0, s38, 26624
    s_nop 0
    buffer_load_dwordx4 v54, s[44:47], s43 offen lds
    s_add_u32 m0, s38, 27648
    s_nop 0
    buffer_load_dwordx4 v55, s[44:47], s43 offen lds
    s_add_u32 s43, s43, 128
    s_cmp_eq_u32 s43, 1280
    s_cselect_b32 s43, 0, s43
    s_waitcnt vmcnt(6)
    s_barrier
    s_add_u32 m0, s38, 0
    s_nop 0
    buffer_load_dwordx4 v14, s[44:47], s43 offen lds
    s_add_u32 m0, s38, 1024
    s_nop 0
    buffer_load_dwordx4 v15, s[44:47], s43 offen lds
    s_add_u32 m0, s38, 2048
    s_nop 0
    buffer_load_dwordx4 v54, s[44:47], s43 offen lds
    s_add_u32 m0, s38, 3072
    s_nop 0
    buffer_load_dwordx4 v55, s[44:47], s43 offen lds
    s_add_u32 s43, s43, 128
    s_cmp_eq_u32 s43, 1280
    s_cselect_b32 s43, 0, s43
    s_waitcnt vmcnt(4)
    s_barrier
    s_waitcnt vmcnt(0)
    s_barrier
    v_lshlrev_b32 v30, 4, v1
    v_add_u32 v30, 69632, v30
    s_cmp_eq_u32 s40, 4
    s_cbranch_scc1 L_G1_RED
L_G1_AUXEND:
    s_barrier
    s_barrier
    s_cmp_lg_u32 s40, 6
    s_cbranch_scc1 L_F2POLL
    s_mov_b32 s48, s12
    s_mov_b32 s49, s13
    s_mov_b32 s50, 819200
    s_mov_b32 s51, 0x20000
    s_add_u32 m0, s34, 0
    s_mov_b32 s64, 0
    buffer_load_dwordx4 v48, s[48:51], s64 offen lds
    s_add_u32 m0, s34, 5120
    s_mov_b32 s64, 40960
    buffer_load_dwordx4 v48, s[48:51], s64 offen lds
    s_add_u32 m0, s34, 10240
    s_mov_b32 s64, 81920
    buffer_load_dwordx4 v48, s[48:51], s64 offen lds
    s_add_u32 m0, s34, 15360
    s_mov_b32 s64, 122880
    buffer_load_dwordx4 v48, s[48:51], s64 offen lds
    s_add_u32 m0, s34, 20480
    s_mov_b32 s64, 163840
    buffer_load_dwordx4 v48, s[48:51], s64 offen lds
    s_add_u32 m0, s34, 25600
    s_mov_b32 s64, 204800
    buffer_load_dwordx4 v48, s[48:51], s64 offen lds
    s_add_u32 m0, s34, 30720
    s_mov_b32 s64, 245760
    buffer_load_dwordx4 v48, s[48:51], s64 offen lds
    s_add_u32 m0, s34, 35840
    s_mov_b32 s64, 286720
    buffer_load_dwordx4 v48, s[48:51], s64 offen lds
    s_add_u32 m0, s34, 40960
    s_mov_b32 s64, 327680
    buffer_load_dwordx4 v48, s[48:51], s64 offen lds
    s_add_u32 m0, s34, 46080
    s_mov_b32 s64, 368640
    buffer_load_dwordx4 v48, s[48:51], s64 offen lds
    s_add_u32 m0, s34, 51200
    s_mov_b32 s64, 409600
    buffer_load_dwordx4 v48, s[48:51], s64 offen lds
    s_add_u32 m0, s34, 56320
    s_mov_b32 s64, 450560
    buffer_load_dwordx4 v48, s[48:51], s64 offen lds
    s_add_u32 m0, s34, 61440
    s_mov_b32 s64, 491520
    buffer_load_dwordx4 v48, s[48:51], s64 offen lds
    s_add_u32 m0, s34, 66560
    s_mov_b32 s64, 532480
    buffer_load_dwordx4 v48, s[48:51], s64 offen lds
    s_add_u32 m0, s34, 71680
    s_mov_b32 s64, 573440
    buffer_load_dwordx4 v48, s[48:51], s64 offen lds
    s_add_u32 m0, s34, 76800
    s_mov_b32 s64, 614400
    buffer_load_dwordx4 v48, s[48:51], s64 offen lds
    s_cmp_eq_u32 s40, 7
    s_cbranch_scc1 U1_29
    s_add_u32 m0, s35, 0
    s_mov_b32 s64, 0
    buffer_load_dwordx4 v49, s[48:51], s64 offen lds
    s_add_u32 m0, s35, 5120
    s_mov_b32 s64, 40960
    buffer_load_dwordx4 v49, s[48:51], s64 offen lds
    s_add_u32 m0, s35, 10240
    s_mov_b32 s64, 81920
    buffer_load_dwordx4 v49, s[48:51], s64 offen lds
    s_add_u32 m0, s35, 15360
    s_mov_b32 s64, 122880
    buffer_load_dwordx4 v49, s[48:51], s64 offen lds
    s_add_u32 m0, s35, 20480
    s_mov_b32 s64, 163840
    buffer_load_dwordx4 v49, s[48:51], s64 offen lds
    s_add_u32 m0, s35, 25600
    s_mov_b32 s64, 204800
    buffer_load_dwordx4 v49, s[48:51], s64 offen lds
    s_add_u32 m0, s35, 30720
    s_mov_b32 s64, 245760
    buffer_load_dwordx4 v49, s[48:51], s64 offen lds
    s_add_u32 m0, s35, 35840
    s_mov_b32 s64, 286720
    buffer_load_dwordx4 v49, s[48:51], s64 offen lds
    s_add_u32 m0, s35, 40960
    s_mov_b32 s64, 327680
    buffer_load_dwordx4 v49, s[48:51], s64 offen lds
    s_add_u32 m0, s35, 46080
    s_mov_b32 s64, 368640
    buffer_load_dwordx4 v49, s[48:51], s64 offen lds
    s_add_u32 m0, s35, 51200
    s_mov_b32 s64, 409600
    buffer_load_dwordx4 v49, s[48:51], s64 offen lds
    s_add_u32 m0, s35, 56320
    s_mov_b32 s64, 450560
    buffer_load_dwordx4 v49, s[48:51], s64 offen lds
    s_add_u32 m0, s35, 61440
    s_mov_b32 s64, 491520
    buffer_load_dwordx4 v49, s[48:51], s64 offen lds
    s_add_u32 m0, s35, 66560
    s_mov_b32 s64, 532480
    buffer_load_dwordx4 v49, s[48:51], s64 offen lds
    s_add_u32 m0, s35, 71680
    s_mov_b32 s64, 573440
    buffer_load_dwordx4 v49, s[48:51], s64 offen lds
    s_add_u32 m0, s35, 76800
    s_mov_b32 s64, 614400
    buffer_load_dwordx4 v49, s[48:51], s64 offen lds
    s_and_b32 s66, s41, 7
    s_mul_i32 s39, s66, 10
    s_mul_i32 s68, s42, 80
    s_add_u32 s39, s39, s68
    s_mul_i32 s39, s39, 1280
    s_cmp_eq_u32 s40, 5
    s_cselect_b32 s48, s24, s26
    s_cselect_b32 s49, s25, s27
    v_lshlrev_b32 v66, 7, v1
    v_min_u32 v67, 35, v1
    v_lshlrev_b32 v67, 7, v67
    v_add_u32 v67, 8192, v67
    buffer_load_dword v64, v66, s[48:51], s39 offen
    buffer_load_dword v65, v67, s[48:51], s39 offen
    s_branch U2_30
U1_29:
    s_mov_b32 s48, s12
    s_mov_b32 s49, s13
    s_mov_b32 s50, 819200
    s_mov_b32 s51, 0x20000
    s_and_b32 s66, s41, 7
    s_mul_i32 s66, s66, 20480
    s_mul_i32 s67, s42, 160
    s_add_u32 s66, s66, s67
    s_add_u32 s66, s66, 655360
    v_bfe_u32 v66, v1, 1, 4
    v_mul_u32_u24 v66, 1280, v66
    v_and_b32 v67, 1, v1
    v_mul_u32_u24 v67, 156, v67
    v_add_u32 v66, v66, v67
    buffer_load_dword v64, v66, s[48:51], s66 offen
U2_30:
    s_barrier
    s_waitcnt vmcnt(0)
    s_branch L_B_H
L_F2POLL:
    s_cmp_eq_u32 s40, 7
    s_cselect_b32 s66, 16, 0
    s_sub_i32 s67, s41, s66
    s_max_i32 s67, s67, 0
    s_min_i32 s67, s67, 16
    s_lshr_b32 s67, 0xffff0000, s67
    s_and_b32 s67, s67, 0xffff
    s_lshl_b32 s66, s66, 3
    s_lshl_b32 s65, s42, 5
    s_add_u32 s65, s65, s41
    s_lshl_b32 s65, s65, 8
    s_add_u32 s66, s66, s65
    s_add_u32 s66, s66, 786432
    s_mov_b32 s64, 400000
SP_31:
    s_load_dwordx16 s[68:83], s[56:57], s66 offset:0 glc
    s_load_dwordx16 s[84:99], s[56:57], s66 offset:64 glc
    s_mov_b32 s65, 0
    s_waitcnt lgkmcnt(0)
    s_cmp_eq_u64 s[68:69], s[6:7]
    s_addc_u32 s65, s65, s65
    s_cmp_eq_u64 s[70:71], s[6:7]
    s_addc_u32 s65, s65, s65
    s_cmp_eq_u64 s[72:73], s[6:7]
    s_addc_u32 s65, s65, s65
    s_cmp_eq_u64 s[74:75], s[6:7]
    s_addc_u32 s65, s65, s65
    s_cmp_eq_u64 s[76:77], s[6:7]
    s_addc_u32 s65, s65, s65
    s_cmp_eq_u64 s[78:79], s[6:7]
    s_addc_u32 s65, s65, s65
    s_cmp_eq_u64 s[80:81], s[6:7]
    s_addc_u32 s65, s65, s65
    s_cmp_eq_u64 s[82:83], s[6:7]
    s_addc_u32 s65, s65, s65
    s_cmp_eq_u64 s[84:85], s[6:7]
    s_addc_u32 s65, s65, s65
    s_cmp_eq_u64 s[86:87], s[6:7]
    s_addc_u32 s65, s65, s65
    s_cmp_eq_u64 s[88:89], s[6:7]
    s_addc_u32 s65, s65, s65
    s_cmp_eq_u64 s[90:91], s[6:7]
    s_addc_u32 s65, s65, s65
    s_cmp_eq_u64 s[92:93], s[6:7]
    s_addc_u32 s65, s65, s65
    s_cmp_eq_u64 s[94:95], s[6:7]
    s_addc_u32 s65, s65, s65
    s_cmp_eq_u64 s[96:97], s[6:7]
    s_addc_u32 s65, s65, s65
    s_cmp_eq_u64 s[98:99], s[6:7]
    s_addc_u32 s65, s65, s65
    s_andn2_b32 s65, s67, s65
    s_cmp_eq_u32 s65, 0
    s_cbranch_scc1 SD_32
    s_sub_u32 s64, s64, 1
    s_cmp_lg_u32 s64, 0
    s_cbranch_scc1 SP_31
SD_32:
    s_barrier
    s_mov_b32 s48, s12
    s_mov_b32 s49, s13
    s_mov_b32 s50, 819200
    s_mov_b32 s51, 0x20000
    s_add_u32 m0, s34, 0
    s_mov_b32 s64, 0
    buffer_load_dwordx4 v48, s[48:51], s64 offen lds
    s_add_u32 m0, s34, 5120
    s_mov_b32 s64, 40960
    buffer_load_dwordx4 v48, s[48:51], s64 offen lds
    s_add_u32 m0, s34, 10240
    s_mov_b32 s64, 81920
    buffer_load_dwordx4 v48, s[48:51], s64 offen lds
    s_add_u32 m0, s34, 15360
    s_mov_b32 s64, 122880
    buffer_load_dwordx4 v48, s[48:51], s64 offen lds
    s_add_u32 m0, s34, 20480
    s_mov_b32 s64, 163840
    buffer_load_dwordx4 v48, s[48:51], s64 offen lds
    s_add_u32 m0, s34, 25600
    s_mov_b32 s64, 204800
    buffer_load_dwordx4 v48, s[48:51], s64 offen lds
    s_add_u32 m0, s34, 30720
    s_mov_b32 s64, 245760
    buffer_load_dwordx4 v48, s[48:51], s64 offen lds
    s_add_u32 m0, s34, 35840
    s_mov_b32 s64, 286720
    buffer_load_dwordx4 v48, s[48:51], s64 offen lds
    s_add_u32 m0, s34, 40960
    s_mov_b32 s64, 327680
    buffer_load_dwordx4 v48, s[48:51], s64 offen lds
    s_add_u32 m0, s34, 46080
    s_mov_b32 s64, 368640
    buffer_load_dwordx4 v48, s[48:51], s64 offen lds
    s_add_u32 m0, s34, 51200
    s_mov_b32 s64, 409600
    buffer_load_dwordx4 v48, s[48:51], s64 offen lds
    s_add_u32 m0, s34, 56320
    s_mov_b32 s64, 450560
    buffer_load_dwordx4 v48, s[48:51], s64 offen lds
    s_add_u32 m0, s34, 61440
    s_mov_b32 s64, 491520
    buffer_load_dwordx4 v48, s[48:51], s64 offen lds
    s_add_u32 m0, s34, 66560
    s_mov_b32 s64, 532480
    buffer_load_dwordx4 v48, s[48:51], s64 offen lds
    s_add_u32 m0, s34, 71680
    s_mov_b32 s64, 573440
    buffer_load_dwordx4 v48, s[48:51], s64 offen lds
    s_add_u32 m0, s34, 76800
    s_mov_b32 s64, 614400
    buffer_load_dwordx4 v48, s[48:51], s64 offen lds
    s_cmp_eq_u32 s40, 7
    s_cbranch_scc1 U1_33
    s_add_u32 m0, s35, 0
    s_mov_b32 s64, 0
    buffer_load_dwordx4 v49, s[48:51], s64 offen lds
    s_add_u32 m0, s35, 5120
    s_mov_b32 s64, 40960
    buffer_load_dwordx4 v49, s[48:51], s64 offen lds
    s_add_u32 m0, s35, 10240
    s_mov_b32 s64, 81920
    buffer_load_dwordx4 v49, s[48:51], s64 offen lds
    s_add_u32 m0, s35, 15360
    s_mov_b32 s64, 122880
    buffer_load_dwordx4 v49, s[48:51], s64 offen lds
    s_add_u32 m0, s35, 20480
    s_mov_b32 s64, 163840
    buffer_load_dwordx4 v49, s[48:51], s64 offen lds
    s_add_u32 m0, s35, 25600
    s_mov_b32 s64, 204800
    buffer_load_dwordx4 v49, s[48:51], s64 offen lds
    s_add_u32 m0, s35, 30720
    s_mov_b32 s64, 245760
    buffer_load_dwordx4 v49, s[48:51], s64 offen lds
    s_add_u32 m0, s35, 35840
    s_mov_b32 s64, 286720
    buffer_load_dwordx4 v49, s[48:51], s64 offen lds
    s_add_u32 m0, s35, 40960
    s_mov_b32 s64, 327680
    buffer_load_dwordx4 v49, s[48:51], s64 offen lds
    s_add_u32 m0, s35, 46080
    s_mov_b32 s64, 368640
    buffer_load_dwordx4 v49, s[48:51], s64 offen lds
    s_add_u32 m0, s35, 51200
    s_mov_b32 s64, 409600
    buffer_load_dwordx4 v49, s[48:51], s64 offen lds
    s_add_u32 m0, s35, 56320
    s_mov_b32 s64, 450560
    buffer_load_dwordx4 v49, s[48:51], s64 offen lds
    s_add_u32 m0, s35, 61440
    s_mov_b32 s64, 491520
    buffer_load_dwordx4 v49, s[48:51], s64 offen lds
    s_add_u32 m0, s35, 66560
    s_mov_b32 s64, 532480
    buffer_load_dwordx4 v49, s[48:51], s64 offen lds
    s_add_u32 m0, s35, 71680
    s_mov_b32 s64, 573440
    buffer_load_dwordx4 v49, s[48:51], s64 offen lds
    s_add_u32 m0, s35, 76800
    s_mov_b32 s64, 614400
    buffer_load_dwordx4 v49, s[48:51], s64 offen lds
    s_and_b32 s66, s41, 7
    s_mul_i32 s39, s66, 10
    s_mul_i32 s68, s42, 80
    s_add_u32 s39, s39, s68
    s_mul_i32 s39, s39, 1280
    s_cmp_eq_u32 s40, 5
    s_cselect_b32 s48, s24, s26
    s_cselect_b32 s49, s25, s27
    v_lshlrev_b32 v66, 7, v1
    v_min_u32 v67, 35, v1
    v_lshlrev_b32 v67, 7, v67
    v_add_u32 v67, 8192, v67
    buffer_load_dword v64, v66, s[48:51], s39 offen
    buffer_load_dword v65, v67, s[48:51], s39 offen
    s_branch U2_34
U1_33:
    s_mov_b32 s48, s12
    s_mov_b32 s49, s13
    s_mov_b32 s50, 819200
    s_mov_b32 s51, 0x20000
    s_and_b32 s66, s41, 7
    s_mul_i32 s66, s66, 20480
    s_mul_i32 s67, s42, 160
    s_add_u32 s66, s66, s67
    s_add_u32 s66, s66, 655360
    v_bfe_u32 v66, v1, 1, 4
    v_mul_u32_u24 v66, 1280, v66
    v_and_b32 v67, 1, v1
    v_mul_u32_u24 v67, 156, v67
    v_add_u32 v66, v66, v67
    buffer_load_dword v64, v66, s[48:51], s66 offen
U2_34:
    s_waitcnt vmcnt(0)
    s_branch L_B_H
L_G1_RED:
    s_barrier
    ds_read_b128 v[32:35], v30 offset:0
    ds_read_b128 v[36:39], v30 offset:1024
    ds_read_b128 v[40:43], v30 offset:2048
    ds_read_b128 v[44:47], v30 offset:3072
    ds_read_b128 v[48:51], v30 offset:4096
    ds_read_b128 v[52:55], v30 offset:5120
    ds_read_b128 v[56:59], v30 offset:6144
    ds_read_b128 v[60:63], v30 offset:7168
    s_waitcnt lgkmcnt(0)
L_SCAN:
    s_setprio 3
    v_permlane16_swap_b32 v32, v33
    v_permlane16_swap_b32 v34, v35
    v_permlane16_swap_b32 v36, v37
    v_permlane16_swap_b32 v38, v39
    v_permlane16_swap_b32 v40, v41
    v_permlane16_swap_b32 v42, v43
    v_permlane16_swap_b32 v44, v45
    v_permlane16_swap_b32 v46, v47
    v_permlane16_swap_b32 v48, v49
    v_permlane16_swap_b32 v50, v51
    v_permlane16_swap_b32 v52, v53
    v_permlane16_swap_b32 v54, v55
    v_permlane16_swap_b32 v56, v57
    v_permlane16_swap_b32 v58, v59
    v_permlane16_swap_b32 v60, v61
    v_permlane16_swap_b32 v62, v63
    v_pk_mul_f32 v[64:65], v[32:33], v[4:5] op_sel:[0,0] op_sel_hi:[0,1]
    v_pk_fma_f32 v[32:33], v[32:33], v[4:5], v[64:65] op_sel:[1,1,0] op_sel_hi:[1,0,1] neg_hi:[0,1,0]
    v_pk_mul_f32 v[66:67], v[34:35], v[4:5] op_sel:[0,0] op_sel_hi:[0,1]
    v_pk_fma_f32 v[34:35], v[34:35], v[4:5], v[66:67] op_sel:[1,1,0] op_sel_hi:[1,0,1] neg_hi:[0,1,0]
    v_pk_mul_f32 v[64:65], v[36:37], v[4:5] op_sel:[0,0] op_sel_hi:[0,1]
    v_pk_fma_f32 v[36:37], v[36:37], v[4:5], v[64:65] op_sel:[1,1,0] op_sel_hi:[1,0,1] neg_hi:[0,1,0]
    v_pk_mul_f32 v[66:67], v[38:39], v[4:5] op_sel:[0,0] op_sel_hi:[0,1]
    v_pk_fma_f32 v[38:39], v[38:39], v[4:5], v[66:67] op_sel:[1,1,0] op_sel_hi:[1,0,1] neg_hi:[0,1,0]
    v_pk_mul_f32 v[64:65], v[40:41], v[4:5] op_sel:[0,0] op_sel_hi:[0,1]
    v_pk_fma_f32 v[40:41], v[40:41], v[4:5], v[64:65] op_sel:[1,1,0] op_sel_hi:[1,0,1] neg_hi:[0,1,0]
    v_pk_mul_f32 v[66:67], v[42:43], v[4:5] op_sel:[0,0] op_sel_hi:[0,1]
    v_pk_fma_f32 v[42:43], v[42:43], v[4:5], v[66:67] op_sel:[1,1,0] op_sel_hi:[1,0,1] neg_hi:[0,1,0]
    v_pk_mul_f32 v[64:65], v[44:45], v[4:5] op_sel:[0,0] op_sel_hi:[0,1]
    v_pk_fma_f32 v[44:45], v[44:45], v[4:5], v[64:65] op_sel:[1,1,0] op_sel_hi:[1,0,1] neg_hi:[0,1,0]
    v_pk_mul_f32 v[66:67], v[46:47], v[4:5] op_sel:[0,0] op_sel_hi:[0,1]
    v_pk_fma_f32 v[46:47], v[46:47], v[4:5], v[66:67] op_sel:[1,1,0] op_sel_hi:[1,0,1] neg_hi:[0,1,0]
    v_pk_mul_f32 v[64:65], v[48:49], v[4:5] op_sel:[0,0] op_sel_hi:[0,1]
    v_pk_fma_f32 v[48:49], v[48:49], v[4:5], v[64:65] op_sel:[1,1,0] op_sel_hi:[1,0,1] neg_hi:[0,1,0]
    v_pk_mul_f32 v[66:67], v[50:51], v[4:5] op_sel:[0,0] op_sel_hi:[0,1]
    v_pk_fma_f32 v[50:51], v[50:51], v[4:5], v[66:67] op_sel:[1,1,0] op_sel_hi:[1,0,1] neg_hi:[0,1,0]
    v_pk_mul_f32 v[64:65], v[52:53], v[4:5] op_sel:[0,0] op_sel_hi:[0,1]
    v_pk_fma_f32 v[52:53], v[52:53], v[4:5], v[64:65] op_sel:[1,1,0] op_sel_hi:[1,0,1] neg_hi:[0,1,0]
    v_pk_mul_f32 v[66:67], v[54:55], v[4:5] op_sel:[0,0] op_sel_hi:[0,1]
    v_pk_fma_f32 v[54:55], v[54:55], v[4:5], v[66:67] op_sel:[1,1,0] op_sel_hi:[1,0,1] neg_hi:[0,1,0]
    v_pk_mul_f32 v[64:65], v[56:57], v[4:5] op_sel:[0,0] op_sel_hi:[0,1]
    v_pk_fma_f32 v[56:57], v[56:57], v[4:5], v[64:65] op_sel:[1,1,0] op_sel_hi:[1,0,1] neg_hi:[0,1,0]
    v_pk_mul_f32 v[66:67], v[58:59], v[4:5] op_sel:[0,0] op_sel_hi:[0,1]
    v_pk_fma_f32 v[58:59], v[58:59], v[4:5], v[66:67] op_sel:[1,1,0] op_sel_hi:[1,0,1] neg_hi:[0,1,0]
    v_pk_mul_f32 v[64:65], v[60:61], v[4:5] op_sel:[0,0] op_sel_hi:[0,1]
    v_pk_fma_f32 v[60:61], v[60:61], v[4:5], v[64:65] op_sel:[1,1,0] op_sel_hi:[1,0,1] neg_hi:[0,1,0]
    v_pk_mul_f32 v[66:67], v[62:63], v[4:5] op_sel:[0,0] op_sel_hi:[0,1]
    v_pk_fma_f32 v[62:63], v[62:63], v[4:5], v[66:67] op_sel:[1,1,0] op_sel_hi:[1,0,1] neg_hi:[0,1,0]
    v_pk_fma_f32 v[70:71], v[32:33], v[2:3], v[34:35] op_sel:[0,0,0] op_sel_hi:[1,0,1]
    v_pk_fma_f32 v[68:69], v[32:33], v[2:3], v[70:71] op_sel:[1,1,0] op_sel_hi:[0,1,1] neg_lo:[0,1,0]
    v_pk_fma_f32 v[70:71], v[68:69], v[2:3], v[36:37] op_sel:[0,0,0] op_sel_hi:[1,0,1]
    v_pk_fma_f32 v[68:69], v[68:69], v[2:3], v[70:71] op_sel:[1,1,0] op_sel_hi:[0,1,1] neg_lo:[0,1,0]
    v_pk_fma_f32 v[70:71], v[68:69], v[2:3], v[38:39] op_sel:[0,0,0] op_sel_hi:[1,0,1]
    v_pk_fma_f32 v[68:69], v[68:69], v[2:3], v[70:71] op_sel:[1,1,0] op_sel_hi:[0,1,1] neg_lo:[0,1,0]
    v_pk_fma_f32 v[70:71], v[68:69], v[2:3], v[40:41] op_sel:[0,0,0] op_sel_hi:[1,0,1]
    v_pk_fma_f32 v[68:69], v[68:69], v[2:3], v[70:71] op_sel:[1,1,0] op_sel_hi:[0,1,1] neg_lo:[0,1,0]
    v_pk_fma_f32 v[70:71], v[68:69], v[2:3], v[42:43] op_sel:[0,0,0] op_sel_hi:[1,0,1]
    v_pk_fma_f32 v[68:69], v[68:69], v[2:3], v[70:71] op_sel:[1,1,0] op_sel_hi:[0,1,1] neg_lo:[0,1,0]
    v_pk_fma_f32 v[70:71], v[68:69], v[2:3], v[44:45] op_sel:[0,0,0] op_sel_hi:[1,0,1]
    v_pk_fma_f32 v[68:69], v[68:69], v[2:3], v[70:71] op_sel:[1,1,0] op_sel_hi:[0,1,1] neg_lo:[0,1,0]
    v_pk_fma_f32 v[70:71], v[68:69], v[2:3], v[46:47] op_sel:[0,0,0] op_sel_hi:[1,0,1]
    v_pk_fma_f32 v[68:69], v[68:69], v[2:3], v[70:71] op_sel:[1,1,0] op_sel_hi:[0,1,1] neg_lo:[0,1,0]
    v_pk_fma_f32 v[70:71], v[68:69], v[2:3], v[48:49] op_sel:[0,0,0] op_sel_hi:[1,0,1]
    v_pk_fma_f32 v[68:69], v[68:69], v[2:3], v[70:71] op_sel:[1,1,0] op_sel_hi:[0,1,1] neg_lo:[0,1,0]
    v_pk_fma_f32 v[70:71], v[68:69], v[2:3], v[50:51] op_sel:[0,0,0] op_sel_hi:[1,0,1]
    v_pk_fma_f32 v[68:69], v[68:69], v[2:3], v[70:71] op_sel:[1,1,0] op_sel_hi:[0,1,1] neg_lo:[0,1,0]
    v_pk_fma_f32 v[70:71], v[68:69], v[2:3], v[52:53] op_sel:[0,0,0] op_sel_hi:[1,0,1]
    v_pk_fma_f32 v[68:69], v[68:69], v[2:3], v[70:71] op_sel:[1,1,0] op_sel_hi:[0,1,1] neg_lo:[0,1,0]
    v_pk_fma_f32 v[70:71], v[68:69], v[2:3], v[54:55] op_sel:[0,0,0] op_sel_hi:[1,0,1]
    v_pk_fma_f32 v[68:69], v[68:69], v[2:3], v[70:71] op_sel:[1,1,0] op_sel_hi:[0,1,1] neg_lo:[0,1,0]
    v_pk_fma_f32 v[70:71], v[68:69], v[2:3], v[56:57] op_sel:[0,0,0] op_sel_hi:[1,0,1]
    v_pk_fma_f32 v[68:69], v[68:69], v[2:3], v[70:71] op_sel:[1,1,0] op_sel_hi:[0,1,1] neg_lo:[0,1,0]
    v_pk_fma_f32 v[70:71], v[68:69], v[2:3], v[58:59] op_sel:[0,0,0] op_sel_hi:[1,0,1]
    v_pk_fma_f32 v[68:69], v[68:69], v[2:3], v[70:71] op_sel:[1,1,0] op_sel_hi:[0,1,1] neg_lo:[0,1,0]
    v_pk_fma_f32 v[70:71], v[68:69], v[2:3], v[60:61] op_sel:[0,0,0] op_sel_hi:[1,0,1]
    v_pk_fma_f32 v[68:69], v[68:69], v[2:3], v[70:71] op_sel:[1,1,0] op_sel_hi:[0,1,1] neg_lo:[0,1,0]
    v_pk_fma_f32 v[70:71], v[68:69], v[2:3], v[62:63] op_sel:[0,0,0] op_sel_hi:[1,0,1]
    v_pk_fma_f32 v[68:69], v[68:69], v[2:3], v[70:71] op_sel:[1,1,0] op_sel_hi:[0,1,1] neg_lo:[0,1,0]
    s_mul_i32 s64, s42, 20480
    s_add_u32 s64, s64, 294912
    s_add_u32 s60, s56, s64
    s_addc_u32 s61, s57, 0
    s_mov_b32 s62, 20480
    s_mov_b32 s63, 0x20000
    v_mov_b32 v72, v68
    v_mov_b32 v74, v68
    v_mov_b32 v73, v69
    v_mov_b32 v75, v69
    s_nop 0
    v_permlane16_swap_b32 v72, v74
    v_permlane16_swap_b32 v73, v75
    v_mov_b32 v76, v72
    v_mov_b32 v77, v73
    v_mov_b32 v78, v74
    v_mov_b32 v79, v75
    v_permlane32_swap_b32 v72, v76
    v_permlane32_swap_b32 v73, v77
    v_permlane32_swap_b32 v74, v78
    v_permlane32_swap_b32 v75, v79
    v_pk_fma_f32 v[70:71], v[72:73], v[6:7], v[74:75] op_sel:[0,0,0] op_sel_hi:[1,0,1]
    v_pk_fma_f32 v[82:83], v[72:73], v[6:7], v[70:71] op_sel:[1,1,0] op_sel_hi:[0,1,1] neg_lo:[0,1,0]
    v_pk_fma_f32 v[70:71], v[82:83], v[6:7], v[76:77] op_sel:[0,0,0] op_sel_hi:[1,0,1]
    v_pk_fma_f32 v[84:85], v[82:83], v[6:7], v[70:71] op_sel:[1,1,0] op_sel_hi:[0,1,1] neg_lo:[0,1,0]
    v_pk_fma_f32 v[70:71], v[84:85], v[6:7], v[78:79] op_sel:[0,0,0] op_sel_hi:[1,0,1]
    v_pk_fma_f32 v[86:87], v[84:85], v[6:7], v[70:71] op_sel:[1,1,0] op_sel_hi:[0,1,1] neg_lo:[0,1,0]
    s_sub_u32 s64, 31, s41
    s_mul_i32 s64, s64, 640
    s_mov_b64 exec, 0xffff
    buffer_store_dwordx2 v[86:87], v123, s[60:63], s64 offen sc1
    s_mov_b64 exec, -1
    v_mov_b32 v80, 0
    v_mov_b32 v81, 0
    v_cndmask_b32 v80, v80, v72, s[96:97]
    v_cndmask_b32 v81, v81, v73, s[96:97]
    v_cndmask_b32 v80, v80, v82, s[98:99]
    v_cndmask_b32 v81, v81, v83, s[98:99]
    v_cndmask_b32 v80, v80, v84, s[100:101]
    v_cndmask_b32 v81, v81, v85, s[100:101]
    s_lshl_b32 s68, s42, 13
    s_lshl_b32 s69, s41, 3
    s_add_u32 s68, s68, s69
    s_add_u32 s68, s68, 786432
    v_lshlrev_b32 v88, 8, v1
    v_mov_b32 v90, s6
    v_mov_b32 v91, s7
    s_lshl_b32 s69, -2, s41
    s_waitcnt vmcnt(0)
    s_barrier
    s_cmp_lg_u32 s40, 0
    s_cbranch_scc1 L_NOP2
    s_cmp_eq_u32 s69, 0
    s_cbranch_scc1 L_NOP2
    s_mov_b32 exec_lo, s69
    s_mov_b32 exec_hi, 0
    buffer_store_dwordx2 v[90:91], v88, s[56:59], s68 offen sc1
    s_mov_b64 exec, -1
L_NOP2:
    s_cmp_ge_u32 s40, 4
    s_cbranch_scc1 L_NOSKIP
    s_mov_b32 s48, s30
    s_mov_b32 s49, s31
    s_mov_b32 s50, 1280
    s_mov_b32 s51, 0x20000
    buffer_load_ushort v14, v126, s[48:51], 0 offen
    s_mov_b32 s64, 0
    buffer_load_ushort v16, v114, s[44:47], s64 offen
    s_mov_b32 s64, 1280
    buffer_load_ushort v17, v114, s[44:47], s64 offen
    s_mov_b32 s64, 2560
    buffer_load_ushort v18, v114, s[44:47], s64 offen
    s_mov_b32 s64, 3840
    buffer_load_ushort v19, v114, s[44:47], s64 offen
    s_mov_b32 s64, 10240
    buffer_load_ushort v20, v114, s[44:47], s64 offen
    s_mov_b32 s64, 11520
    buffer_load_ushort v21, v114, s[44:47], s64 offen
    s_mov_b32 s64, 12800
    buffer_load_ushort v22, v114, s[44:47], s64 offen
    s_mov_b32 s64, 14080
    buffer_load_ushort v23, v114, s[44:47], s64 offen
    s_mov_b32 s64, 20480
    buffer_load_ushort v24, v114, s[44:47], s64 offen
    s_mov_b32 s64, 21760
    buffer_load_ushort v25, v114, s[44:47], s64 offen
    s_mov_b32 s64, 23040
    buffer_load_ushort v26, v114, s[44:47], s64 offen
    s_mov_b32 s64, 24320
    buffer_load_ushort v27, v114, s[44:47], s64 offen
    s_mov_b32 s64, 30720
    buffer_load_ushort v28, v114, s[44:47], s64 offen
    s_mov_b32 s64, 32000
    buffer_load_ushort v29, v114, s[44:47], s64 offen
    s_mov_b32 s64, 33280
    buffer_load_ushort v30, v114, s[44:47], s64 offen
    s_mov_b32 s64, 34560
    buffer_load_ushort v31, v114, s[44:47], s64 offen
L_NOSKIP:
    s_movk_i32 s64, 4480
    s_barrier
    buffer_load_dwordx2 v[96:97], v124, s[60:63], s64 offen offset:0 sc1
    buffer_load_dwordx2 v[98:99], v124, s[60:63], 0 offen offset:3840 sc1
    buffer_load_dwordx2 v[100:101], v124, s[60:63], 0 offen offset:3200 sc1
    buffer_load_dwordx2 v[102:103], v124, s[60:63], 0 offen offset:2560 sc1
    buffer_load_dwordx2 v[104:105], v124, s[60:63], 0 offen offset:1920 sc1
    buffer_load_dwordx2 v[106:107], v124, s[60:63], 0 offen offset:1280 sc1
    buffer_load_dwordx2 v[108:109], v124, s[60:63], 0 offen offset:640 sc1
    buffer_load_dwordx2 v[110:111], v124, s[60:63], 0 offen offset:0 sc1
    s_waitcnt vmcnt(6)
    v_pk_fma_f32 v[70:71], v[96:97], v[10:11], v[98:99] op_sel:[0,0,0] op_sel_hi:[1,0,1]
    v_pk_fma_f32 v[68:69], v[96:97], v[10:11], v[70:71] op_sel:[1,1,0] op_sel_hi:[0,1,1] neg_lo:[0,1,0]
    s_waitcnt vmcnt(5)
    v_pk_fma_f32 v[70:71], v[68:69], v[10:11], v[100:101] op_sel:[0,0,0] op_sel_hi:[1,0,1]
    v_pk_fma_f32 v[68:69], v[68:69], v[10:11], v[70:71] op_sel:[1,1,0] op_sel_hi:[0,1,1] neg_lo:[0,1,0]
    s_waitcnt vmcnt(4)
    v_pk_fma_f32 v[70:71], v[68:69], v[10:11], v[102:103] op_sel:[0,0,0] op_sel_hi:[1,0,1]
    v_pk_fma_f32 v[68:69], v[68:69], v[10:11], v[70:71] op_sel:[1,1,0] op_sel_hi:[0,1,1] neg_lo:[0,1,0]
    s_waitcnt vmcnt(3)
    v_pk_fma_f32 v[70:71], v[68:69], v[10:11], v[104:105] op_sel:[0,0,0] op_sel_hi:[1,0,1]
    v_pk_fma_f32 v[68:69], v[68:69], v[10:11], v[70:71] op_sel:[1,1,0] op_sel_hi:[0,1,1] neg_lo:[0,1,0]
    s_waitcnt vmcnt(2)
    v_pk_fma_f32 v[70:71], v[68:69], v[10:11], v[106:107] op_sel:[0,0,0] op_sel_hi:[1,0,1]
    v_pk_fma_f32 v[68:69], v[68:69], v[10:11], v[70:71] op_sel:[1,1,0] op_sel_hi:[0,1,1] neg_lo:[0,1,0]
    s_waitcnt vmcnt(1)
    v_pk_fma_f32 v[70:71], v[68:69], v[10:11], v[108:109] op_sel:[0,0,0] op_sel_hi:[1,0,1]
    v_pk_fma_f32 v[68:69], v[68:69], v[10:11], v[70:71] op_sel:[1,1,0] op_sel_hi:[0,1,1] neg_lo:[0,1,0]
    s_waitcnt vmcnt(0)
    v_pk_fma_f32 v[70:71], v[68:69], v[10:11], v[110:111] op_sel:[0,0,0] op_sel_hi:[1,0,1]
    v_pk_fma_f32 v[68:69], v[68:69], v[10:11], v[70:71] op_sel:[1,1,0] op_sel_hi:[0,1,1] neg_lo:[0,1,0]
    v_mov_b32 v72, v68
    v_mov_b32 v74, v68
    v_mov_b32 v73, v69
    v_mov_b32 v75, v69
    s_nop 0
    v_permlane16_swap_b32 v72, v74
    v_permlane16_swap_b32 v73, v75
    v_mov_b32 v76, v72
    v_mov_b32 v77, v73
    v_mov_b32 v78, v74
    v_mov_b32 v79, v75
    v_permlane32_swap_b32 v72, v76
    v_permlane32_swap_b32 v73, v77
    v_permlane32_swap_b32 v74, v78
    v_permlane32_swap_b32 v75, v79
    v_pk_fma_f32 v[70:71], v[78:79], v[12:13], v[76:77] op_sel:[0,0,0] op_sel_hi:[1,0,1]
    v_pk_fma_f32 v[68:69], v[78:79], v[12:13], v[70:71] op_sel:[1,1,0] op_sel_hi:[0,1,1] neg_lo:[0,1,0]
    v_pk_fma_f32 v[70:71], v[68:69], v[12:13], v[74:75] op_sel:[0,0,0] op_sel_hi:[1,0,1]
    v_pk_fma_f32 v[68:69], v[68:69], v[12:13], v[70:71] op_sel:[1,1,0] op_sel_hi:[0,1,1] neg_lo:[0,1,0]
    v_pk_fma_f32 v[70:71], v[68:69], v[12:13], v[72:73] op_sel:[0,0,0] op_sel_hi:[1,0,1]
    v_pk_fma_f32 v[68:69], v[68:69], v[12:13], v[70:71] op_sel:[1,1,0] op_sel_hi:[0,1,1] neg_lo:[0,1,0]
    v_pk_fma_f32 v[70:71], v[68:69], v[8:9], v[80:81] op_sel:[0,0,0] op_sel_hi:[1,0,1]
    v_pk_fma_f32 v[68:69], v[68:69], v[8:9], v[70:71] op_sel:[1,1,0] op_sel_hi:[0,1,1] neg_lo:[0,1,0]
    s_mul_i32 s64, s41, 163840
    s_add_u32 s64, s64, 13631488
    v_pk_fma_f32 v[70:71], v[68:69], v[2:3], v[32:33] op_sel:[0,0,0] op_sel_hi:[1,0,1]
    v_pk_fma_f32 v[32:33], v[68:69], v[2:3], v[70:71] op_sel:[1,1,0] op_sel_hi:[0,1,1] neg_lo:[0,1,0]
    v_pk_fma_f32 v[70:71], v[32:33], v[2:3], v[34:35] op_sel:[0,0,0] op_sel_hi:[1,0,1]
    v_pk_fma_f32 v[34:35], v[32:33], v[2:3], v[70:71] op_sel:[1,1,0] op_sel_hi:[0,1,1] neg_lo:[0,1,0]
    v_pk_fma_f32 v[70:71], v[34:35], v[2:3], v[36:37] op_sel:[0,0,0] op_sel_hi:[1,0,1]
    v_pk_fma_f32 v[36:37], v[34:35], v[2:3], v[70:71] op_sel:[1,1,0] op_sel_hi:[0,1,1] neg_lo:[0,1,0]
    v_pk_fma_f32 v[70:71], v[36:37], v[2:3], v[38:39] op_sel:[0,0,0] op_sel_hi:[1,0,1]
    v_pk_fma_f32 v[38:39], v[36:37], v[2:3], v[70:71] op_sel:[1,1,0] op_sel_hi:[0,1,1] neg_lo:[0,1,0]
    v_pk_fma_f32 v[70:71], v[38:39], v[2:3], v[40:41] op_sel:[0,0,0] op_sel_hi:[1,0,1]
    v_pk_fma_f32 v[40:41], v[38:39], v[2:3], v[70:71] op_sel:[1,1,0] op_sel_hi:[0,1,1] neg_lo:[0,1,0]
    v_pk_fma_f32 v[70:71], v[40:41], v[2:3], v[42:43] op_sel:[0,0,0] op_sel_hi:[1,0,1]
    v_pk_fma_f32 v[42:43], v[40:41], v[2:3], v[70:71] op_sel:[1,1,0] op_sel_hi:[0,1,1] neg_lo:[0,1,0]
    v_pk_fma_f32 v[70:71], v[42:43], v[2:3], v[44:45] op_sel:[0,0,0] op_sel_hi:[1,0,1]
    v_pk_fma_f32 v[44:45], v[42:43], v[2:3], v[70:71] op_sel:[1,1,0] op_sel_hi:[0,1,1] neg_lo:[0,1,0]
    v_pk_fma_f32 v[70:71], v[44:45], v[2:3], v[46:47] op_sel:[0,0,0] op_sel_hi:[1,0,1]
    v_pk_fma_f32 v[46:47], v[44:45], v[2:3], v[70:71] op_sel:[1,1,0] op_sel_hi:[0,1,1] neg_lo:[0,1,0]
    v_cvt_pk_bf16_f32 v72, v32, v34
    v_cvt_pk_bf16_f32 v73, v36, v38
    v_cvt_pk_bf16_f32 v74, v40, v42
    v_cvt_pk_bf16_f32 v75, v44, v46
    s_add_u32 s65, s64, 0
    buffer_store_dwordx4 v[72:75], v125, s[56:59], s65 offen sc1
    v_cvt_pk_bf16_f32 v76, v33, v35
    v_cvt_pk_bf16_f32 v77, v37, v39
    v_cvt_pk_bf16_f32 v78, v41, v43
    v_cvt_pk_bf16_f32 v79, v45, v47
    s_add_u32 s65, s64, 10240
    buffer_store_dwordx4 v[76:79], v125, s[56:59], s65 offen sc1
    v_pk_fma_f32 v[70:71], v[46:47], v[2:3], v[48:49] op_sel:[0,0,0] op_sel_hi:[1,0,1]
    v_pk_fma_f32 v[48:49], v[46:47], v[2:3], v[70:71] op_sel:[1,1,0] op_sel_hi:[0,1,1] neg_lo:[0,1,0]
    v_pk_fma_f32 v[70:71], v[48:49], v[2:3], v[50:51] op_sel:[0,0,0] op_sel_hi:[1,0,1]
    v_pk_fma_f32 v[50:51], v[48:49], v[2:3], v[70:71] op_sel:[1,1,0] op_sel_hi:[0,1,1] neg_lo:[0,1,0]
    v_pk_fma_f32 v[70:71], v[50:51], v[2:3], v[52:53] op_sel:[0,0,0] op_sel_hi:[1,0,1]
    v_pk_fma_f32 v[52:53], v[50:51], v[2:3], v[70:71] op_sel:[1,1,0] op_sel_hi:[0,1,1] neg_lo:[0,1,0]
    v_pk_fma_f32 v[70:71], v[52:53], v[2:3], v[54:55] op_sel:[0,0,0] op_sel_hi:[1,0,1]
    v_pk_fma_f32 v[54:55], v[52:53], v[2:3], v[70:71] op_sel:[1,1,0] op_sel_hi:[0,1,1] neg_lo:[0,1,0]
    v_pk_fma_f32 v[70:71], v[54:55], v[2:3], v[56:57] op_sel:[0,0,0] op_sel_hi:[1,0,1]
    v_pk_fma_f32 v[56:57], v[54:55], v[2:3], v[70:71] op_sel:[1,1,0] op_sel_hi:[0,1,1] neg_lo:[0,1,0]
    v_pk_fma_f32 v[70:71], v[56:57], v[2:3], v[58:59] op_sel:[0,0,0] op_sel_hi:[1,0,1]
    v_pk_fma_f32 v[58:59], v[56:57], v[2:3], v[70:71] op_sel:[1,1,0] op_sel_hi:[0,1,1] neg_lo:[0,1,0]
    v_pk_fma_f32 v[70:71], v[58:59], v[2:3], v[60:61] op_sel:[0,0,0] op_sel_hi:[1,0,1]
    v_pk_fma_f32 v[60:61], v[58:59], v[2:3], v[70:71] op_sel:[1,1,0] op_sel_hi:[0,1,1] neg_lo:[0,1,0]
    v_pk_fma_f32 v[70:71], v[60:61], v[2:3], v[62:63] op_sel:[0,0,0] op_sel_hi:[1,0,1]
    v_pk_fma_f32 v[62:63], v[60:61], v[2:3], v[70:71] op_sel:[1,1,0] op_sel_hi:[0,1,1] neg_lo:[0,1,0]
    v_cvt_pk_bf16_f32 v80, v48, v50
    v_cvt_pk_bf16_f32 v81, v52, v54
    v_cvt_pk_bf16_f32 v82, v56, v58
    v_cvt_pk_bf16_f32 v83, v60, v62
    s_add_u32 s65, s64, 20480
    buffer_store_dwordx4 v[80:83], v125, s[56:59], s65 offen sc1
    v_cvt_pk_bf16_f32 v84, v49, v51
    v_cvt_pk_bf16_f32 v85, v53, v55
    v_cvt_pk_bf16_f32 v86, v57, v59
    v_cvt_pk_bf16_f32 v87, v61, v63
    s_add_u32 s65, s64, 30720
    buffer_store_dwordx4 v[84:87], v125, s[56:59], s65 offen sc1
    s_waitcnt vmcnt(0)
L_B_H:
    s_setprio 3
    s_barrier
    s_cmp_lg_u32 s40, 0
    s_cbranch_scc1 L_NOP3
    s_lshl_b32 s68, s41, 10
    s_lshl_b32 s69, s42, 3
    s_add_u32 s68, s68, s69
    s_add_u32 s68, s68, 851968
    v_lshlrev_b32 v88, 7, v1
    s_mov_b64 exec, 0xff
    buffer_store_dwordx2 v[90:91], v88, s[56:59], s68 offen sc1
    s_mov_b64 exec, -1
L_NOP3:
    s_cmp_ge_u32 s40, 4
    s_cbranch_scc1 L_B_SMALL
    s_lshr_b32 s64, s40, 1
    s_mul_i32 s64, s64, 51200
    v_add_u32 v10, s64, v116
    v_mov_b32 v8, v116
    v_mov_b32 v2, v112
    v_mov_b32 v3, v113
    v_mov_b32 v4, v122
    v_mov_b32 v5, v115
    v_mov_b32 v6, v118
    v_mov_b32 v9, v117
    ds_read_b64_tr_b16 v[48:49], v10 offset:0
    ds_read_b64_tr_b16 v[50:51], v10 offset:160
    ds_read_b64_tr_b16 v[52:53], v10 offset:2560
    ds_read_b64_tr_b16 v[54:55], v10 offset:2720
    ds_read_b64_tr_b16 v[56:57], v10 offset:5120
    ds_read_b64_tr_b16 v[58:59], v10 offset:5280
    ds_read_b64_tr_b16 v[60:61], v10 offset:7680
    ds_read_b64_tr_b16 v[62:63], v10 offset:7840
    ds_read_b64_tr_b16 v[64:65], v10 offset:10240
    ds_read_b64_tr_b16 v[66:67], v10 offset:10400
    ds_read_b64_tr_b16 v[68:69], v10 offset:12800
    ds_read_b64_tr_b16 v[70:71], v10 offset:12960
    ds_read_b64_tr_b16 v[72:73], v10 offset:15360
    ds_read_b64_tr_b16 v[74:75], v10 offset:15520
    ds_read_b64_tr_b16 v[76:77], v10 offset:17920
    ds_read_b64_tr_b16 v[78:79], v10 offset:18080
    ds_read_b64_tr_b16 v[80:81], v10 offset:20480
    ds_read_b64_tr_b16 v[82:83], v10 offset:20640
    ds_read_b64_tr_b16 v[84:85], v10 offset:23040
    ds_read_b64_tr_b16 v[86:87], v10 offset:23200
    ds_read_b64_tr_b16 v[88:89], v10 offset:25600
    ds_read_b64_tr_b16 v[90:91], v10 offset:25760
    ds_read_b64_tr_b16 v[92:93], v10 offset:28160
    ds_read_b64_tr_b16 v[94:95], v10 offset:28320
    s_cmp_ge_u32 s40, 2
    s_cbranch_scc1 L_WR0
    ds_read_b64_tr_b16 v[96:97], v10 offset:30720
    ds_read_b64_tr_b16 v[98:99], v10 offset:30880
    ds_read_b64_tr_b16 v[100:101], v10 offset:33280
    ds_read_b64_tr_b16 v[102:103], v10 offset:33440
    ds_read_b64_tr_b16 v[104:105], v10 offset:35840
    ds_read_b64_tr_b16 v[106:107], v10 offset:36000
    ds_read_b64_tr_b16 v[108:109], v10 offset:38400
    ds_read_b64_tr_b16 v[110:111], v10 offset:38560
    ds_read_b64_tr_b16 v[112:113], v10 offset:40960
    ds_read_b64_tr_b16 v[114:115], v10 offset:41120
    ds_read_b64_tr_b16 v[116:117], v10 offset:43520
    ds_read_b64_tr_b16 v[118:119], v10 offset:43680
    ds_read_b64_tr_b16 v[120:121], v10 offset:46080
    ds_read_b64_tr_b16 v[122:123], v10 offset:46240
    ds_read_b64_tr_b16 v[124:125], v10 offset:48640
    ds_read_b64_tr_b16 v[126:127], v10 offset:48800
L_WR0:
    v_dot2_f32_bf16 v16, v16, v14, 0
    v_dot2_f32_bf16 v17, v17, v14, 0
    v_dot2_f32_bf16 v18, v18, v14, 0
    v_dot2_f32_bf16 v19, v19, v14, 0
    v_dot2_f32_bf16 v20, v20, v14, 0
    v_dot2_f32_bf16 v21, v21, v14, 0
    v_dot2_f32_bf16 v22, v22, v14, 0
    v_dot2_f32_bf16 v23, v23, v14, 0
    v_dot2_f32_bf16 v24, v24, v14, 0
    v_dot2_f32_bf16 v25, v25, v14, 0
    v_dot2_f32_bf16 v26, v26, v14, 0
    v_dot2_f32_bf16 v27, v27, v14, 0
    v_dot2_f32_bf16 v28, v28, v14, 0
    v_dot2_f32_bf16 v29, v29, v14, 0
    v_dot2_f32_bf16 v30, v30, v14, 0
    v_dot2_f32_bf16 v31, v31, v14, 0
    s_lshl_b32 s45, s41, 3
    s_add_u32 s45, s45, s42
    s_lshl_b32 s45, s45, 7
    s_add_u32 s45, s45, 851968
    s_mov_b32 s48, s12
    s_mov_b32 s49, s13
    s_mov_b32 s50, 819200
    s_mov_b32 s51, 0x20000
    s_lshl_b32 s46, s40, 10
    s_waitcnt lgkmcnt(0)
    s_barrier
    s_load_dwordx16 s[8:23], s[56:57], s45 glc
    s_add_u32 m0, s46, 0
    s_mov_b32 s64, 655360
    buffer_load_dwordx4 v9, s[48:51], s64 offen lds
    s_add_u32 m0, s46, 5120
    s_mov_b32 s64, 696320
    buffer_load_dwordx4 v9, s[48:51], s64 offen lds
    s_add_u32 m0, s46, 10240
    s_mov_b32 s64, 737280
    buffer_load_dwordx4 v9, s[48:51], s64 offen lds
    s_add_u32 m0, s46, 15360
    s_mov_b32 s64, 778240
    buffer_load_dwordx4 v9, s[48:51], s64 offen lds
WD_35:
    s_mov_b32 s48, s24
    s_mov_b32 s49, s25
    s_mov_b32 s50, 819200
    s_mov_b32 s51, 0x20000
    s_mov_b32 s52, s26
    s_mov_b32 s53, s27
    s_mov_b32 s54, 819200
    s_mov_b32 s55, 0x20000
    s_mul_i32 s44, s41, 163840
    s_mul_i32 s64, s40, 40960
    s_add_u32 s44, s44, s64
    s_add_u32 s44, s44, 13631488
    v_xor_b32 v0, 32, v3
    v_xor_b32 v1, 64, v3
    v_xor_b32 v7, 96, v3
    s_mul_i32 s39, s40, 2176
    s_lshl_b32 s43, s37, 10
    s_waitcnt lgkmcnt(0)
    s_mov_b32 s65, 0
    s_cmp_eq_u64 s[8:9], s[6:7]
    s_addc_u32 s65, s65, s65
    s_cmp_eq_u64 s[10:11], s[6:7]
    s_addc_u32 s65, s65, s65
    s_cmp_eq_u64 s[12:13], s[6:7]
    s_addc_u32 s65, s65, s65
    s_cmp_eq_u64 s[14:15], s[6:7]
    s_addc_u32 s65, s65, s65
    s_cmp_eq_u64 s[16:17], s[6:7]
    s_addc_u32 s65, s65, s65
    s_cmp_eq_u64 s[18:19], s[6:7]
    s_addc_u32 s65, s65, s65
    s_cmp_eq_u64 s[20:21], s[6:7]
    s_addc_u32 s65, s65, s65
    s_cmp_eq_u64 s[22:23], s[6:7]
    s_addc_u32 s65, s65, s65
    s_cmp_eq_u32 s65, 255
    s_cbranch_scc1 L_F3OK
    s_mov_b32 s64, 400000
SP_36:
    s_load_dwordx16 s[8:23], s[56:57], s45 offset:0 glc
    s_mov_b32 s65, 0
    s_waitcnt lgkmcnt(0)
    s_cmp_eq_u64 s[8:9], s[6:7]
    s_addc_u32 s65, s65, s65
    s_cmp_eq_u64 s[10:11], s[6:7]
    s_addc_u32 s65, s65, s65
    s_cmp_eq_u64 s[12:13], s[6:7]
    s_addc_u32 s65, s65, s65
    s_cmp_eq_u64 s[14:15], s[6:7]
    s_addc_u32 s65, s65, s65
    s_cmp_eq_u64 s[16:17], s[6:7]
    s_addc_u32 s65, s65, s65
    s_cmp_eq_u64 s[18:19], s[6:7]
    s_addc_u32 s65, s65, s65
    s_cmp_eq_u64 s[20:21], s[6:7]
    s_addc_u32 s65, s65, s65
    s_cmp_eq_u64 s[22:23], s[6:7]
    s_addc_u32 s65, s65, s65
    s_cmp_eq_u32 s65, 255
    s_cbranch_scc1 SD_37
    s_sleep 2
    s_sub_u32 s64, s64, 1
    s_cmp_lg_u32 s64, 0
    s_cbranch_scc1 SP_36
SD_37:
L_F3OK:
    s_add_u32 m0, s39, 56832
    s_add_u32 s64, s44, s43
    buffer_load_dwordx4 v4, s[56:59], s64 offen sc1 lds
    s_add_u32 m0, s39, 57920
    s_add_u32 s64, s44, s43
    s_add_u32 s64, s64, 20480
    buffer_load_dwordx4 v4, s[56:59], s64 offen sc1 lds
    s_add_u32 s43, s43, 1024
    s_cmp_eq_u32 s43, 10240
    s_cselect_b32 s43, 0, s43
    s_waitcnt vmcnt(2)
    s_barrier
    s_sub_u32 s66, s2, 256
    s_lshl_b32 s66, s66, 7
    s_add_u32 s66, s66, 65536
    s_load_dwordx2 s[8:9], s[56:57], s66 glc
    s_cmp_lt_u32 s40, 2
    s_cbranch_scc1 L_WR1
    ds_read_b64_tr_b16 v[96:97], v8 offset:0
    ds_read_b64_tr_b16 v[98:99], v8 offset:160
    ds_read_b64_tr_b16 v[100:101], v8 offset:2560
    ds_read_b64_tr_b16 v[102:103], v8 offset:2720
    ds_read_b64_tr_b16 v[104:105], v8 offset:5120
    ds_read_b64_tr_b16 v[106:107], v8 offset:5280
    ds_read_b64_tr_b16 v[108:109], v8 offset:7680
    ds_read_b64_tr_b16 v[110:111], v8 offset:7840
    ds_read_b64_tr_b16 v[112:113], v8 offset:10240
    ds_read_b64_tr_b16 v[114:115], v8 offset:10400
    ds_read_b64_tr_b16 v[116:117], v8 offset:12800
    ds_read_b64_tr_b16 v[118:119], v8 offset:12960
    ds_read_b64_tr_b16 v[120:121], v8 offset:15360
    ds_read_b64_tr_b16 v[122:123], v8 offset:15520
    ds_read_b64_tr_b16 v[124:125], v8 offset:17920
    ds_read_b64_tr_b16 v[126:127], v8 offset:18080
L_WR1:
    s_waitcnt lgkmcnt(0)
    s_barrier
    s_waitcnt vmcnt(0)
    s_add_u32 m0, s39, 0
    s_add_u32 s64, s44, s43
    buffer_load_dwordx4 v4, s[56:59], s64 offen sc1 lds
    s_add_u32 m0, s39, 1088
    s_add_u32 s64, s44, s43
    s_add_u32 s64, s64, 20480
    buffer_load_dwordx4 v4, s[56:59], s64 offen sc1 lds
    s_add_u32 s43, s43, 1024
    s_cmp_eq_u32 s43, 10240
    s_cselect_b32 s43, 0, s43
    s_add_u32 m0, s39, 18944
    s_add_u32 s64, s44, s43
    buffer_load_dwordx4 v4, s[56:59], s64 offen sc1 lds
    s_add_u32 m0, s39, 20032
    s_add_u32 s64, s44, s43
    s_add_u32 s64, s64, 20480
    buffer_load_dwordx4 v4, s[56:59], s64 offen sc1 lds
    s_add_u32 s43, s43, 1024
    s_cmp_eq_u32 s43, 10240
    s_cselect_b32 s43, 0, s43
    s_add_u32 m0, s39, 37888
    s_add_u32 s64, s44, s43
    buffer_load_dwordx4 v4, s[56:59], s64 offen sc1 lds
    s_add_u32 m0, s39, 38976
    s_add_u32 s64, s44, s43
    s_add_u32 s64, s64, 20480
    buffer_load_dwordx4 v4, s[56:59], s64 offen sc1 lds
    s_add_u32 s43, s43, 1024
    s_cmp_eq_u32 s43, 10240
    s_cselect_b32 s43, 0, s43
    s_cmp_eq_u64 s[8:9], s[6:7]
    s_cbranch_scc1 G2W_38
    s_cmp_lg_u32 s40, 0
    s_cbranch_scc1 G2W_38
    s_mov_b32 s64, 400000
SP_39:
    s_load_dwordx2 s[8:9], s[56:57], s66 offset:0 glc
    s_mov_b32 s65, 0
    s_waitcnt lgkmcnt(0)
    s_cmp_eq_u64 s[8:9], s[6:7]
    s_addc_u32 s65, s65, s65
    s_cmp_eq_u32 s65, 1
    s_cbranch_scc1 SD_40
    s_sleep 2
    s_sub_u32 s64, s64, 1
    s_cmp_lg_u32 s64, 0
    s_cbranch_scc1 SP_39
SD_40:
G2W_38:
    s_setprio 3
    s_barrier
    ds_read_b64_tr_b16 v[32:33], v2 offset:56832
    ds_read_b64_tr_b16 v[34:35], v2 offset:56896
    ds_read_b128 v[36:39], v3 offset:56832
    ds_read_b64_tr_b16 v[40:41], v2 offset:57088
    ds_read_b64_tr_b16 v[42:43], v2 offset:57152
    ds_read_b128 v[44:47], v0 offset:56832
    ds_read_b64_tr_b16 v[8:9], v2 offset:57344
    ds_read_b64_tr_b16 v[10:11], v2 offset:57408
    ds_read_b128 v[12:15], v1 offset:56832
    s_waitcnt lgkmcnt(6)
    s_setprio 0
    v_mfma_f32_32x32x16_bf16 v[16:31], v[32:35], v[36:39], v[16:31]
    s_setprio 3
    ds_read_b64_tr_b16 v[32:33], v2 offset:57600
    ds_read_b64_tr_b16 v[34:35], v2 offset:57664
    ds_read_b128 v[36:39], v7 offset:56832
    s_waitcnt lgkmcnt(6)
    s_setprio 0
    v_mfma_f32_32x32x16_bf16 v[16:31], v[40:43], v[44:47], v[16:31]
    s_setprio 3
    s_waitcnt lgkmcnt(3)
    s_setprio 0
    v_mfma_f32_32x32x16_bf16 v[16:31], v[8:11], v[12:15], v[16:31]
    s_setprio 3
    s_waitcnt lgkmcnt(0)
    s_waitcnt vmcnt(4)
    s_barrier
    ds_read_b64_tr_b16 v[40:41], v2 offset:0
    ds_read_b64_tr_b16 v[42:43], v2 offset:64
    ds_read_b128 v[44:47], v3 offset:0
    ds_read_b64_tr_b16 v[8:9], v2 offset:256
    ds_read_b64_tr_b16 v[10:11], v2 offset:320
    ds_read_b128 v[12:15], v0 offset:0
    s_setprio 0
    v_mfma_f32_32x32x16_bf16 v[16:31], v[32:35], v[36:39], v[16:31]
    s_setprio 3
    ds_read_b64_tr_b16 v[32:33], v2 offset:512
    ds_read_b64_tr_b16 v[34:35], v2 offset:576
    ds_read_b128 v[36:39], v1 offset:0
    s_waitcnt lgkmcnt(6)
    s_setprio 0
    v_mfma_f32_32x32x16_bf16 v[16:31], v[40:43], v[44:47], v[16:31]
    s_setprio 3
    ds_read_b64_tr_b16 v[40:41], v2 offset:768
    ds_read_b64_tr_b16 v[42:43], v2 offset:832
    ds_read_b128 v[44:47], v7 offset:0
    s_add_u32 m0, s39, 56832
    s_add_u32 s64, s44, s43
    buffer_load_dwordx4 v4, s[56:59], s64 offen sc1 lds
    s_add_u32 m0, s39, 57920
    s_add_u32 s64, s44, s43
    s_add_u32 s64, s64, 20480
    buffer_load_dwordx4 v4, s[56:59], s64 offen sc1 lds
    s_add_u32 s43, s43, 1024
    s_cmp_eq_u32 s43, 10240
    s_cselect_b32 s43, 0, s43
    s_waitcnt lgkmcnt(6)
    s_setprio 0
    v_mfma_f32_32x32x16_bf16 v[16:31], v[8:11], v[12:15], v[16:31]
    s_setprio 3
    s_waitcnt lgkmcnt(3)
    s_setprio 0
    v_mfma_f32_32x32x16_bf16 v[16:31], v[32:35], v[36:39], v[16:31]
    s_setprio 3
    s_waitcnt lgkmcnt(0)
    s_waitcnt vmcnt(4)
    s_barrier
    ds_read_b64_tr_b16 v[8:9], v2 offset:18944
    ds_read_b64_tr_b16 v[10:11], v2 offset:19008
    ds_read_b128 v[12:15], v3 offset:18944
    ds_read_b64_tr_b16 v[32:33], v2 offset:19200
    ds_read_b64_tr_b16 v[34:35], v2 offset:19264
    ds_read_b128 v[36:39], v0 offset:18944
    s_setprio 0
    v_mfma_f32_32x32x16_bf16 v[16:31], v[40:43], v[44:47], v[16:31]
    s_setprio 3
    ds_read_b64_tr_b16 v[40:41], v2 offset:19456
    ds_read_b64_tr_b16 v[42:43], v2 offset:19520
    ds_read_b128 v[44:47], v1 offset:18944
    s_waitcnt lgkmcnt(6)
    s_setprio 0
    v_mfma_f32_32x32x16_bf16 v[16:31], v[8:11], v[12:15], v[16:31]
    s_setprio 3
    ds_read_b64_tr_b16 v[8:9], v2 offset:19712
    ds_read_b64_tr_b16 v[10:11], v2 offset:19776
    ds_read_b128 v[12:15], v7 offset:18944
    s_add_u32 m0, s39, 0
    s_add_u32 s64, s44, s43
    buffer_load_dwordx4 v4, s[56:59], s64 offen sc1 lds
    s_add_u32 m0, s39, 1088
    s_add_u32 s64, s44, s43
    s_add_u32 s64, s64, 20480
    buffer_load_dwordx4 v4, s[56:59], s64 offen sc1 lds
    s_add_u32 s43, s43, 1024
    s_cmp_eq_u32 s43, 10240
    s_cselect_b32 s43, 0, s43
    s_waitcnt lgkmcnt(6)
    s_setprio 0
    v_mfma_f32_32x32x16_bf16 v[16:31], v[32:35], v[36:39], v[16:31]
    s_setprio 3
    s_waitcnt lgkmcnt(3)
    s_setprio 0
    v_mfma_f32_32x32x16_bf16 v[16:31], v[40:43], v[44:47], v[16:31]
    s_setprio 3
    s_waitcnt lgkmcnt(0)
    s_waitcnt vmcnt(4)
    s_barrier
    ds_read_b64_tr_b16 v[32:33], v2 offset:37888
    ds_read_b64_tr_b16 v[34:35], v2 offset:37952
    ds_read_b128 v[36:39], v3 offset:37888
    ds_read_b64_tr_b16 v[40:41], v2 offset:38144
    ds_read_b64_tr_b16 v[42:43], v2 offset:38208
    ds_read_b128 v[44:47], v0 offset:37888
    s_setprio 0
    v_mfma_f32_32x32x16_bf16 v[16:31], v[8:11], v[12:15], v[16:31]
    s_setprio 3
    ds_read_b64_tr_b16 v[8:9], v2 offset:38400
    ds_read_b64_tr_b16 v[10:11], v2 offset:38464
    ds_read_b128 v[12:15], v1 offset:37888
    s_waitcnt lgkmcnt(6)
    s_setprio 0
    v_mfma_f32_32x32x16_bf16 v[16:31], v[32:35], v[36:39], v[16:31]
    s_setprio 3
    ds_read_b64_tr_b16 v[32:33], v2 offset:38656
    ds_read_b64_tr_b16 v[34:35], v2 offset:38720
    ds_read_b128 v[36:39], v7 offset:37888
    s_add_u32 m0, s39, 18944
    s_add_u32 s64, s44, s43
    buffer_load_dwordx4 v4, s[56:59], s64 offen sc1 lds
    s_add_u32 m0, s39, 20032
    s_add_u32 s64, s44, s43
    s_add_u32 s64, s64, 20480
    buffer_load_dwordx4 v4, s[56:59], s64 offen sc1 lds
    s_add_u32 s43, s43, 1024
    s_cmp_eq_u32 s43, 10240
    s_cselect_b32 s43, 0, s43
    s_waitcnt lgkmcnt(6)
    s_setprio 0
    v_mfma_f32_32x32x16_bf16 v[16:31], v[40:43], v[44:47], v[16:31]
    s_setprio 3
    s_waitcnt lgkmcnt(3)
    s_setprio 0
    v_mfma_f32_32x32x16_bf16 v[16:31], v[8:11], v[12:15], v[16:31]
    s_setprio 3
    s_waitcnt lgkmcnt(0)
    s_waitcnt vmcnt(4)
    s_barrier
    ds_read_b64_tr_b16 v[40:41], v2 offset:56832
    ds_read_b64_tr_b16 v[42:43], v2 offset:56896
    ds_read_b128 v[44:47], v3 offset:56832
    ds_read_b64_tr_b16 v[8:9], v2 offset:57088
    ds_read_b64_tr_b16 v[10:11], v2 offset:57152
    ds_read_b128 v[12:15], v0 offset:56832
    s_setprio 0
    v_mfma_f32_32x32x16_bf16 v[16:31], v[32:35], v[36:39], v[16:31]
    s_setprio 3
    ds_read_b64_tr_b16 v[32:33], v2 offset:57344
    ds_read_b64_tr_b16 v[34:35], v2 offset:57408
    ds_read_b128 v[36:39], v1 offset:56832
    s_waitcnt lgkmcnt(6)
    s_setprio 0
    v_mfma_f32_32x32x16_bf16 v[16:31], v[40:43], v[44:47], v[16:31]
    s_setprio 3
    ds_read_b64_tr_b16 v[40:41], v2 offset:57600
    ds_read_b64_tr_b16 v[42:43], v2 offset:57664
    ds_read_b128 v[44:47], v7 offset:56832
    s_add_u32 m0, s39, 37888
    s_add_u32 s64, s44, s43
    buffer_load_dwordx4 v4, s[56:59], s64 offen sc1 lds
    s_add_u32 m0, s39, 38976
    s_add_u32 s64, s44, s43
    s_add_u32 s64, s64, 20480
    buffer_load_dwordx4 v4, s[56:59], s64 offen sc1 lds
    s_add_u32 s43, s43, 1024
    s_cmp_eq_u32 s43, 10240
    s_cselect_b32 s43, 0, s43
    s_waitcnt lgkmcnt(6)
    s_setprio 0
    v_mfma_f32_32x32x16_bf16 v[16:31], v[8:11], v[12:15], v[16:31]
    s_setprio 3
    s_waitcnt lgkmcnt(3)
    s_setprio 0
    v_mfma_f32_32x32x16_bf16 v[16:31], v[32:35], v[36:39], v[16:31]
    s_setprio 3
    s_waitcnt lgkmcnt(0)
    s_waitcnt vmcnt(4)
    s_barrier
    ds_read_b64_tr_b16 v[8:9], v2 offset:0
    ds_read_b64_tr_b16 v[10:11], v2 offset:64
    ds_read_b128 v[12:15], v3 offset:0
    ds_read_b64_tr_b16 v[32:33], v2 offset:256
    ds_read_b64_tr_b16 v[34:35], v2 offset:320
    ds_read_b128 v[36:39], v0 offset:0
    s_setprio 0
    v_mfma_f32_32x32x16_bf16 v[16:31], v[40:43], v[44:47], v[16:31]
    s_setprio 3
    ds_read_b64_tr_b16 v[40:41], v2 offset:512
    ds_read_b64_tr_b16 v[42:43], v2 offset:576
    ds_read_b128 v[44:47], v1 offset:0
    s_waitcnt lgkmcnt(6)
    s_setprio 0
    v_mfma_f32_32x32x16_bf16 v[16:31], v[8:11], v[12:15], v[16:31]
    s_setprio 3
    ds_read_b64_tr_b16 v[8:9], v2 offset:768
    ds_read_b64_tr_b16 v[10:11], v2 offset:832
    ds_read_b128 v[12:15], v7 offset:0
    s_add_u32 m0, s39, 56832
    s_add_u32 s64, s44, s43
    buffer_load_dwordx4 v4, s[56:59], s64 offen sc1 lds
    s_add_u32 m0, s39, 57920
    s_add_u32 s64, s44, s43
    s_add_u32 s64, s64, 20480
    buffer_load_dwordx4 v4, s[56:59], s64 offen sc1 lds
    s_add_u32 s43, s43, 1024
    s_cmp_eq_u32 s43, 10240
    s_cselect_b32 s43, 0, s43
    s_waitcnt lgkmcnt(6)
    s_setprio 0
    v_mfma_f32_32x32x16_bf16 v[16:31], v[32:35], v[36:39], v[16:31]
    s_setprio 3
    s_waitcnt lgkmcnt(3)
    s_setprio 0
    v_mfma_f32_32x32x16_bf16 v[16:31], v[40:43], v[44:47], v[16:31]
    s_setprio 3
    s_waitcnt lgkmcnt(0)
    s_waitcnt vmcnt(4)
    s_barrier
    ds_read_b64_tr_b16 v[32:33], v2 offset:18944
    ds_read_b64_tr_b16 v[34:35], v2 offset:19008
    ds_read_b128 v[36:39], v3 offset:18944
    ds_read_b64_tr_b16 v[40:41], v2 offset:19200
    ds_read_b64_tr_b16 v[42:43], v2 offset:19264
    ds_read_b128 v[44:47], v0 offset:18944
    s_setprio 0
    v_mfma_f32_32x32x16_bf16 v[16:31], v[8:11], v[12:15], v[16:31]
    s_setprio 3
    ds_read_b64_tr_b16 v[8:9], v2 offset:19456
    ds_read_b64_tr_b16 v[10:11], v2 offset:19520
    ds_read_b128 v[12:15], v1 offset:18944
    s_waitcnt lgkmcnt(6)
    s_setprio 0
    v_mfma_f32_32x32x16_bf16 v[16:31], v[32:35], v[36:39], v[16:31]
    s_setprio 3
    ds_read_b64_tr_b16 v[32:33], v2 offset:19712
    ds_read_b64_tr_b16 v[34:35], v2 offset:19776
    ds_read_b128 v[36:39], v7 offset:18944
    s_add_u32 m0, s39, 0
    s_add_u32 s64, s44, s43
    buffer_load_dwordx4 v4, s[56:59], s64 offen sc1 lds
    s_add_u32 m0, s39, 1088
    s_add_u32 s64, s44, s43
    s_add_u32 s64, s64, 20480
    buffer_load_dwordx4 v4, s[56:59], s64 offen sc1 lds
    s_add_u32 s43, s43, 1024
    s_cmp_eq_u32 s43, 10240
    s_cselect_b32 s43, 0, s43
    s_waitcnt lgkmcnt(6)
    s_setprio 0
    v_mfma_f32_32x32x16_bf16 v[16:31], v[40:43], v[44:47], v[16:31]
    s_setprio 3
    s_waitcnt lgkmcnt(3)
    s_setprio 0
    v_mfma_f32_32x32x16_bf16 v[16:31], v[8:11], v[12:15], v[16:31]
    s_setprio 3
    s_waitcnt lgkmcnt(0)
    s_waitcnt vmcnt(4)
    s_barrier
    ds_read_b64_tr_b16 v[40:41], v2 offset:37888
    ds_read_b64_tr_b16 v[42:43], v2 offset:37952
    ds_read_b128 v[44:47], v3 offset:37888
    ds_read_b64_tr_b16 v[8:9], v2 offset:38144
    ds_read_b64_tr_b16 v[10:11], v2 offset:38208
    ds_read_b128 v[12:15], v0 offset:37888
    s_setprio 0
    v_mfma_f32_32x32x16_bf16 v[16:31], v[32:35], v[36:39], v[16:31]
    s_setprio 3
    ds_read_b64_tr_b16 v[32:33], v2 offset:38400
    ds_read_b64_tr_b16 v[34:35], v2 offset:38464
    ds_read_b128 v[36:39], v1 offset:37888
    s_waitcnt lgkmcnt(6)
    s_setprio 0
    v_mfma_f32_32x32x16_bf16 v[16:31], v[40:43], v[44:47], v[16:31]
    s_setprio 3
    ds_read_b64_tr_b16 v[40:41], v2 offset:38656
    ds_read_b64_tr_b16 v[42:43], v2 offset:38720
    ds_read_b128 v[44:47], v7 offset:37888
    s_add_u32 m0, s39, 18944
    s_add_u32 s64, s44, s43
    s_add_u32 s64, s64, 10240
    buffer_load_dwordx4 v4, s[56:59], s64 offen sc1 lds
    s_add_u32 m0, s39, 20032
    s_add_u32 s64, s44, s43
    s_add_u32 s64, s64, 30720
    buffer_load_dwordx4 v4, s[56:59], s64 offen sc1 lds
    s_add_u32 s43, s43, 1024
    s_cmp_eq_u32 s43, 10240
    s_cselect_b32 s43, 0, s43
    s_waitcnt lgkmcnt(6)
    s_setprio 0
    v_mfma_f32_32x32x16_bf16 v[16:31], v[8:11], v[12:15], v[16:31]
    s_setprio 3
    s_waitcnt lgkmcnt(3)
    s_setprio 0
    v_mfma_f32_32x32x16_bf16 v[16:31], v[32:35], v[36:39], v[16:31]
    s_setprio 3
    s_waitcnt lgkmcnt(0)
    s_waitcnt vmcnt(4)
    s_barrier
    ds_read_b64_tr_b16 v[8:9], v2 offset:56832
    ds_read_b64_tr_b16 v[10:11], v2 offset:56896
    ds_read_b128 v[12:15], v3 offset:56832
    ds_read_b64_tr_b16 v[32:33], v2 offset:57088
    ds_read_b64_tr_b16 v[34:35], v2 offset:57152
    ds_read_b128 v[36:39], v0 offset:56832
    s_setprio 0
    v_mfma_f32_32x32x16_bf16 v[16:31], v[40:43], v[44:47], v[16:31]
    s_setprio 3
    ds_read_b64_tr_b16 v[40:41], v2 offset:57344
    ds_read_b64_tr_b16 v[42:43], v2 offset:57408
    ds_read_b128 v[44:47], v1 offset:56832
    s_waitcnt lgkmcnt(6)
    s_setprio 0
    v_mfma_f32_32x32x16_bf16 v[16:31], v[8:11], v[12:15], v[16:31]
    s_setprio 3
    ds_read_b64_tr_b16 v[8:9], v2 offset:57600
    ds_read_b64_tr_b16 v[10:11], v2 offset:57664
    ds_read_b128 v[12:15], v7 offset:56832
    s_add_u32 m0, s39, 37888
    s_add_u32 s64, s44, s43
    s_add_u32 s64, s64, 10240
    buffer_load_dwordx4 v4, s[56:59], s64 offen sc1 lds
    s_add_u32 m0, s39, 38976
    s_add_u32 s64, s44, s43
    s_add_u32 s64, s64, 30720
    buffer_load_dwordx4 v4, s[56:59], s64 offen sc1 lds
    s_add_u32 s43, s43, 1024
    s_cmp_eq_u32 s43, 10240
    s_cselect_b32 s43, 0, s43
    s_waitcnt lgkmcnt(6)
    s_setprio 0
    v_mfma_f32_32x32x16_bf16 v[16:31], v[32:35], v[36:39], v[16:31]
    s_setprio 3
    s_waitcnt lgkmcnt(3)
    s_setprio 0
    v_mfma_f32_32x32x16_bf16 v[16:31], v[40:43], v[44:47], v[16:31]
    s_setprio 3
    s_waitcnt lgkmcnt(0)
    s_waitcnt vmcnt(4)
    s_barrier
    ds_read_b64_tr_b16 v[32:33], v2 offset:0
    ds_read_b64_tr_b16 v[34:35], v2 offset:64
    ds_read_b128 v[36:39], v3 offset:0
    ds_read_b64_tr_b16 v[40:41], v2 offset:256
    ds_read_b64_tr_b16 v[42:43], v2 offset:320
    ds_read_b128 v[44:47], v0 offset:0
    s_setprio 0
    v_mfma_f32_32x32x16_bf16 v[16:31], v[8:11], v[12:15], v[16:31]
    s_setprio 3
    ds_read_b64_tr_b16 v[8:9], v2 offset:512
    ds_read_b64_tr_b16 v[10:11], v2 offset:576
    ds_read_b128 v[12:15], v1 offset:0
    s_waitcnt lgkmcnt(6)
    s_setprio 0
    v_mfma_f32_32x32x16_bf16 v[16:31], v[32:35], v[36:39], v[16:31]
    s_setprio 3
    ds_read_b64_tr_b16 v[32:33], v2 offset:768
    ds_read_b64_tr_b16 v[34:35], v2 offset:832
    ds_read_b128 v[36:39], v7 offset:0
    s_add_u32 m0, s39, 56832
    s_add_u32 s64, s44, s43
    s_add_u32 s64, s64, 10240
    buffer_load_dwordx4 v4, s[56:59], s64 offen sc1 lds
    s_add_u32 m0, s39, 57920
    s_add_u32 s64, s44, s43
    s_add_u32 s64, s64, 30720
    buffer_load_dwordx4 v4, s[56:59], s64 offen sc1 lds
    s_add_u32 s43, s43, 1024
    s_cmp_eq_u32 s43, 10240
    s_cselect_b32 s43, 0, s43
    s_waitcnt lgkmcnt(6)
    s_setprio 0
    v_mfma_f32_32x32x16_bf16 v[16:31], v[40:43], v[44:47], v[16:31]
    s_setprio 3
    s_waitcnt lgkmcnt(3)
    s_setprio 0
    v_mfma_f32_32x32x16_bf16 v[16:31], v[8:11], v[12:15], v[16:31]
    s_setprio 3
    s_waitcnt lgkmcnt(0)
    s_waitcnt vmcnt(4)
    s_barrier
    ds_read_b64_tr_b16 v[40:41], v2 offset:18944
    ds_read_b64_tr_b16 v[42:43], v2 offset:19008
    ds_read_b128 v[44:47], v3 offset:18944
    ds_read_b64_tr_b16 v[8:9], v2 offset:19200
    ds_read_b64_tr_b16 v[10:11], v2 offset:19264
    ds_read_b128 v[12:15], v0 offset:18944
    s_setprio 0
    v_mfma_f32_32x32x16_bf16 v[16:31], v[32:35], v[36:39], v[16:31]
    s_setprio 3
    ds_read_b64_tr_b16 v[32:33], v2 offset:19456
    ds_read_b64_tr_b16 v[34:35], v2 offset:19520
    ds_read_b128 v[36:39], v1 offset:18944
    s_waitcnt lgkmcnt(6)
    s_setprio 0
    v_mfma_f32_32x32x16_bf16 v[16:31], v[40:43], v[44:47], v[16:31]
    s_setprio 3
    ds_read_b64_tr_b16 v[40:41], v2 offset:19712
    ds_read_b64_tr_b16 v[42:43], v2 offset:19776
    ds_read_b128 v[44:47], v7 offset:18944
    s_add_u32 m0, s39, 0
    s_add_u32 s64, s44, s43
    s_add_u32 s64, s64, 10240
    buffer_load_dwordx4 v4, s[56:59], s64 offen sc1 lds
    s_add_u32 m0, s39, 1088
    s_add_u32 s64, s44, s43
    s_add_u32 s64, s64, 30720
    buffer_load_dwordx4 v4, s[56:59], s64 offen sc1 lds
    s_add_u32 s43, s43, 1024
    s_cmp_eq_u32 s43, 10240
    s_cselect_b32 s43, 0, s43
    s_waitcnt lgkmcnt(6)
    s_setprio 0
    v_mfma_f32_32x32x16_bf16 v[16:31], v[8:11], v[12:15], v[16:31]
    s_setprio 3
    s_waitcnt lgkmcnt(3)
    s_setprio 0
    v_mfma_f32_32x32x16_bf16 v[16:31], v[32:35], v[36:39], v[16:31]
    s_setprio 3
    s_waitcnt lgkmcnt(0)
    s_waitcnt vmcnt(4)
    s_barrier
    ds_read_b64_tr_b16 v[8:9], v2 offset:37888
    ds_read_b64_tr_b16 v[10:11], v2 offset:37952
    ds_read_b128 v[12:15], v3 offset:37888
    ds_read_b64_tr_b16 v[32:33], v2 offset:38144
    ds_read_b64_tr_b16 v[34:35], v2 offset:38208
    ds_read_b128 v[36:39], v0 offset:37888
    s_setprio 0
    v_mfma_f32_32x32x16_bf16 v[16:31], v[40:43], v[44:47], v[16:31]
    s_setprio 3
    ds_read_b64_tr_b16 v[40:41], v2 offset:38400
    ds_read_b64_tr_b16 v[42:43], v2 offset:38464
    ds_read_b128 v[44:47], v1 offset:37888
    s_waitcnt lgkmcnt(6)
    s_setprio 0
    v_mfma_f32_32x32x16_bf16 v[16:31], v[8:11], v[12:15], v[16:31]
    s_setprio 3
    ds_read_b64_tr_b16 v[8:9], v2 offset:38656
    ds_read_b64_tr_b16 v[10:11], v2 offset:38720
    ds_read_b128 v[12:15], v7 offset:37888
    s_add_u32 m0, s39, 18944
    s_add_u32 s64, s44, s43
    s_add_u32 s64, s64, 10240
    buffer_load_dwordx4 v4, s[56:59], s64 offen sc1 lds
    s_add_u32 m0, s39, 20032
    s_add_u32 s64, s44, s43
    s_add_u32 s64, s64, 30720
    buffer_load_dwordx4 v4, s[56:59], s64 offen sc1 lds
    s_add_u32 s43, s43, 1024
    s_cmp_eq_u32 s43, 10240
    s_cselect_b32 s43, 0, s43
    s_waitcnt lgkmcnt(6)
    s_setprio 0
    v_mfma_f32_32x32x16_bf16 v[16:31], v[32:35], v[36:39], v[16:31]
    s_setprio 3
    s_waitcnt lgkmcnt(3)
    s_setprio 0
    v_mfma_f32_32x32x16_bf16 v[16:31], v[40:43], v[44:47], v[16:31]
    s_setprio 3
    s_waitcnt lgkmcnt(0)
    s_waitcnt vmcnt(4)
    s_barrier
    ds_read_b64_tr_b16 v[32:33], v2 offset:56832
    ds_read_b64_tr_b16 v[34:35], v2 offset:56896
    ds_read_b128 v[36:39], v3 offset:56832
    ds_read_b64_tr_b16 v[40:41], v2 offset:57088
    ds_read_b64_tr_b16 v[42:43], v2 offset:57152
    ds_read_b128 v[44:47], v0 offset:56832
    s_setprio 0
    v_mfma_f32_32x32x16_bf16 v[16:31], v[8:11], v[12:15], v[16:31]
    s_setprio 3
    ds_read_b64_tr_b16 v[8:9], v2 offset:57344
    ds_read_b64_tr_b16 v[10:11], v2 offset:57408
    ds_read_b128 v[12:15], v1 offset:56832
    s_waitcnt lgkmcnt(6)
    s_setprio 0
    v_mfma_f32_32x32x16_bf16 v[16:31], v[32:35], v[36:39], v[16:31]
    s_setprio 3
    ds_read_b64_tr_b16 v[32:33], v2 offset:57600
    ds_read_b64_tr_b16 v[34:35], v2 offset:57664
    ds_read_b128 v[36:39], v7 offset:56832
    s_add_u32 m0, s39, 37888
    s_add_u32 s64, s44, s43
    s_add_u32 s64, s64, 10240
    buffer_load_dwordx4 v4, s[56:59], s64 offen sc1 lds
    s_add_u32 m0, s39, 38976
    s_add_u32 s64, s44, s43
    s_add_u32 s64, s64, 30720
    buffer_load_dwordx4 v4, s[56:59], s64 offen sc1 lds
    s_add_u32 s43, s43, 1024
    s_cmp_eq_u32 s43, 10240
    s_cselect_b32 s43, 0, s43
    s_waitcnt lgkmcnt(6)
    s_setprio 0
    v_mfma_f32_32x32x16_bf16 v[16:31], v[40:43], v[44:47], v[16:31]
    s_setprio 3
    s_waitcnt lgkmcnt(3)
    s_setprio 0
    v_mfma_f32_32x32x16_bf16 v[16:31], v[8:11], v[12:15], v[16:31]
    s_setprio 3
    s_waitcnt lgkmcnt(0)
    s_waitcnt vmcnt(4)
    s_barrier
    ds_read_b64_tr_b16 v[40:41], v2 offset:0
    ds_read_b64_tr_b16 v[42:43], v2 offset:64
    ds_read_b128 v[44:47], v3 offset:0
    ds_read_b64_tr_b16 v[8:9], v2 offset:256
    ds_read_b64_tr_b16 v[10:11], v2 offset:320
    ds_read_b128 v[12:15], v0 offset:0
    s_setprio 0
    v_mfma_f32_32x32x16_bf16 v[16:31], v[32:35], v[36:39], v[16:31]
    s_setprio 3
    ds_read_b64_tr_b16 v[32:33], v2 offset:512
    ds_read_b64_tr_b16 v[34:35], v2 offset:576
    ds_read_b128 v[36:39], v1 offset:0
    s_waitcnt lgkmcnt(6)
    s_setprio 0
    v_mfma_f32_32x32x16_bf16 v[16:31], v[40:43], v[44:47], v[16:31]
    s_setprio 3
    ds_read_b64_tr_b16 v[40:41], v2 offset:768
    ds_read_b64_tr_b16 v[42:43], v2 offset:832
    ds_read_b128 v[44:47], v7 offset:0
    s_add_u32 m0, s39, 56832
    s_add_u32 s64, s44, s43
    s_add_u32 s64, s64, 10240
    buffer_load_dwordx4 v4, s[56:59], s64 offen sc1 lds
    s_add_u32 m0, s39, 57920
    s_add_u32 s64, s44, s43
    s_add_u32 s64, s64, 30720
    buffer_load_dwordx4 v4, s[56:59], s64 offen sc1 lds
    s_add_u32 s43, s43, 1024
    s_cmp_eq_u32 s43, 10240
    s_cselect_b32 s43, 0, s43
    s_waitcnt lgkmcnt(6)
    s_setprio 0
    v_mfma_f32_32x32x16_bf16 v[16:31], v[8:11], v[12:15], v[16:31]
    s_setprio 3
    s_waitcnt lgkmcnt(3)
    s_setprio 0
    v_mfma_f32_32x32x16_bf16 v[16:31], v[32:35], v[36:39], v[16:31]
    s_setprio 3
    s_waitcnt lgkmcnt(0)
    s_waitcnt vmcnt(4)
    s_barrier
    ds_read_b64_tr_b16 v[8:9], v2 offset:18944
    ds_read_b64_tr_b16 v[10:11], v2 offset:19008
    ds_read_b128 v[12:15], v3 offset:18944
    ds_read_b64_tr_b16 v[32:33], v2 offset:19200
    ds_read_b64_tr_b16 v[34:35], v2 offset:19264
    ds_read_b128 v[36:39], v0 offset:18944
    s_setprio 0
    v_mfma_f32_32x32x16_bf16 v[16:31], v[40:43], v[44:47], v[16:31]
    s_setprio 3
    ds_read_b64_tr_b16 v[40:41], v2 offset:19456
    ds_read_b64_tr_b16 v[42:43], v2 offset:19520
    ds_read_b128 v[44:47], v1 offset:18944
    s_waitcnt lgkmcnt(6)
    s_setprio 0
    v_mfma_f32_32x32x16_bf16 v[16:31], v[8:11], v[12:15], v[16:31]
    s_setprio 3
    ds_read_b64_tr_b16 v[8:9], v2 offset:19712
    ds_read_b64_tr_b16 v[10:11], v2 offset:19776
    ds_read_b128 v[12:15], v7 offset:18944
    s_add_u32 m0, s39, 0
    s_add_u32 s64, s44, s43
    s_add_u32 s64, s64, 10240
    buffer_load_dwordx4 v4, s[56:59], s64 offen sc1 lds
    s_add_u32 m0, s39, 1088
    s_add_u32 s64, s44, s43
    s_add_u32 s64, s64, 30720
    buffer_load_dwordx4 v4, s[56:59], s64 offen sc1 lds
    s_add_u32 s43, s43, 1024
    s_cmp_eq_u32 s43, 10240
    s_cselect_b32 s43, 0, s43
    s_waitcnt lgkmcnt(6)
    s_setprio 0
    v_mfma_f32_32x32x16_bf16 v[16:31], v[32:35], v[36:39], v[16:31]
    s_setprio 3
    s_waitcnt lgkmcnt(3)
    s_setprio 0
    v_mfma_f32_32x32x16_bf16 v[16:31], v[40:43], v[44:47], v[16:31]
    s_setprio 3
    s_waitcnt lgkmcnt(0)
    s_waitcnt vmcnt(4)
    s_barrier
    ds_read_b64_tr_b16 v[32:33], v2 offset:37888
    ds_read_b64_tr_b16 v[34:35], v2 offset:37952
    ds_read_b128 v[36:39], v3 offset:37888
    ds_read_b64_tr_b16 v[40:41], v2 offset:38144
    ds_read_b64_tr_b16 v[42:43], v2 offset:38208
    ds_read_b128 v[44:47], v0 offset:37888
    s_setprio 0
    v_mfma_f32_32x32x16_bf16 v[16:31], v[8:11], v[12:15], v[16:31]
    s_setprio 3
    ds_read_b64_tr_b16 v[8:9], v2 offset:38400
    ds_read_b64_tr_b16 v[10:11], v2 offset:38464
    ds_read_b128 v[12:15], v1 offset:37888
    s_waitcnt lgkmcnt(6)
    s_setprio 0
    v_mfma_f32_32x32x16_bf16 v[16:31], v[32:35], v[36:39], v[16:31]
    s_setprio 3
    ds_read_b64_tr_b16 v[32:33], v2 offset:38656
    ds_read_b64_tr_b16 v[34:35], v2 offset:38720
    ds_read_b128 v[36:39], v7 offset:37888
    s_add_u32 m0, s39, 18944
    s_add_u32 s64, s44, s43
    s_add_u32 s64, s64, 10240
    buffer_load_dwordx4 v4, s[56:59], s64 offen sc1 lds
    s_add_u32 m0, s39, 20032
    s_add_u32 s64, s44, s43
    s_add_u32 s64, s64, 30720
    buffer_load_dwordx4 v4, s[56:59], s64 offen sc1 lds
    s_add_u32 s43, s43, 1024
    s_cmp_eq_u32 s43, 10240
    s_cselect_b32 s43, 0, s43
    s_waitcnt lgkmcnt(6)
    s_setprio 0
    v_mfma_f32_32x32x16_bf16 v[16:31], v[40:43], v[44:47], v[16:31]
    s_setprio 3
    s_waitcnt lgkmcnt(3)
    s_setprio 0
    v_mfma_f32_32x32x16_bf16 v[16:31], v[8:11], v[12:15], v[16:31]
    s_setprio 3
    s_waitcnt lgkmcnt(0)
    s_waitcnt vmcnt(4)
    s_barrier
    ds_read_b64_tr_b16 v[40:41], v2 offset:56832
    ds_read_b64_tr_b16 v[42:43], v2 offset:56896
    ds_read_b128 v[44:47], v3 offset:56832
    ds_read_b64_tr_b16 v[8:9], v2 offset:57088
    ds_read_b64_tr_b16 v[10:11], v2 offset:57152
    ds_read_b128 v[12:15], v0 offset:56832
    s_setprio 0
    v_mfma_f32_32x32x16_bf16 v[16:31], v[32:35], v[36:39], v[16:31]
    s_setprio 3
    ds_read_b64_tr_b16 v[32:33], v2 offset:57344
    ds_read_b64_tr_b16 v[34:35], v2 offset:57408
    ds_read_b128 v[36:39], v1 offset:56832
    s_waitcnt lgkmcnt(6)
    s_setprio 0
    v_mfma_f32_32x32x16_bf16 v[16:31], v[40:43], v[44:47], v[16:31]
    s_setprio 3
    ds_read_b64_tr_b16 v[40:41], v2 offset:57600
    ds_read_b64_tr_b16 v[42:43], v2 offset:57664
    ds_read_b128 v[44:47], v7 offset:56832
    s_add_u32 m0, s39, 37888
    s_add_u32 s64, s44, s43
    s_add_u32 s64, s64, 10240
    buffer_load_dwordx4 v4, s[56:59], s64 offen sc1 lds
    s_add_u32 m0, s39, 38976
    s_add_u32 s64, s44, s43
    s_add_u32 s64, s64, 30720
    buffer_load_dwordx4 v4, s[56:59], s64 offen sc1 lds
    s_add_u32 s43, s43, 1024
    s_cmp_eq_u32 s43, 10240
    s_cselect_b32 s43, 0, s43
    s_waitcnt lgkmcnt(6)
    s_setprio 0
    v_mfma_f32_32x32x16_bf16 v[16:31], v[8:11], v[12:15], v[16:31]
    s_setprio 3
    s_waitcnt lgkmcnt(3)
    s_setprio 0
    v_mfma_f32_32x32x16_bf16 v[16:31], v[32:35], v[36:39], v[16:31]
    s_setprio 3
    s_waitcnt lgkmcnt(0)
    s_waitcnt vmcnt(4)
    s_barrier
    ds_read_b64_tr_b16 v[8:9], v2 offset:0
    ds_read_b64_tr_b16 v[10:11], v2 offset:64
    ds_read_b128 v[12:15], v3 offset:0
    ds_read_b64_tr_b16 v[32:33], v2 offset:256
    ds_read_b64_tr_b16 v[34:35], v2 offset:320
    ds_read_b128 v[36:39], v0 offset:0
    s_setprio 0
    v_mfma_f32_32x32x16_bf16 v[16:31], v[40:43], v[44:47], v[16:31]
    s_setprio 3
    ds_read_b64_tr_b16 v[40:41], v2 offset:512
    ds_read_b64_tr_b16 v[42:43], v2 offset:576
    ds_read_b128 v[44:47], v1 offset:0
    s_waitcnt lgkmcnt(6)
    s_setprio 0
    v_mfma_f32_32x32x16_bf16 v[16:31], v[8:11], v[12:15], v[16:31]
    s_setprio 3
    ds_read_b64_tr_b16 v[8:9], v2 offset:768
    ds_read_b64_tr_b16 v[10:11], v2 offset:832
    ds_read_b128 v[12:15], v7 offset:0
    s_waitcnt lgkmcnt(6)
    s_setprio 0
    v_mfma_f32_32x32x16_bf16 v[16:31], v[32:35], v[36:39], v[16:31]
    s_setprio 3
    s_waitcnt lgkmcnt(3)
    s_setprio 0
    v_mfma_f32_32x32x16_bf16 v[16:31], v[40:43], v[44:47], v[16:31]
    s_setprio 3
    s_waitcnt lgkmcnt(0)
    s_waitcnt vmcnt(2)
    s_barrier
    ds_read_b64_tr_b16 v[32:33], v2 offset:18944
    ds_read_b64_tr_b16 v[34:35], v2 offset:19008
    ds_read_b128 v[36:39], v3 offset:18944
    ds_read_b64_tr_b16 v[40:41], v2 offset:19200
    ds_read_b64_tr_b16 v[42:43], v2 offset:19264
    ds_read_b128 v[44:47], v0 offset:18944
    s_setprio 0
    v_mfma_f32_32x32x16_bf16 v[16:31], v[8:11], v[12:15], v[16:31]
    s_setprio 3
    ds_read_b64_tr_b16 v[8:9], v2 offset:19456
    ds_read_b64_tr_b16 v[10:11], v2 offset:19520
    ds_read_b128 v[12:15], v1 offset:18944
    s_waitcnt lgkmcnt(6)
    s_setprio 0
    v_mfma_f32_32x32x16_bf16 v[16:31], v[32:35], v[36:39], v[16:31]
    s_setprio 3
    ds_read_b64_tr_b16 v[32:33], v2 offset:19712
    ds_read_b64_tr_b16 v[34:35], v2 offset:19776
    ds_read_b128 v[36:39], v7 offset:18944
    s_waitcnt lgkmcnt(6)
    s_setprio 0
    v_mfma_f32_32x32x16_bf16 v[16:31], v[40:43], v[44:47], v[16:31]
    s_setprio 3
    s_waitcnt lgkmcnt(3)
    s_setprio 0
    v_mfma_f32_32x32x16_bf16 v[16:31], v[8:11], v[12:15], v[16:31]
    s_setprio 3
    s_waitcnt lgkmcnt(0)
    s_waitcnt vmcnt(0)
    s_barrier
    ds_read_b64_tr_b16 v[40:41], v2 offset:37888
    ds_read_b64_tr_b16 v[42:43], v2 offset:37952
    ds_read_b128 v[44:47], v3 offset:37888
    ds_read_b64_tr_b16 v[8:9], v2 offset:38144
    ds_read_b64_tr_b16 v[10:11], v2 offset:38208
    ds_read_b128 v[12:15], v0 offset:37888
    s_setprio 0
    v_mfma_f32_32x32x16_bf16 v[16:31], v[32:35], v[36:39], v[16:31]
    s_setprio 3
    ds_read_b64_tr_b16 v[32:33], v2 offset:38400
    ds_read_b64_tr_b16 v[34:35], v2 offset:38464
    ds_read_b128 v[36:39], v1 offset:37888
    s_waitcnt lgkmcnt(6)
    s_setprio 0
    v_mfma_f32_32x32x16_bf16 v[16:31], v[40:43], v[44:47], v[16:31]
    s_setprio 3
    ds_read_b64_tr_b16 v[40:41], v2 offset:38656
    ds_read_b64_tr_b16 v[42:43], v2 offset:38720
    ds_read_b128 v[44:47], v7 offset:37888
    s_waitcnt lgkmcnt(6)
    s_setprio 0
    v_mfma_f32_32x32x16_bf16 v[16:31], v[8:11], v[12:15], v[16:31]
    s_setprio 3
    s_waitcnt lgkmcnt(3)
    s_setprio 0
    v_mfma_f32_32x32x16_bf16 v[16:31], v[32:35], v[36:39], v[16:31]
    s_setprio 3
    s_waitcnt lgkmcnt(0)
    s_setprio 0
    v_mfma_f32_32x32x16_bf16 v[16:31], v[40:43], v[44:47], v[16:31]
    s_setprio 3
    s_setprio 3
    s_mov_b32 s52, s32
    s_mov_b32 s53, s33
    s_mov_b32 s54, 10485760
    s_mov_b32 s55, 0x20000
    s_mul_i32 s44, s40, 32768
    s_lshl_b32 s64, s41, 9
    s_add_u32 s44, s44, s64
    s_add_u32 s44, s44, 10485760
    s_lshl_b32 s46, s40, 10
    s_lshl_b32 s45, s41, 3
    s_add_u32 s45, s45, s42
    s_lshl_b32 s45, s45, 8
    s_lshl_b32 s64, s40, 6
    s_add_u32 s45, s45, s64
    s_add_u32 s45, s45, 720896
    v_lshrrev_b32 v0, 9, v4
    v_mul_u32_u24 v0, 16384, v0
    v_and_b32 v7, 0x1f0, v4
    s_and_b32 s64, s40, 1
    s_lshl_b32 s64, s64, 7
    v_xor_b32 v7, s64, v7
    v_add_u32 v7, v0, v7
    s_mov_b32 s64, 0
    buffer_store_dword v16, v5, s[52:55], s64 offen offset:2560 sc1
    s_mov_b32 s64, 5120
    buffer_store_dword v17, v5, s[52:55], s64 offen offset:2560 sc1
    s_mov_b32 s64, 10240
    buffer_store_dword v18, v5, s[52:55], s64 offen offset:2560 sc1
    s_mov_b32 s64, 15360
    buffer_store_dword v19, v5, s[52:55], s64 offen offset:2560 sc1
    s_mov_b32 s64, 40960
    buffer_store_dword v20, v5, s[52:55], s64 offen offset:2560 sc1
    s_mov_b32 s64, 46080
    buffer_store_dword v21, v5, s[52:55], s64 offen offset:2560 sc1
    s_mov_b32 s64, 51200
    buffer_store_dword v22, v5, s[52:55], s64 offen offset:2560 sc1
    s_mov_b32 s64, 56320
    buffer_store_dword v23, v5, s[52:55], s64 offen offset:2560 sc1
    s_mov_b32 s64, 81920
    buffer_store_dword v24, v5, s[52:55], s64 offen offset:2560 sc1
    s_mov_b32 s64, 87040
    buffer_store_dword v25, v5, s[52:55], s64 offen offset:2560 sc1
    s_mov_b32 s64, 92160
    buffer_store_dword v26, v5, s[52:55], s64 offen offset:2560 sc1
    s_mov_b32 s64, 97280
    buffer_store_dword v27, v5, s[52:55], s64 offen offset:2560 sc1
    s_mov_b32 s64, 122880
    buffer_store_dword v28, v5, s[52:55], s64 offen offset:2560 sc1
    s_mov_b32 s64, 128000
    buffer_store_dword v29, v5, s[52:55], s64 offen offset:2560 sc1
    s_mov_b32 s64, 133120
    buffer_store_dword v30, v5, s[52:55], s64 offen offset:2560 sc1
    s_mov_b32 s64, 138240
    buffer_store_dword v31, v5, s[52:55], s64 offen offset:2560 sc1
    s_mov_b32 s64, 400000
SP_41:
    s_load_dwordx16 s[8:23], s[56:57], s45 offset:0 glc
    s_mov_b32 s65, 0
    s_waitcnt lgkmcnt(0)
    s_cmp_eq_u64 s[8:9], s[6:7]
    s_addc_u32 s65, s65, s65
    s_cmp_eq_u64 s[10:11], s[6:7]
    s_addc_u32 s65, s65, s65
    s_cmp_eq_u64 s[12:13], s[6:7]
    s_addc_u32 s65, s65, s65
    s_cmp_eq_u64 s[14:15], s[6:7]
    s_addc_u32 s65, s65, s65
    s_cmp_eq_u64 s[16:17], s[6:7]
    s_addc_u32 s65, s65, s65
    s_cmp_eq_u64 s[18:19], s[6:7]
    s_addc_u32 s65, s65, s65
    s_cmp_eq_u64 s[20:21], s[6:7]
    s_addc_u32 s65, s65, s65
    s_cmp_eq_u64 s[22:23], s[6:7]
    s_addc_u32 s65, s65, s65
    s_cmp_eq_u32 s65, 255
    s_cbranch_scc1 SD_42
    s_sleep 2
    s_sub_u32 s64, s64, 1
    s_cmp_lg_u32 s64, 0
    s_cbranch_scc1 SP_41
SD_42:
    s_barrier
    s_add_u32 m0, s46, 0
    s_add_u32 s64, s44, 0
    buffer_load_dwordx4 v7, s[56:59], s64 offen sc1 lds
    s_add_u32 m0, s46, 40960
    s_add_u32 s64, s44, 1310720
    buffer_load_dwordx4 v7, s[56:59], s64 offen sc1 lds
    s_barrier
    s_add_u32 m0, s46, 8192
    s_add_u32 s64, s44, 262144
    buffer_load_dwordx4 v7, s[56:59], s64 offen sc1 lds
    s_add_u32 m0, s46, 49152
    s_add_u32 s64, s44, 1572864
    buffer_load_dwordx4 v7, s[56:59], s64 offen sc1 lds
    s_add_u32 m0, s46, 16384
    s_add_u32 s64, s44, 524288
    buffer_load_dwordx4 v7, s[56:59], s64 offen sc1 lds
    s_add_u32 m0, s46, 57344
    s_add_u32 s64, s44, 1835008
    buffer_load_dwordx4 v7, s[56:59], s64 offen sc1 lds
    s_add_u32 m0, s46, 24576
    s_add_u32 s64, s44, 786432
    buffer_load_dwordx4 v7, s[56:59], s64 offen sc1 lds
    s_add_u32 m0, s46, 65536
    s_add_u32 s64, s44, 2097152
    buffer_load_dwordx4 v7, s[56:59], s64 offen sc1 lds
    s_add_u32 m0, s46, 32768
    s_add_u32 s64, s44, 1048576
    buffer_load_dwordx4 v7, s[56:59], s64 offen sc1 lds
    s_add_u32 m0, s46, 73728
    s_add_u32 s64, s44, 2359296
    buffer_load_dwordx4 v7, s[56:59], s64 offen sc1 lds
    v_mbcnt_lo_u32_b32 v0, -1, 0
    v_mbcnt_hi_u32_b32 v0, -1, v0
    s_lshr_b32 s64, s40, 1
    s_mul_i32 s65, s64, 51712
    s_and_b32 s66, s40, 1
    s_lshl_b32 s66, s66, 7
    s_add_u32 s65, s65, s66
    v_and_b32 v2, 31, v0
    v_mul_u32_u24 v2, 336, v2
    v_lshrrev_b32 v3, 5, v0
    v_lshl_add_u32 v2, v3, 4, v2
    v_add_u32 v2, s65, v2
    s_mul_i32 s67, s64, 4294945792
    s_add_u32 s67, s67, 10752
    v_add_u32 v7, s67, v2
    v_xor_b32 v1, 256, v6
    s_lshl_b32 s64, s40, 6
    v_add_u32 v0, s64, v0
    v_mul_u32_u24 v3, 3277, v0
    v_lshrrev_b32 v3, 16, v3
    v_mul_u32_u24 v5, 20, v3
    v_sub_u32 v0, v0, v5
    v_lshlrev_b32 v0, 4, v0
    s_mul_i32 s64, s41, 327680
    s_mul_i32 s65, s42, 320
    s_add_u32 s47, s64, s65
    v_mul_u32_u24 v5, 5120, v3
    v_add_u32 v5, v5, v0
    v_mul_u32_u24 v3, 336, v3
    v_add_u32 v3, v3, v0
    s_cmp_lg_u32 s41, 31
    s_cbranch_scc1 NE_43
    s_or_b32 s64, s42, s40
    s_cmp_lg_u32 s64, 0
    s_cbranch_scc1 NE_43
    s_waitcnt vmcnt(0)
    v_mov_b32 v8, s6
    s_mov_b64 exec, 1
    buffer_store_dword v8, off, s[56:59], 0 offset:0 sc1
    s_mov_b64 exec, -1
    s_waitcnt vmcnt(0)
NE_43:
    s_waitcnt vmcnt(8)
    s_barrier
    ds_read_b64 v[8:9], v6 offset:0
    ds_read_b64 v[10:11], v6 offset:512
    ds_read_b64 v[12:13], v1 offset:0
    ds_read_b64 v[14:15], v1 offset:512
    s_waitcnt lgkmcnt(2)
    v_mfma_f32_32x32x16_bf16 v[16:31], v[48:51], v[8:11], 0
    ds_read_b64 v[8:9], v6 offset:2048
    ds_read_b64 v[10:11], v6 offset:2560
    s_waitcnt lgkmcnt(2)
    v_mfma_f32_32x32x16_bf16 v[32:47], v[48:51], v[12:15], 0
    ds_read_b64 v[12:13], v1 offset:2048
    ds_read_b64 v[14:15], v1 offset:2560
    ds_read_b64 v[48:49], v6 offset:4096
    ds_read_b64 v[50:51], v6 offset:4608
    s_waitcnt lgkmcnt(4)
    v_mfma_f32_32x32x16_bf16 v[16:31], v[52:55], v[8:11], v[16:31]
    ds_read_b64 v[8:9], v1 offset:4096
    ds_read_b64 v[10:11], v1 offset:4608
    s_waitcnt lgkmcnt(4)
    v_mfma_f32_32x32x16_bf16 v[32:47], v[52:55], v[12:15], v[32:47]
    ds_read_b64 v[12:13], v6 offset:6144
    ds_read_b64 v[14:15], v6 offset:6656
    ds_read_b64 v[52:53], v1 offset:6144
    ds_read_b64 v[54:55], v1 offset:6656
    s_waitcnt lgkmcnt(6)
    v_mfma_f32_32x32x16_bf16 v[16:31], v[56:59], v[48:51], v[16:31]
    s_waitcnt lgkmcnt(4)
    v_mfma_f32_32x32x16_bf16 v[32:47], v[56:59], v[8:11], v[32:47]
    s_waitcnt lgkmcnt(2)
    v_mfma_f32_32x32x16_bf16 v[16:31], v[60:63], v[12:15], v[16:31]
    s_waitcnt lgkmcnt(0)
    v_mfma_f32_32x32x16_bf16 v[32:47], v[60:63], v[52:55], v[32:47]
    s_waitcnt vmcnt(4)
    s_barrier
    ds_read_b64 v[48:49], v6 offset:8192
    ds_read_b64 v[50:51], v6 offset:8704
    ds_read_b64 v[8:9], v1 offset:8192
    ds_read_b64 v[10:11], v1 offset:8704
    ds_read_b64 v[56:57], v6 offset:10240
    ds_read_b64 v[58:59], v6 offset:10752
    ds_read_b64 v[12:13], v1 offset:10240
    ds_read_b64 v[14:15], v1 offset:10752
    ds_read_b64 v[52:53], v6 offset:12288
    ds_read_b64 v[54:55], v6 offset:12800
    ds_read_b64 v[60:61], v1 offset:12288
    ds_read_b64 v[62:63], v1 offset:12800
    s_waitcnt lgkmcnt(10)
    v_mfma_f32_32x32x16_bf16 v[16:31], v[64:67], v[48:51], v[16:31]
    ds_read_b64 v[48:49], v6 offset:14336
    ds_read_b64 v[50:51], v6 offset:14848
    s_waitcnt lgkmcnt(10)
    v_mfma_f32_32x32x16_bf16 v[32:47], v[64:67], v[8:11], v[32:47]
    ds_read_b64 v[8:9], v1 offset:14336
    ds_read_b64 v[10:11], v1 offset:14848
    s_waitcnt lgkmcnt(10)
    v_mfma_f32_32x32x16_bf16 v[16:31], v[68:71], v[56:59], v[16:31]
    ds_read_b64 v[64:65], v6 offset:16384
    ds_read_b64 v[66:67], v6 offset:16896
    s_waitcnt lgkmcnt(10)
    v_mfma_f32_32x32x16_bf16 v[32:47], v[68:71], v[12:15], v[32:47]
    ds_read_b64 v[56:57], v1 offset:16384
    ds_read_b64 v[58:59], v1 offset:16896
    s_waitcnt lgkmcnt(10)
    v_mfma_f32_32x32x16_bf16 v[16:31], v[72:75], v[52:55], v[16:31]
    ds_read_b64 v[12:13], v6 offset:18432
    ds_read_b64 v[14:15], v6 offset:18944
    s_waitcnt lgkmcnt(10)
    v_mfma_f32_32x32x16_bf16 v[32:47], v[72:75], v[60:63], v[32:47]
    ds_read_b64 v[68:69], v1 offset:18432
    ds_read_b64 v[70:71], v1 offset:18944
    s_waitcnt lgkmcnt(10)
    v_mfma_f32_32x32x16_bf16 v[16:31], v[76:79], v[48:51], v[16:31]
    ds_read_b64 v[52:53], v6 offset:20480
    ds_read_b64 v[54:55], v6 offset:20992
    s_waitcnt lgkmcnt(10)
    v_mfma_f32_32x32x16_bf16 v[32:47], v[76:79], v[8:11], v[32:47]
    ds_read_b64 v[60:61], v1 offset:20480
    ds_read_b64 v[62:63], v1 offset:20992
    s_waitcnt lgkmcnt(10)
    v_mfma_f32_32x32x16_bf16 v[16:31], v[80:83], v[64:67], v[16:31]
    ds_read_b64 v[72:73], v6 offset:22528
    ds_read_b64 v[74:75], v6 offset:23040
    s_waitcnt lgkmcnt(10)
    v_mfma_f32_32x32x16_bf16 v[32:47], v[80:83], v[56:59], v[32:47]
    ds_read_b64 v[48:49], v1 offset:22528
    ds_read_b64 v[50:51], v1 offset:23040
    s_waitcnt lgkmcnt(10)
    v_mfma_f32_32x32x16_bf16 v[16:31], v[84:87], v[12:15], v[16:31]
    s_waitcnt lgkmcnt(8)
    v_mfma_f32_32x32x16_bf16 v[32:47], v[84:87], v[68:71], v[32:47]
    s_waitcnt lgkmcnt(6)
    v_mfma_f32_32x32x16_bf16 v[16:31], v[88:91], v[52:55], v[16:31]
    s_waitcnt lgkmcnt(4)
    v_mfma_f32_32x32x16_bf16 v[32:47], v[88:91], v[60:63], v[32:47]
    s_waitcnt lgkmcnt(2)
    v_mfma_f32_32x32x16_bf16 v[16:31], v[92:95], v[72:75], v[16:31]
    s_waitcnt lgkmcnt(0)
    v_mfma_f32_32x32x16_bf16 v[32:47], v[92:95], v[48:51], v[32:47]
    s_waitcnt vmcnt(0)
    s_barrier
    ds_read_b64 v[8:9], v6 offset:24576
    ds_read_b64 v[10:11], v6 offset:25088
    ds_read_b64 v[76:77], v1 offset:24576
    ds_read_b64 v[78:79], v1 offset:25088
    ds_read_b64 v[64:65], v6 offset:26624
    ds_read_b64 v[66:67], v6 offset:27136
    ds_read_b64 v[56:57], v1 offset:26624
    ds_read_b64 v[58:59], v1 offset:27136
    ds_read_b64 v[80:81], v6 offset:28672
    ds_read_b64 v[82:83], v6 offset:29184
    ds_read_b64 v[12:13], v1 offset:28672
    ds_read_b64 v[14:15], v1 offset:29184
    s_waitcnt lgkmcnt(10)
    v_mfma_f32_32x32x16_bf16 v[16:31], v[96:99], v[8:11], v[16:31]
    ds_read_b64 v[68:69], v6 offset:30720
    ds_read_b64 v[70:71], v6 offset:31232
    s_waitcnt lgkmcnt(10)
    v_mfma_f32_32x32x16_bf16 v[32:47], v[96:99], v[76:79], v[32:47]
    ds_read_b64 v[84:85], v1 offset:30720
    ds_read_b64 v[86:87], v1 offset:31232
    s_waitcnt lgkmcnt(10)
    v_mfma_f32_32x32x16_bf16 v[16:31], v[100:103], v[64:67], v[16:31]
    ds_read_b64 v[52:53], v1 offset:32768
    ds_read_b64 v[54:55], v1 offset:33280
    s_waitcnt lgkmcnt(10)
    v_mfma_f32_32x32x16_bf16 v[32:47], v[100:103], v[56:59], v[32:47]
    ds_read_b64 v[60:61], v1 offset:34816
    ds_read_b64 v[62:63], v1 offset:35328
    s_waitcnt lgkmcnt(10)
    v_mfma_f32_32x32x16_bf16 v[16:31], v[104:107], v[80:83], v[16:31]
    ds_read_b64 v[88:89], v1 offset:36864
    ds_read_b64 v[90:91], v1 offset:37376
    s_waitcnt lgkmcnt(10)
    v_mfma_f32_32x32x16_bf16 v[32:47], v[104:107], v[12:15], v[32:47]
    ds_read_b64 v[72:73], v1 offset:38912
    ds_read_b64 v[74:75], v1 offset:39424
    s_waitcnt lgkmcnt(10)
    v_mfma_f32_32x32x16_bf16 v[16:31], v[108:111], v[68:71], v[16:31]
    ds_read_b64 v[48:49], v6 offset:32768
    ds_read_b64 v[50:51], v6 offset:33280
    s_waitcnt lgkmcnt(10)
    v_mfma_f32_32x32x16_bf16 v[32:47], v[108:111], v[84:87], v[32:47]
    ds_read_b64 v[92:93], v6 offset:34816
    ds_read_b64 v[94:95], v6 offset:35328
    s_waitcnt lgkmcnt(10)
    v_mfma_f32_32x32x16_bf16 v[32:47], v[112:115], v[52:55], v[32:47]
    ds_read_b64 v[8:9], v6 offset:36864
    ds_read_b64 v[10:11], v6 offset:37376
    s_waitcnt lgkmcnt(10)
    v_mfma_f32_32x32x16_bf16 v[32:47], v[116:119], v[60:63], v[32:47]
    ds_read_b64 v[76:77], v6 offset:38912
    ds_read_b64 v[78:79], v6 offset:39424
    s_waitcnt lgkmcnt(10)
    v_mfma_f32_32x32x16_bf16 v[32:47], v[120:123], v[88:91], v[32:47]
    s_waitcnt lgkmcnt(8)
    v_mfma_f32_32x32x16_bf16 v[32:47], v[124:127], v[72:75], v[32:47]
    s_waitcnt lgkmcnt(6)
    v_mfma_f32_32x32x16_bf16 v[16:31], v[112:115], v[48:51], v[16:31]
    s_nop 7
    s_waitcnt lgkmcnt(0)
    v_mfma_f32_32x32x16_bf16 v[16:31], v[116:119], v[92:95], v[16:31]
    ds_write_b128 v7, v[32:35] offset:0
    ds_write_b128 v7, v[36:39] offset:32
    v_mfma_f32_32x32x16_bf16 v[16:31], v[120:123], v[8:11], v[16:31]
    ds_write_b128 v7, v[40:43] offset:64
    ds_write_b128 v7, v[44:47] offset:96
    v_mfma_f32_32x32x16_bf16 v[16:31], v[124:127], v[76:79], v[16:31]
    s_nop 11
    ds_write_b128 v2, v[16:19] offset:0
    ds_write_b128 v2, v[20:23] offset:32
    ds_write_b128 v2, v[24:27] offset:64
    ds_write_b128 v2, v[28:31] offset:96
    s_waitcnt lgkmcnt(0)
    s_barrier
    ds_read_b128 v[48:51], v3 offset:0
    ds_read_b128 v[52:55], v3 offset:40960
    ds_read_b128 v[56:59], v3 offset:5376
    ds_read_b128 v[60:63], v3 offset:46336
    ds_read_b128 v[64:67], v3 offset:10752
    ds_read_b128 v[68:71], v3 offset:51712
    ds_read_b128 v[72:75], v3 offset:16128
    ds_read_b128 v[76:79], v3 offset:57088
    s_waitcnt lgkmcnt(6)
    v_pk_add_f32 v[48:49], v[48:49], v[52:53]
    v_pk_add_f32 v[50:51], v[50:51], v[54:55]
    buffer_store_dwordx4 v[48:51], v5, s[52:55], s47 offen sc1
    s_add_u32 s47, s47, 81920
    s_waitcnt lgkmcnt(4)
    v_pk_add_f32 v[56:57], v[56:57], v[60:61]
    v_pk_add_f32 v[58:59], v[58:59], v[62:63]
    buffer_store_dwordx4 v[56:59], v5, s[52:55], s47 offen sc1
    s_add_u32 s47, s47, 81920
    s_waitcnt lgkmcnt(2)
    v_pk_add_f32 v[64:65], v[64:65], v[68:69]
    v_pk_add_f32 v[66:67], v[66:67], v[70:71]
    buffer_store_dwordx4 v[64:67], v5, s[52:55], s47 offen sc1
    s_add_u32 s47, s47, 81920
    s_waitcnt lgkmcnt(0)
    v_pk_add_f32 v[72:73], v[72:73], v[76:77]
    v_pk_add_f32 v[74:75], v[74:75], v[78:79]
    buffer_store_dwordx4 v[72:75], v5, s[52:55], s47 offen sc1
    s_endpgm
L_B_SMALL:
    s_mov_b32 s60, s30
    s_mov_b32 s61, s31
    s_mov_b32 s62, 1280
    s_mov_b32 s63, 0x20000
    buffer_load_ushort v0, v126, s[60:63], 0 offen
    s_mov_b32 s64, 0
    buffer_load_ushort v32, v114, s[44:47], s64 offen
    s_mov_b32 s64, 1280
    buffer_load_ushort v33, v114, s[44:47], s64 offen
    s_mov_b32 s64, 2560
    buffer_load_ushort v34, v114, s[44:47], s64 offen
    s_mov_b32 s64, 3840
    buffer_load_ushort v35, v114, s[44:47], s64 offen
    s_sub_u32 s95, s40, 4
    v_add_u32 v18, 40960, v116
    v_mov_b32 v16, v116
    v_mov_b32 v2, v112
    v_mov_b32 v3, v113
    v_mov_b32 v4, v127
    v_mov_b32 v5, v115
    v_mov_b32 v6, v118
    v_mov_b32 v7, v28
    v_mov_b32 v9, v122
    v_mov_b32 v10, v119
    v_mov_b32 v8, v26
    v_mov_b32 v11, v27
    v_mov_b32 v17, v117
    ds_read_b64_tr_b16 v[48:49], v16 offset:0
    ds_read_b64_tr_b16 v[50:51], v16 offset:160
    ds_read_b64_tr_b16 v[52:53], v16 offset:5120
    ds_read_b64_tr_b16 v[54:55], v16 offset:5280
    ds_read_b64_tr_b16 v[56:57], v16 offset:10240
    ds_read_b64_tr_b16 v[58:59], v16 offset:10400
    ds_read_b64_tr_b16 v[60:61], v16 offset:15360
    ds_read_b64_tr_b16 v[62:63], v16 offset:15520
    ds_read_b64_tr_b16 v[64:65], v16 offset:20480
    ds_read_b64_tr_b16 v[66:67], v16 offset:20640
    ds_read_b64_tr_b16 v[68:69], v16 offset:25600
    ds_read_b64_tr_b16 v[70:71], v16 offset:25760
    ds_read_b64_tr_b16 v[72:73], v16 offset:30720
    ds_read_b64_tr_b16 v[74:75], v16 offset:30880
    ds_read_b64_tr_b16 v[76:77], v16 offset:35840
    ds_read_b64_tr_b16 v[78:79], v16 offset:36000
    ds_read_b64_tr_b16 v[80:81], v18 offset:0
    ds_read_b64_tr_b16 v[82:83], v18 offset:160
    ds_read_b64_tr_b16 v[84:85], v18 offset:5120
    ds_read_b64_tr_b16 v[86:87], v18 offset:5280
    ds_read_b64_tr_b16 v[88:89], v18 offset:10240
    ds_read_b64_tr_b16 v[90:91], v18 offset:10400
    ds_read_b64_tr_b16 v[92:93], v18 offset:15360
    ds_read_b64_tr_b16 v[94:95], v18 offset:15520
    ds_read_b64_tr_b16 v[96:97], v18 offset:20480
    ds_read_b64_tr_b16 v[98:99], v18 offset:20640
    ds_read_b64_tr_b16 v[100:101], v18 offset:25600
    ds_read_b64_tr_b16 v[102:103], v18 offset:25760
    ds_read_b64_tr_b16 v[104:105], v18 offset:30720
    ds_read_b64_tr_b16 v[106:107], v18 offset:30880
    ds_read_b64_tr_b16 v[108:109], v18 offset:35840
    ds_read_b64_tr_b16 v[110:111], v18 offset:36000
    s_mov_b32 s48, s12
    s_mov_b32 s49, s13
    s_mov_b32 s50, 819200
    s_mov_b32 s51, 0x20000
    s_lshl_b32 s46, s40, 10
    s_waitcnt lgkmcnt(0)
    s_barrier
    s_cmp_ge_u32 s40, 5
    s_cbranch_scc1 WD_44
    s_add_u32 m0, s46, 0
    s_mov_b32 s64, 655360
    buffer_load_dwordx4 v17, s[48:51], s64 offen lds
    s_add_u32 m0, s46, 5120
    s_mov_b32 s64, 696320
    buffer_load_dwordx4 v17, s[48:51], s64 offen lds
    s_add_u32 m0, s46, 10240
    s_mov_b32 s64, 737280
    buffer_load_dwordx4 v17, s[48:51], s64 offen lds
    s_add_u32 m0, s46, 15360
    s_mov_b32 s64, 778240
    buffer_load_dwordx4 v17, s[48:51], s64 offen lds
WD_44:
    s_waitcnt vmcnt(0)
    v_dot2_f32_bf16 v12, v32, v0, 0
    v_dot2_f32_bf16 v13, v33, v0, 0
    v_dot2_f32_bf16 v14, v34, v0, 0
    v_dot2_f32_bf16 v15, v35, v0, 0
    s_mov_b32 s48, s24
    s_mov_b32 s49, s25
    s_mov_b32 s50, 819200
    s_mov_b32 s51, 0x20000
    s_mov_b32 s52, s26
    s_mov_b32 s53, s27
    s_mov_b32 s54, 819200
    s_mov_b32 s55, 0x20000
    s_lshl_b32 s39, s95, 10
    s_lshl_b32 s43, s37, 7
    s_add_u32 m0, s39, 65536
    s_nop 0
    buffer_load_dwordx4 v9, s[48:51], s43 offen lds
    s_add_u32 m0, s39, 69632
    s_nop 0
    buffer_load_dwordx4 v8, s[48:51], s43 offen lds
    s_cmp_ge_u32 s95, 2
    s_cbranch_scc1 SD_45
    s_add_u32 m0, s39, 73728
    s_nop 0
    buffer_load_dwordx4 v11, s[48:51], s43 offen lds
SD_45:
    s_add_u32 s43, s43, 128
    s_cmp_eq_u32 s43, 1280
    s_cselect_b32 s43, 0, s43
    s_barrier
    ds_read_b64_tr_b16 v[112:113], v16 offset:0
    ds_read_b64_tr_b16 v[114:115], v16 offset:160
    ds_read_b64_tr_b16 v[116:117], v16 offset:5120
    ds_read_b64_tr_b16 v[118:119], v16 offset:5280
    ds_read_b64_tr_b16 v[120:121], v16 offset:10240
    ds_read_b64_tr_b16 v[122:123], v16 offset:10400
    ds_read_b64_tr_b16 v[124:125], v16 offset:15360
    ds_read_b64_tr_b16 v[126:127], v16 offset:15520
    s_waitcnt lgkmcnt(0)
    s_barrier
    s_waitcnt vmcnt(0)
    s_add_u32 m0, s39, 8704
    s_nop 0
    buffer_load_dwordx4 v9, s[48:51], s43 offen lds
    s_add_u32 m0, s39, 12800
    s_nop 0
    buffer_load_dwordx4 v8, s[48:51], s43 offen lds
    s_cmp_ge_u32 s95, 2
    s_cbranch_scc1 SD_46
    s_add_u32 m0, s39, 16896
    s_nop 0
    buffer_load_dwordx4 v11, s[48:51], s43 offen lds
SD_46:
    s_add_u32 s43, s43, 128
    s_cmp_eq_u32 s43, 1280
    s_cselect_b32 s43, 0, s43
    s_add_u32 m0, s39, 27648
    s_nop 0
    buffer_load_dwordx4 v9, s[48:51], s43 offen lds
    s_add_u32 m0, s39, 31744
    s_nop 0
    buffer_load_dwordx4 v8, s[48:51], s43 offen lds
    s_cmp_ge_u32 s95, 2
    s_cbranch_scc1 SD_47
    s_add_u32 m0, s39, 35840
    s_nop 0
    buffer_load_dwordx4 v11, s[48:51], s43 offen lds
SD_47:
    s_add_u32 s43, s43, 128
    s_cmp_eq_u32 s43, 1280
    s_cselect_b32 s43, 0, s43
    s_add_u32 m0, s39, 46592
    s_nop 0
    buffer_load_dwordx4 v9, s[48:51], s43 offen lds
    s_add_u32 m0, s39, 50688
    s_nop 0
    buffer_load_dwordx4 v8, s[48:51], s43 offen lds
    s_cmp_ge_u32 s95, 2
    s_cbranch_scc1 SD_48
    s_add_u32 m0, s39, 54784
    s_nop 0
    buffer_load_dwordx4 v11, s[48:51], s43 offen lds
SD_48:
    s_add_u32 s43, s43, 128
    s_cmp_eq_u32 s43, 1280
    s_cselect_b32 s43, 0, s43
    s_setprio 3
    s_barrier
    ds_read_b64_tr_b16 v[16:17], v2 offset:56832
    ds_read_b64_tr_b16 v[18:19], v2 offset:56896
    ds_read_b128 v[20:23], v3 offset:56832
    ds_read_b64_tr_b16 v[24:25], v2 offset:57344
    ds_read_b64_tr_b16 v[26:27], v2 offset:57408
    ds_read_b128 v[28:31], v4 offset:56832
    s_waitcnt lgkmcnt(0)
    s_waitcnt vmcnt(4)
    s_barrier
    s_add_u32 m0, s39, 65536
    s_nop 0
    buffer_load_dwordx4 v9, s[48:51], s43 offen lds
    s_add_u32 m0, s39, 69632
    s_nop 0
    buffer_load_dwordx4 v8, s[48:51], s43 offen lds
    s_cmp_ge_u32 s95, 2
    s_cbranch_scc1 SD_49
    s_add_u32 m0, s39, 73728
    s_nop 0
    buffer_load_dwordx4 v11, s[48:51], s43 offen lds
SD_49:
    s_add_u32 s43, s43, 128
    s_cmp_eq_u32 s43, 1280
    s_cselect_b32 s43, 0, s43
    s_setprio 0
    v_mfma_f32_16x16x32_bf16 v[12:15], v[16:19], v[20:23], v[12:15]
    s_setprio 3
    ds_read_b64_tr_b16 v[32:33], v2 offset:0
    ds_read_b64_tr_b16 v[34:35], v2 offset:64
    ds_read_b128 v[36:39], v3 offset:0
    ds_read_b64_tr_b16 v[40:41], v2 offset:512
    ds_read_b64_tr_b16 v[42:43], v2 offset:576
    ds_read_b128 v[44:47], v4 offset:0
    s_setprio 0
    v_mfma_f32_16x16x32_bf16 v[12:15], v[24:27], v[28:31], v[12:15]
    s_setprio 3
    s_waitcnt lgkmcnt(0)
    s_waitcnt vmcnt(4)
    s_barrier
    s_add_u32 m0, s39, 8704
    s_nop 0
    buffer_load_dwordx4 v9, s[48:51], s43 offen lds
    s_add_u32 m0, s39, 12800
    s_nop 0
    buffer_load_dwordx4 v8, s[48:51], s43 offen lds
    s_cmp_ge_u32 s95, 2
    s_cbranch_scc1 SD_50
    s_add_u32 m0, s39, 16896
    s_nop 0
    buffer_load_dwordx4 v11, s[48:51], s43 offen lds
SD_50:
    s_add_u32 s43, s43, 128
    s_cmp_eq_u32 s43, 1280
    s_cselect_b32 s43, 0, s43
    s_setprio 0
    v_mfma_f32_16x16x32_bf16 v[12:15], v[32:35], v[36:39], v[12:15]
    s_setprio 3
    ds_read_b64_tr_b16 v[16:17], v2 offset:18944
    ds_read_b64_tr_b16 v[18:19], v2 offset:19008
    ds_read_b128 v[20:23], v3 offset:18944
    ds_read_b64_tr_b16 v[24:25], v2 offset:19456
    ds_read_b64_tr_b16 v[26:27], v2 offset:19520
    ds_read_b128 v[28:31], v4 offset:18944
    s_setprio 0
    v_mfma_f32_16x16x32_bf16 v[12:15], v[40:43], v[44:47], v[12:15]
    s_setprio 3
    s_waitcnt lgkmcnt(0)
    s_waitcnt vmcnt(4)
    s_barrier
    s_add_u32 m0, s39, 27648
    s_nop 0
    buffer_load_dwordx4 v9, s[48:51], s43 offen lds
    s_add_u32 m0, s39, 31744
    s_nop 0
    buffer_load_dwordx4 v8, s[48:51], s43 offen lds
    s_cmp_ge_u32 s95, 2
    s_cbranch_scc1 SD_51
    s_add_u32 m0, s39, 35840
    s_nop 0
    buffer_load_dwordx4 v11, s[48:51], s43 offen lds
SD_51:
    s_add_u32 s43, s43, 128
    s_cmp_eq_u32 s43, 1280
    s_cselect_b32 s43, 0, s43
    s_setprio 0
    v_mfma_f32_16x16x32_bf16 v[12:15], v[16:19], v[20:23], v[12:15]
    s_setprio 3
    ds_read_b64_tr_b16 v[32:33], v2 offset:37888
    ds_read_b64_tr_b16 v[34:35], v2 offset:37952
    ds_read_b128 v[36:39], v3 offset:37888
    ds_read_b64_tr_b16 v[40:41], v2 offset:38400
    ds_read_b64_tr_b16 v[42:43], v2 offset:38464
    ds_read_b128 v[44:47], v4 offset:37888
    s_setprio 0
    v_mfma_f32_16x16x32_bf16 v[12:15], v[24:27], v[28:31], v[12:15]
    s_setprio 3
    s_waitcnt lgkmcnt(0)
    s_waitcnt vmcnt(4)
    s_barrier
    s_add_u32 m0, s39, 46592
    s_nop 0
    buffer_load_dwordx4 v9, s[48:51], s43 offen lds
    s_add_u32 m0, s39, 50688
    s_nop 0
    buffer_load_dwordx4 v8, s[48:51], s43 offen lds
    s_cmp_ge_u32 s95, 2
    s_cbranch_scc1 SD_52
    s_add_u32 m0, s39, 54784
    s_nop 0
    buffer_load_dwordx4 v11, s[48:51], s43 offen lds
SD_52:
    s_add_u32 s43, s43, 128
    s_cmp_eq_u32 s43, 1280
    s_cselect_b32 s43, 0, s43
    s_setprio 0
    v_mfma_f32_16x16x32_bf16 v[12:15], v[32:35], v[36:39], v[12:15]
    s_setprio 3
    ds_read_b64_tr_b16 v[16:17], v2 offset:56832
    ds_read_b64_tr_b16 v[18:19], v2 offset:56896
    ds_read_b128 v[20:23], v3 offset:56832
    ds_read_b64_tr_b16 v[24:25], v2 offset:57344
    ds_read_b64_tr_b16 v[26:27], v2 offset:57408
    ds_read_b128 v[28:31], v4 offset:56832
    s_setprio 0
    v_mfma_f32_16x16x32_bf16 v[12:15], v[40:43], v[44:47], v[12:15]
    s_setprio 3
    s_waitcnt lgkmcnt(0)
    s_waitcnt vmcnt(4)
    s_barrier
    s_add_u32 m0, s39, 65536
    s_nop 0
    buffer_load_dwordx4 v9, s[48:51], s43 offen lds
    s_add_u32 m0, s39, 69632
    s_nop 0
    buffer_load_dwordx4 v8, s[48:51], s43 offen lds
    s_cmp_ge_u32 s95, 2
    s_cbranch_scc1 SD_53
    s_add_u32 m0, s39, 73728
    s_nop 0
    buffer_load_dwordx4 v11, s[48:51], s43 offen lds
SD_53:
    s_add_u32 s43, s43, 128
    s_cmp_eq_u32 s43, 1280
    s_cselect_b32 s43, 0, s43
    s_setprio 0
    v_mfma_f32_16x16x32_bf16 v[12:15], v[16:19], v[20:23], v[12:15]
    s_setprio 3
    ds_read_b64_tr_b16 v[32:33], v2 offset:0
    ds_read_b64_tr_b16 v[34:35], v2 offset:64
    ds_read_b128 v[36:39], v3 offset:0
    ds_read_b64_tr_b16 v[40:41], v2 offset:512
    ds_read_b64_tr_b16 v[42:43], v2 offset:576
    ds_read_b128 v[44:47], v4 offset:0
    s_setprio 0
    v_mfma_f32_16x16x32_bf16 v[12:15], v[24:27], v[28:31], v[12:15]
    s_setprio 3
    s_waitcnt lgkmcnt(0)
    s_waitcnt vmcnt(4)
    s_barrier
    s_add_u32 m0, s39, 8704
    s_nop 0
    buffer_load_dwordx4 v9, s[48:51], s43 offen lds
    s_add_u32 m0, s39, 12800
    s_nop 0
    buffer_load_dwordx4 v8, s[48:51], s43 offen lds
    s_cmp_ge_u32 s95, 2
    s_cbranch_scc1 SD_54
    s_add_u32 m0, s39, 16896
    s_nop 0
    buffer_load_dwordx4 v11, s[48:51], s43 offen lds
SD_54:
    s_add_u32 s43, s43, 128
    s_cmp_eq_u32 s43, 1280
    s_cselect_b32 s43, 0, s43
    s_setprio 0
    v_mfma_f32_16x16x32_bf16 v[12:15], v[32:35], v[36:39], v[12:15]
    s_setprio 3
    ds_read_b64_tr_b16 v[16:17], v2 offset:18944
    ds_read_b64_tr_b16 v[18:19], v2 offset:19008
    ds_read_b128 v[20:23], v3 offset:18944
    ds_read_b64_tr_b16 v[24:25], v2 offset:19456
    ds_read_b64_tr_b16 v[26:27], v2 offset:19520
    ds_read_b128 v[28:31], v4 offset:18944
    s_setprio 0
    v_mfma_f32_16x16x32_bf16 v[12:15], v[40:43], v[44:47], v[12:15]
    s_setprio 3
    s_waitcnt lgkmcnt(0)
    s_waitcnt vmcnt(4)
    s_barrier
    s_add_u32 m0, s39, 27648
    s_nop 0
    buffer_load_dwordx4 v9, s[52:55], s43 offen lds
    s_add_u32 m0, s39, 31744
    s_nop 0
    buffer_load_dwordx4 v8, s[52:55], s43 offen lds
    s_cmp_ge_u32 s95, 2
    s_cbranch_scc1 SD_55
    s_add_u32 m0, s39, 35840
    s_nop 0
    buffer_load_dwordx4 v11, s[52:55], s43 offen lds
SD_55:
    s_add_u32 s43, s43, 128
    s_cmp_eq_u32 s43, 1280
    s_cselect_b32 s43, 0, s43
    s_setprio 0
    v_mfma_f32_16x16x32_bf16 v[12:15], v[16:19], v[20:23], v[12:15]
    s_setprio 3
    ds_read_b64_tr_b16 v[32:33], v2 offset:37888
    ds_read_b64_tr_b16 v[34:35], v2 offset:37952
    ds_read_b128 v[36:39], v3 offset:37888
    ds_read_b64_tr_b16 v[40:41], v2 offset:38400
    ds_read_b64_tr_b16 v[42:43], v2 offset:38464
    ds_read_b128 v[44:47], v4 offset:37888
    s_setprio 0
    v_mfma_f32_16x16x32_bf16 v[12:15], v[24:27], v[28:31], v[12:15]
    s_setprio 3
    s_waitcnt lgkmcnt(0)
    s_waitcnt vmcnt(4)
    s_barrier
    s_add_u32 m0, s39, 46592
    s_nop 0
    buffer_load_dwordx4 v9, s[52:55], s43 offen lds
    s_add_u32 m0, s39, 50688
    s_nop 0
    buffer_load_dwordx4 v8, s[52:55], s43 offen lds
    s_cmp_ge_u32 s95, 2
    s_cbranch_scc1 SD_56
    s_add_u32 m0, s39, 54784
    s_nop 0
    buffer_load_dwordx4 v11, s[52:55], s43 offen lds
SD_56:
    s_add_u32 s43, s43, 128
    s_cmp_eq_u32 s43, 1280
    s_cselect_b32 s43, 0, s43
    s_setprio 0
    v_mfma_f32_16x16x32_bf16 v[12:15], v[32:35], v[36:39], v[12:15]
    s_setprio 3
    ds_read_b64_tr_b16 v[16:17], v2 offset:56832
    ds_read_b64_tr_b16 v[18:19], v2 offset:56896
    ds_read_b128 v[20:23], v3 offset:56832
    ds_read_b64_tr_b16 v[24:25], v2 offset:57344
    ds_read_b64_tr_b16 v[26:27], v2 offset:57408
    ds_read_b128 v[28:31], v4 offset:56832
    s_setprio 0
    v_mfma_f32_16x16x32_bf16 v[12:15], v[40:43], v[44:47], v[12:15]
    s_setprio 3
    s_waitcnt lgkmcnt(0)
    s_waitcnt vmcnt(4)
    s_barrier
    s_add_u32 m0, s39, 65536
    s_nop 0
    buffer_load_dwordx4 v9, s[52:55], s43 offen lds
    s_add_u32 m0, s39, 69632
    s_nop 0
    buffer_load_dwordx4 v8, s[52:55], s43 offen lds
    s_cmp_ge_u32 s95, 2
    s_cbranch_scc1 SD_57
    s_add_u32 m0, s39, 73728
    s_nop 0
    buffer_load_dwordx4 v11, s[52:55], s43 offen lds
SD_57:
    s_add_u32 s43, s43, 128
    s_cmp_eq_u32 s43, 1280
    s_cselect_b32 s43, 0, s43
    s_setprio 0
    v_mfma_f32_16x16x32_bf16 v[12:15], v[16:19], v[20:23], v[12:15]
    s_setprio 3
    ds_read_b64_tr_b16 v[32:33], v2 offset:0
    ds_read_b64_tr_b16 v[34:35], v2 offset:64
    ds_read_b128 v[36:39], v3 offset:0
    ds_read_b64_tr_b16 v[40:41], v2 offset:512
    ds_read_b64_tr_b16 v[42:43], v2 offset:576
    ds_read_b128 v[44:47], v4 offset:0
    s_setprio 0
    v_mfma_f32_16x16x32_bf16 v[12:15], v[24:27], v[28:31], v[12:15]
    s_setprio 3
    s_waitcnt lgkmcnt(0)
    s_waitcnt vmcnt(4)
    s_barrier
    s_add_u32 m0, s39, 8704
    s_nop 0
    buffer_load_dwordx4 v9, s[52:55], s43 offen lds
    s_add_u32 m0, s39, 12800
    s_nop 0
    buffer_load_dwordx4 v8, s[52:55], s43 offen lds
    s_cmp_ge_u32 s95, 2
    s_cbranch_scc1 SD_58
    s_add_u32 m0, s39, 16896
    s_nop 0
    buffer_load_dwordx4 v11, s[52:55], s43 offen lds
SD_58:
    s_add_u32 s43, s43, 128
    s_cmp_eq_u32 s43, 1280
    s_cselect_b32 s43, 0, s43
    s_setprio 0
    v_mfma_f32_16x16x32_bf16 v[12:15], v[32:35], v[36:39], v[12:15]
    s_setprio 3
    ds_read_b64_tr_b16 v[16:17], v2 offset:18944
    ds_read_b64_tr_b16 v[18:19], v2 offset:19008
    ds_read_b128 v[20:23], v3 offset:18944
    ds_read_b64_tr_b16 v[24:25], v2 offset:19456
    ds_read_b64_tr_b16 v[26:27], v2 offset:19520
    ds_read_b128 v[28:31], v4 offset:18944
    s_setprio 0
    v_mfma_f32_16x16x32_bf16 v[12:15], v[40:43], v[44:47], v[12:15]
    s_setprio 3
    s_waitcnt lgkmcnt(0)
    s_waitcnt vmcnt(4)
    s_barrier
    s_add_u32 m0, s39, 27648
    s_nop 0
    buffer_load_dwordx4 v9, s[52:55], s43 offen lds
    s_add_u32 m0, s39, 31744
    s_nop 0
    buffer_load_dwordx4 v8, s[52:55], s43 offen lds
    s_cmp_ge_u32 s95, 2
    s_cbranch_scc1 SD_59
    s_add_u32 m0, s39, 35840
    s_nop 0
    buffer_load_dwordx4 v11, s[52:55], s43 offen lds
SD_59:
    s_add_u32 s43, s43, 128
    s_cmp_eq_u32 s43, 1280
    s_cselect_b32 s43, 0, s43
    s_setprio 0
    v_mfma_f32_16x16x32_bf16 v[12:15], v[16:19], v[20:23], v[12:15]
    s_setprio 3
    ds_read_b64_tr_b16 v[32:33], v2 offset:37888
    ds_read_b64_tr_b16 v[34:35], v2 offset:37952
    ds_read_b128 v[36:39], v3 offset:37888
    ds_read_b64_tr_b16 v[40:41], v2 offset:38400
    ds_read_b64_tr_b16 v[42:43], v2 offset:38464
    ds_read_b128 v[44:47], v4 offset:37888
    s_setprio 0
    v_mfma_f32_16x16x32_bf16 v[12:15], v[24:27], v[28:31], v[12:15]
    s_setprio 3
    s_waitcnt lgkmcnt(0)
    s_waitcnt vmcnt(4)
    s_barrier
    s_add_u32 m0, s39, 46592
    s_nop 0
    buffer_load_dwordx4 v9, s[52:55], s43 offen lds
    s_add_u32 m0, s39, 50688
    s_nop 0
    buffer_load_dwordx4 v8, s[52:55], s43 offen lds
    s_cmp_ge_u32 s95, 2
    s_cbranch_scc1 SD_60
    s_add_u32 m0, s39, 54784
    s_nop 0
    buffer_load_dwordx4 v11, s[52:55], s43 offen lds
SD_60:
    s_add_u32 s43, s43, 128
    s_cmp_eq_u32 s43, 1280
    s_cselect_b32 s43, 0, s43
    s_setprio 0
    v_mfma_f32_16x16x32_bf16 v[12:15], v[32:35], v[36:39], v[12:15]
    s_setprio 3
    ds_read_b64_tr_b16 v[16:17], v2 offset:56832
    ds_read_b64_tr_b16 v[18:19], v2 offset:56896
    ds_read_b128 v[20:23], v3 offset:56832
    ds_read_b64_tr_b16 v[24:25], v2 offset:57344
    ds_read_b64_tr_b16 v[26:27], v2 offset:57408
    ds_read_b128 v[28:31], v4 offset:56832
    s_setprio 0
    v_mfma_f32_16x16x32_bf16 v[12:15], v[40:43], v[44:47], v[12:15]
    s_setprio 3
    s_waitcnt lgkmcnt(0)
    s_waitcnt vmcnt(4)
    s_barrier
    s_add_u32 m0, s39, 65536
    s_nop 0
    buffer_load_dwordx4 v9, s[52:55], s43 offen lds
    s_add_u32 m0, s39, 69632
    s_nop 0
    buffer_load_dwordx4 v8, s[52:55], s43 offen lds
    s_cmp_ge_u32 s95, 2
    s_cbranch_scc1 SD_61
    s_add_u32 m0, s39, 73728
    s_nop 0
    buffer_load_dwordx4 v11, s[52:55], s43 offen lds
SD_61:
    s_add_u32 s43, s43, 128
    s_cmp_eq_u32 s43, 1280
    s_cselect_b32 s43, 0, s43
    s_setprio 0
    v_mfma_f32_16x16x32_bf16 v[12:15], v[16:19], v[20:23], v[12:15]
    s_setprio 3
    ds_read_b64_tr_b16 v[32:33], v2 offset:0
    ds_read_b64_tr_b16 v[34:35], v2 offset:64
    ds_read_b128 v[36:39], v3 offset:0
    ds_read_b64_tr_b16 v[40:41], v2 offset:512
    ds_read_b64_tr_b16 v[42:43], v2 offset:576
    ds_read_b128 v[44:47], v4 offset:0
    s_setprio 0
    v_mfma_f32_16x16x32_bf16 v[12:15], v[24:27], v[28:31], v[12:15]
    s_setprio 3
    s_waitcnt lgkmcnt(0)
    s_waitcnt vmcnt(4)
    s_barrier
    s_add_u32 m0, s39, 8704
    s_nop 0
    buffer_load_dwordx4 v9, s[52:55], s43 offen lds
    s_add_u32 m0, s39, 12800
    s_nop 0
    buffer_load_dwordx4 v8, s[52:55], s43 offen lds
    s_cmp_ge_u32 s95, 2
    s_cbranch_scc1 SD_62
    s_add_u32 m0, s39, 16896
    s_nop 0
    buffer_load_dwordx4 v11, s[52:55], s43 offen lds
SD_62:
    s_add_u32 s43, s43, 128
    s_cmp_eq_u32 s43, 1280
    s_cselect_b32 s43, 0, s43
    s_setprio 0
    v_mfma_f32_16x16x32_bf16 v[12:15], v[32:35], v[36:39], v[12:15]
    s_setprio 3
    ds_read_b64_tr_b16 v[16:17], v2 offset:18944
    ds_read_b64_tr_b16 v[18:19], v2 offset:19008
    ds_read_b128 v[20:23], v3 offset:18944
    ds_read_b64_tr_b16 v[24:25], v2 offset:19456
    ds_read_b64_tr_b16 v[26:27], v2 offset:19520
    ds_read_b128 v[28:31], v4 offset:18944
    s_setprio 0
    v_mfma_f32_16x16x32_bf16 v[12:15], v[40:43], v[44:47], v[12:15]
    s_setprio 3
    s_waitcnt lgkmcnt(0)
    s_waitcnt vmcnt(4)
    s_barrier
    s_add_u32 m0, s39, 27648
    s_nop 0
    buffer_load_dwordx4 v9, s[52:55], s43 offen lds
    s_add_u32 m0, s39, 31744
    s_nop 0
    buffer_load_dwordx4 v8, s[52:55], s43 offen lds
    s_cmp_ge_u32 s95, 2
    s_cbranch_scc1 SD_63
    s_add_u32 m0, s39, 35840
    s_nop 0
    buffer_load_dwordx4 v11, s[52:55], s43 offen lds
SD_63:
    s_add_u32 s43, s43, 128
    s_cmp_eq_u32 s43, 1280
    s_cselect_b32 s43, 0, s43
    s_setprio 0
    v_mfma_f32_16x16x32_bf16 v[12:15], v[16:19], v[20:23], v[12:15]
    s_setprio 3
    ds_read_b64_tr_b16 v[32:33], v2 offset:37888
    ds_read_b64_tr_b16 v[34:35], v2 offset:37952
    ds_read_b128 v[36:39], v3 offset:37888
    ds_read_b64_tr_b16 v[40:41], v2 offset:38400
    ds_read_b64_tr_b16 v[42:43], v2 offset:38464
    ds_read_b128 v[44:47], v4 offset:37888
    s_setprio 0
    v_mfma_f32_16x16x32_bf16 v[12:15], v[24:27], v[28:31], v[12:15]
    s_setprio 3
    s_waitcnt lgkmcnt(0)
    s_waitcnt vmcnt(4)
    s_barrier
    s_add_u32 m0, s39, 46592
    s_nop 0
    buffer_load_dwordx4 v9, s[52:55], s43 offen lds
    s_add_u32 m0, s39, 50688
    s_nop 0
    buffer_load_dwordx4 v8, s[52:55], s43 offen lds
    s_cmp_ge_u32 s95, 2
    s_cbranch_scc1 SD_64
    s_add_u32 m0, s39, 54784
    s_nop 0
    buffer_load_dwordx4 v11, s[52:55], s43 offen lds
SD_64:
    s_add_u32 s43, s43, 128
    s_cmp_eq_u32 s43, 1280
    s_cselect_b32 s43, 0, s43
    s_setprio 0
    v_mfma_f32_16x16x32_bf16 v[12:15], v[32:35], v[36:39], v[12:15]
    s_setprio 3
    ds_read_b64_tr_b16 v[16:17], v2 offset:56832
    ds_read_b64_tr_b16 v[18:19], v2 offset:56896
    ds_read_b128 v[20:23], v3 offset:56832
    ds_read_b64_tr_b16 v[24:25], v2 offset:57344
    ds_read_b64_tr_b16 v[26:27], v2 offset:57408
    ds_read_b128 v[28:31], v4 offset:56832
    s_setprio 0
    v_mfma_f32_16x16x32_bf16 v[12:15], v[40:43], v[44:47], v[12:15]
    s_setprio 3
    s_waitcnt lgkmcnt(0)
    s_waitcnt vmcnt(4)
    s_barrier
    s_setprio 0
    v_mfma_f32_16x16x32_bf16 v[12:15], v[16:19], v[20:23], v[12:15]
    s_setprio 3
    ds_read_b64_tr_b16 v[32:33], v2 offset:0
    ds_read_b64_tr_b16 v[34:35], v2 offset:64
    ds_read_b128 v[36:39], v3 offset:0
    ds_read_b64_tr_b16 v[40:41], v2 offset:512
    ds_read_b64_tr_b16 v[42:43], v2 offset:576
    ds_read_b128 v[44:47], v4 offset:0
    s_setprio 0
    v_mfma_f32_16x16x32_bf16 v[12:15], v[24:27], v[28:31], v[12:15]
    s_setprio 3
    s_waitcnt lgkmcnt(0)
    s_waitcnt vmcnt(2)
    s_barrier
    s_setprio 0
    v_mfma_f32_16x16x32_bf16 v[12:15], v[32:35], v[36:39], v[12:15]
    s_setprio 3
    ds_read_b64_tr_b16 v[16:17], v2 offset:18944
    ds_read_b64_tr_b16 v[18:19], v2 offset:19008
    ds_read_b128 v[20:23], v3 offset:18944
    ds_read_b64_tr_b16 v[24:25], v2 offset:19456
    ds_read_b64_tr_b16 v[26:27], v2 offset:19520
    ds_read_b128 v[28:31], v4 offset:18944
    s_setprio 0
    v_mfma_f32_16x16x32_bf16 v[12:15], v[40:43], v[44:47], v[12:15]
    s_setprio 3
    s_waitcnt lgkmcnt(0)
    s_waitcnt vmcnt(0)
    s_barrier
    s_setprio 0
    v_mfma_f32_16x16x32_bf16 v[12:15], v[16:19], v[20:23], v[12:15]
    s_setprio 3
    ds_read_b64_tr_b16 v[32:33], v2 offset:37888
    ds_read_b64_tr_b16 v[34:35], v2 offset:37952
    ds_read_b128 v[36:39], v3 offset:37888
    ds_read_b64_tr_b16 v[40:41], v2 offset:38400
    ds_read_b64_tr_b16 v[42:43], v2 offset:38464
    ds_read_b128 v[44:47], v4 offset:37888
    s_setprio 0
    v_mfma_f32_16x16x32_bf16 v[12:15], v[24:27], v[28:31], v[12:15]
    s_setprio 3
    s_waitcnt lgkmcnt(0)
    s_setprio 0
    v_mfma_f32_16x16x32_bf16 v[12:15], v[32:35], v[36:39], v[12:15]
    v_mfma_f32_16x16x32_bf16 v[12:15], v[40:43], v[44:47], v[12:15]
    s_setprio 3
    s_setprio 3
    s_mov_b32 s52, s32
    s_mov_b32 s53, s33
    s_mov_b32 s54, 10485760
    s_mov_b32 s55, 0x20000
    s_mul_i32 s44, s40, 32768
    s_lshl_b32 s64, s41, 9
    s_add_u32 s44, s44, s64
    s_add_u32 s44, s44, 10485760
    s_lshl_b32 s46, s40, 10
    s_mov_b32 s64, 0
    buffer_store_dword v12, v5, s[52:55], s64 offen offset:2560 sc1
    s_mov_b32 s64, 5120
    buffer_store_dword v13, v5, s[52:55], s64 offen offset:2560 sc1
    s_mov_b32 s64, 10240
    buffer_store_dword v14, v5, s[52:55], s64 offen offset:2560 sc1
    s_mov_b32 s64, 15360
    buffer_store_dword v15, v5, s[52:55], s64 offen offset:2560 sc1
    s_barrier
    s_add_u32 m0, s46, 0
    s_add_u32 s64, s44, 0
    buffer_load_dwordx4 v10, s[56:59], s64 offen sc1 lds
    s_add_u32 m0, s46, 40960
    s_add_u32 s64, s44, 1310720
    buffer_load_dwordx4 v10, s[56:59], s64 offen sc1 lds
    s_barrier
    s_add_u32 m0, s46, 8192
    s_add_u32 s64, s44, 262144
    buffer_load_dwordx4 v10, s[56:59], s64 offen sc1 lds
    s_add_u32 m0, s46, 49152
    s_add_u32 s64, s44, 1572864
    buffer_load_dwordx4 v10, s[56:59], s64 offen sc1 lds
    s_add_u32 m0, s46, 16384
    s_add_u32 s64, s44, 524288
    buffer_load_dwordx4 v10, s[56:59], s64 offen sc1 lds
    s_add_u32 m0, s46, 57344
    s_add_u32 s64, s44, 1835008
    buffer_load_dwordx4 v10, s[56:59], s64 offen sc1 lds
    s_add_u32 m0, s46, 24576
    s_add_u32 s64, s44, 786432
    buffer_load_dwordx4 v10, s[56:59], s64 offen sc1 lds
    s_add_u32 m0, s46, 65536
    s_add_u32 s64, s44, 2097152
    buffer_load_dwordx4 v10, s[56:59], s64 offen sc1 lds
    s_add_u32 m0, s46, 32768
    s_add_u32 s64, s44, 1048576
    buffer_load_dwordx4 v10, s[56:59], s64 offen sc1 lds
    s_add_u32 m0, s46, 73728
    s_add_u32 s64, s44, 2359296
    buffer_load_dwordx4 v10, s[56:59], s64 offen sc1 lds
    v_mbcnt_lo_u32_b32 v0, -1, 0
    v_mbcnt_hi_u32_b32 v0, -1, v0
    s_mul_i32 s65, s95, 5376
    s_add_u32 s65, s65, 256
    v_and_b32 v2, 15, v0
    v_mul_u32_u24 v2, 336, v2
    v_lshrrev_b32 v3, 4, v0
    v_lshl_add_u32 v2, v3, 4, v2
    v_add_u32 v2, s65, v2
    v_mov_b32 v8, 0
    v_mov_b32 v9, 0
    v_mov_b32 v10, 0
    v_mov_b32 v11, 0
    s_lshl_b32 s64, s40, 6
    v_add_u32 v0, s64, v0
    v_mul_u32_u24 v3, 3277, v0
    v_lshrrev_b32 v3, 16, v3
    v_mul_u32_u24 v5, 20, v3
    v_sub_u32 v0, v0, v5
    v_lshlrev_b32 v0, 4, v0
    s_mul_i32 s64, s41, 327680
    s_mul_i32 s65, s42, 320
    s_add_u32 s47, s64, s65
    v_mul_u32_u24 v5, 5120, v3
    v_add_u32 v5, v5, v0
    v_mul_u32_u24 v3, 336, v3
    v_add_u32 v3, v3, v0
    s_waitcnt vmcnt(8)
    s_barrier
    ds_read_b64 v[16:17], v6 offset:0
    ds_read_b64 v[18:19], v6 offset:512
    ds_read_b64 v[20:21], v6 offset:4096
    ds_read_b64 v[22:23], v6 offset:4608
    ds_read_b64 v[24:25], v7 offset:0
    ds_read_b64 v[26:27], v7 offset:512
    ds_read_b64 v[28:29], v7 offset:4096
    ds_read_b64 v[30:31], v7 offset:4608
    s_waitcnt lgkmcnt(6)
    v_mfma_f32_16x16x32_bf16 v[12:15], v[48:51], v[16:19], 0
    s_waitcnt lgkmcnt(4)
    v_mfma_f32_16x16x32_bf16 v[12:15], v[52:55], v[20:23], v[12:15]
    s_waitcnt lgkmcnt(2)
    v_mfma_f32_16x16x32_bf16 v[12:15], v[88:91], v[24:27], v[12:15]
    s_waitcnt lgkmcnt(0)
    v_mfma_f32_16x16x32_bf16 v[12:15], v[92:95], v[28:31], v[12:15]
    s_waitcnt vmcnt(4)
    s_barrier
    ds_read_b64 v[32:33], v6 offset:8192
    ds_read_b64 v[34:35], v6 offset:8704
    ds_read_b64 v[36:37], v6 offset:12288
    ds_read_b64 v[38:39], v6 offset:12800
    ds_read_b64 v[40:41], v7 offset:8192
    ds_read_b64 v[42:43], v7 offset:8704
    ds_read_b64 v[44:45], v7 offset:12288
    ds_read_b64 v[46:47], v7 offset:12800
    ds_read_b64 v[16:17], v6 offset:16384
    ds_read_b64 v[18:19], v6 offset:16896
    ds_read_b64 v[20:21], v6 offset:20480
    ds_read_b64 v[22:23], v6 offset:20992
    ds_read_b64 v[24:25], v7 offset:16384
    ds_read_b64 v[26:27], v7 offset:16896
    ds_read_b64 v[28:29], v7 offset:20480
    ds_read_b64 v[30:31], v7 offset:20992
    s_waitcnt lgkmcnt(14)
    v_mfma_f32_16x16x32_bf16 v[12:15], v[56:59], v[32:35], v[12:15]
    s_waitcnt lgkmcnt(12)
    v_mfma_f32_16x16x32_bf16 v[12:15], v[60:63], v[36:39], v[12:15]
    s_waitcnt lgkmcnt(10)
    v_mfma_f32_16x16x32_bf16 v[12:15], v[96:99], v[40:43], v[12:15]
    s_waitcnt lgkmcnt(8)
    v_mfma_f32_16x16x32_bf16 v[12:15], v[100:103], v[44:47], v[12:15]
    s_waitcnt lgkmcnt(6)
    v_mfma_f32_16x16x32_bf16 v[12:15], v[64:67], v[16:19], v[12:15]
    s_waitcnt lgkmcnt(4)
    v_mfma_f32_16x16x32_bf16 v[12:15], v[68:71], v[20:23], v[12:15]
    s_waitcnt lgkmcnt(2)
    v_mfma_f32_16x16x32_bf16 v[12:15], v[104:107], v[24:27], v[12:15]
    s_waitcnt lgkmcnt(0)
    v_mfma_f32_16x16x32_bf16 v[12:15], v[108:111], v[28:31], v[12:15]
    s_waitcnt vmcnt(0)
    s_barrier
    ds_read_b64 v[32:33], v6 offset:24576
    ds_read_b64 v[34:35], v6 offset:25088
    ds_read_b64 v[36:37], v6 offset:28672
    ds_read_b64 v[38:39], v6 offset:29184
    ds_read_b64 v[40:41], v7 offset:24576
    ds_read_b64 v[42:43], v7 offset:25088
    ds_read_b64 v[44:45], v7 offset:28672
    ds_read_b64 v[46:47], v7 offset:29184
    ds_read_b64 v[16:17], v6 offset:32768
    ds_read_b64 v[18:19], v6 offset:33280
    ds_read_b64 v[20:21], v6 offset:36864
    ds_read_b64 v[22:23], v6 offset:37376
    ds_read_b64 v[24:25], v7 offset:32768
    ds_read_b64 v[26:27], v7 offset:33280
    ds_read_b64 v[28:29], v7 offset:36864
    ds_read_b64 v[30:31], v7 offset:37376
    s_waitcnt lgkmcnt(14)
    v_mfma_f32_16x16x32_bf16 v[12:15], v[72:75], v[32:35], v[12:15]
    s_waitcnt lgkmcnt(12)
    v_mfma_f32_16x16x32_bf16 v[12:15], v[76:79], v[36:39], v[12:15]
    s_waitcnt lgkmcnt(10)
    v_mfma_f32_16x16x32_bf16 v[12:15], v[112:115], v[40:43], v[12:15]
    s_waitcnt lgkmcnt(8)
    v_mfma_f32_16x16x32_bf16 v[12:15], v[116:119], v[44:47], v[12:15]
    s_waitcnt lgkmcnt(6)
    v_mfma_f32_16x16x32_bf16 v[12:15], v[80:83], v[16:19], v[12:15]
    s_waitcnt lgkmcnt(4)
    v_mfma_f32_16x16x32_bf16 v[12:15], v[84:87], v[20:23], v[12:15]
    s_waitcnt lgkmcnt(2)
    v_mfma_f32_16x16x32_bf16 v[12:15], v[120:123], v[24:27], v[12:15]
    s_waitcnt lgkmcnt(0)
    v_mfma_f32_16x16x32_bf16 v[12:15], v[124:127], v[28:31], v[12:15]
    ds_write_b128 v2, v[8:11] offset:40960
    s_nop 6
    ds_write_b128 v2, v[12:15]
    s_waitcnt lgkmcnt(0)
    s_barrier
    s_cmp_ge_u32 s40, 5
    s_cbranch_scc1 L_B_DONE
    ds_read_b128 v[48:51], v3 offset:0
    ds_read_b128 v[52:55], v3 offset:40960
    ds_read_b128 v[56:59], v3 offset:5376
    ds_read_b128 v[60:63], v3 offset:46336
    ds_read_b128 v[64:67], v3 offset:10752
    ds_read_b128 v[68:71], v3 offset:51712
    ds_read_b128 v[72:75], v3 offset:16128
    ds_read_b128 v[76:79], v3 offset:57088
    s_waitcnt lgkmcnt(6)
    v_pk_add_f32 v[48:49], v[48:49], v[52:53]
    v_pk_add_f32 v[50:51], v[50:51], v[54:55]
    buffer_store_dwordx4 v[48:51], v5, s[52:55], s47 offen sc1
    s_add_u32 s47, s47, 81920
    s_waitcnt lgkmcnt(4)
    v_pk_add_f32 v[56:57], v[56:57], v[60:61]
    v_pk_add_f32 v[58:59], v[58:59], v[62:63]
    buffer_store_dwordx4 v[56:59], v5, s[52:55], s47 offen sc1
    s_add_u32 s47, s47, 81920
    s_waitcnt lgkmcnt(2)
    v_pk_add_f32 v[64:65], v[64:65], v[68:69]
    v_pk_add_f32 v[66:67], v[66:67], v[70:71]
    buffer_store_dwordx4 v[64:67], v5, s[52:55], s47 offen sc1
    s_add_u32 s47, s47, 81920
    s_waitcnt lgkmcnt(0)
    v_pk_add_f32 v[72:73], v[72:73], v[76:77]
    v_pk_add_f32 v[74:75], v[74:75], v[78:79]
    buffer_store_dwordx4 v[72:75], v5, s[52:55], s47 offen sc1
L_B_DONE:
    s_endpgm
L_END:
    s_endpgm
.section .rodata,"a"
.p2align 6
.amdhsa_kernel concat_heads__softmax_full_mha__ssm_conv_s5__prompt_kernel
  .amdhsa_next_free_vgpr 128
  .amdhsa_next_free_sgpr 102
  .amdhsa_accum_offset 128
  .amdhsa_group_segment_fixed_size 0
  .amdhsa_kernarg_size 120
  .amdhsa_user_sgpr_count 2
  .amdhsa_user_sgpr_kernarg_segment_ptr 1
  .amdhsa_system_sgpr_workgroup_id_x 1
.end_amdhsa_kernel
```
